```python
import torch

def _softmax(x, axis=-1):
    return torch.softmax(x, dim=axis)

def _gelu(x):
    return torch.nn.functional.gelu(x, approximate='tanh')

def _silu(x):
    return torch.nn.functional.silu(x)

def _sigmoid(x):
    return torch.sigmoid(x)

def _layernorm(x, axis=-1, eps=1e-05):
    m = x.mean(dim=axis, keepdim=True)
    v = x.var(dim=axis, keepdim=True, unbiased=False)
    return (x - m) / torch.sqrt(v + eps)

def _scatter_add(tgt, idx, src, axis=0):
    return tgt.clone().index_add_(axis, idx, src)

def _segment_sum(src, seg, n):
    out = torch.zeros((n,) + src.shape[1:], dtype=src.dtype)
    return out.index_add_(0, seg, src)

def _pad(x, pw):
    flat = tuple((v for pair in reversed(pw) for v in pair))
    return torch.nn.functional.pad(x, flat)
kernel_name = 'interleave_layers__linear_attn_block__memory_aug_recurrent_mem_tr__prompt'

def setup_inputs():

    _w = lambda a: (lambda t: t.to(torch.bfloat16) if t.is_floating_point() else t)(torch.as_tensor(a))

    def _A_setup():
        B, S, D = (1, 2048, 576)
        return {'x': _w((lambda *s: torch.randn(*s, dtype=torch.bfloat16) * 0.05)(B, S, D)), 'wqkv': _w((lambda *s: torch.randn(*s, dtype=torch.bfloat16) * 0.05)(D, 3 * D)), 'wo': _w((lambda *s: torch.randn(*s, dtype=torch.bfloat16) * 0.05)(D, D))}
    _A_in = _A_setup()

    def _B_setup():
        B, S, Dm = (1, 2048, 576)
        H, Dh = (32, 128)
        M, seg = (8, 32)
        seg = min(seg, S)
        S = S // seg * seg
        return {'x': _w((lambda *s: torch.randn(*s, dtype=torch.bfloat16) * 0.05)(B, S, Dm)), 'mem0': _w((lambda *s: torch.randn(*s, dtype=torch.bfloat16) * 0.8)(B, M, Dm)), 'Wq': _w((lambda *s: torch.randn(*s, dtype=torch.bfloat16) * 1.6)(Dm, H, Dh) * Dm ** (-0.5)), 'Wk': _w((lambda *s: torch.randn(*s, dtype=torch.bfloat16) * 1.6)(Dm, H, Dh) * Dm ** (-0.5)), 'Wv': _w((lambda *s: torch.randn(*s, dtype=torch.bfloat16) * 0.8)(Dm, H, Dh) * Dm ** (-0.5)), 'Wo': _w((lambda *s: torch.randn(*s, dtype=torch.bfloat16) * 0.8)(H, Dh, Dm) * (H * Dh) ** (-0.5)), 'seg_len': seg}
    _B_in = _B_setup()
    return {'A_x': _A_in['x'], 'A_wqkv': _A_in['wqkv'], 'A_wo': _A_in['wo'], 'B_x': _B_in['x'], 'B_mem0': _B_in['mem0'], 'B_Wq': _B_in['Wq'], 'B_Wk': _B_in['Wk'], 'B_Wv': _B_in['Wv'], 'B_Wo': _B_in['Wo'], 'B_seg_len': _B_in['seg_len']}

def reference(A_x, A_wqkv, A_wo, B_x, B_mem0, B_Wq, B_Wk, B_Wv, B_Wo, B_seg_len):

    def _A_ref(x, wqkv, wo):
        B, S, D = x.shape
        H = 32
        Dh = D // H
        qkv = (lambda x, *d: x.permute(*d))((x @ wqkv).reshape(B, S, 3, H, Dh), 2, 0, 3, 1, 4)
        q, k, v = (qkv[0], qkv[1], qkv[2])
        phi = lambda t: torch.where(t > 0, t + 1, torch.exp(t)) + 1e-06
        pq, pk = (phi(q), phi(k))
        kv = torch.einsum('bhsd,bhse->bhde', pk, v)
        z = torch.einsum('bhsd->bhd', pk)
        num = torch.einsum('bhqd,bhde->bhqe', pq, kv)
        den = torch.einsum('bhqd,bhd->bhq', pq, z)[..., None] + 1e-06
        o = num / den
        return (lambda x, *d: x.permute(*d))(o, 0, 2, 1, 3).reshape(B, S, D) @ wo

    def _B_ref(x, mem0, Wq, Wk, Wv, Wo, seg_len):
        B, S, Dm = x.shape
        H, Dh = (Wq.shape[1], Wq.shape[2])
        M = mem0.shape[1]
        scale = Dh ** (-0.5)
        n_seg = S // seg_len
        L = M + seg_len
        idx = torch.arange(L)
        mask = (idx[:, None] < M) | (idx[:, None] >= idx[None, :])
        mem = mem0
        outs = []
        for s in range(n_seg):
            xs = x[:, s * seg_len:(s + 1) * seg_len, :].clone()
            h = torch.concatenate([mem, xs], axis=1)
            q = torch.einsum('btd,dhe->bhte', h, Wq)
            k = torch.einsum('btd,dhe->bhte', h, Wk)
            v = torch.einsum('btd,dhe->bhte', h, Wv)
            scores = torch.einsum('bhqe,bhke->bhqk', q, k) * scale
            scores = torch.where(mask[None, None], scores, -1000000000.0)
            p = _softmax(scores, axis=-1)
            o = torch.einsum('bhqk,bhke->bhqe', p, v)
            o = torch.einsum('bhte,hed->btd', o, Wo)
            mem = o[:, :M, :].clone()
            outs.append(o[:, M:, :])
        return torch.concatenate(outs, axis=1)
    x = A_x
    x = x + _A_ref(_layernorm(x, axis=-1), A_wqkv, A_wo)
    x = x + _B_ref(_layernorm(x, axis=-1), B_mem0, B_Wq, B_Wk, B_Wv, B_Wo, B_seg_len)
    x = x + _A_ref(_layernorm(x, axis=-1), A_wqkv, A_wo)
    x = x + _B_ref(_layernorm(x, axis=-1), B_mem0, B_Wq, B_Wk, B_Wv, B_Wo, B_seg_len)
    return x
```

```asm
; @launch grid=(256,1,1) block=(256,1,1) lds=163840
.amdgcn_target "amdgcn-amd-amdhsa--gfx950"
.text
.globl interleave_layers__linear_attn_block__memory_aug_recurrent_mem_tr__prompt_kernel
.p2align 8
.type interleave_layers__linear_attn_block__memory_aug_recurrent_mem_tr__prompt_kernel,@function
interleave_layers__linear_attn_block__memory_aug_recurrent_mem_tr__prompt_kernel:
  s_cmp_ge_u32 s2, 256
  s_cbranch_scc1 END
  s_load_dwordx16 s[24:39], s[0:1], 0
  s_load_dwordx8 s[40:47], s[0:1], 64
  s_load_dwordx2 s[48:49], s[0:1], 96
  v_lshrrev_b32 v1, 6, v0
  s_nop 0
  v_readfirstlane_b32 s51, v1
  s_getreg_b32 s60, hwreg(HW_REG_XCC_ID)
  s_and_b32 s60, s60, 7
  s_mov_b32 s56, 0x05040100
  s_mov_b32 s57, 0x07060302
  s_mov_b32 s58, 0
  s_waitcnt lgkmcnt(0)
  s_mov_b32 s4, s48
  s_mov_b32 s5, s49
  s_mov_b32 s6, 268435456
  s_mov_b32 s7, 0x00020000
  s_mov_b32 s20, s46
  s_mov_b32 s21, s47
  s_mov_b32 s22, 256
  s_mov_b32 s23, 0x00020000
  s_mov_b32 s8, s24
  s_mov_b32 s9, s25
  s_mov_b32 s10, 2359296
  s_mov_b32 s11, 0x00020000
  s_mov_b32 s16, s44
  s_mov_b32 s17, s45
  s_mov_b32 s18, 2359296
  s_mov_b32 s19, 0x00020000
  s_mov_b32 s12, s26
  s_mov_b32 s13, s27
  s_mov_b32 s14, 1990656
  s_mov_b32 s15, 0x00020000
  s_cmp_lg_u32 s51, 0
  s_cbranch_scc1 TK_WAIT
  s_mov_b64 exec, 1
  s_mov_b32 s61, 8
TK_LOOP:
  s_lshl_b32 s62, s60, 5
  v_mov_b32 v1, s62
  v_mov_b32 v2, 1
  buffer_atomic_add v2, v1, s[20:23], 0 offen sc0 sc1
  s_waitcnt vmcnt(0)
  v_readfirstlane_b32 s63, v2
  s_nop 0
  s_cmp_lt_u32 s63, 32
  s_cbranch_scc1 TK_GOT
  s_add_u32 s60, s60, 1
  s_and_b32 s60, s60, 7
  s_sub_u32 s61, s61, 1
  s_cmp_lg_u32 s61, 0
  s_cbranch_scc1 TK_LOOP
  s_mov_b32 s62, 256
  s_mov_b32 s63, 0
TK_GOT:
  s_add_u32 s62, s62, s63
  v_mov_b32 v1, 0
  v_mov_b32 v2, s62
  ds_write_b32 v1, v2
  s_mov_b64 exec, -1
TK_WAIT:
  s_lshr_b32 s61, s2, 3
  s_lshl_b32 s61, s61, 15
  s_cmp_eq_u32 s60, 0
  s_cselect_b32 s61, 0x40000000, s61
  s_add_u32 s62, s61, 0x100000
  v_lshlrev_b32 v164, 7, v0
  buffer_load_dword v165, v164, s[12:15], s61 offen
  buffer_load_dword v166, v164, s[12:15], s62 offen
  s_waitcnt lgkmcnt(0)
  s_barrier
  v_mov_b32 v1, 0
  ds_read_b32 v2, v1
  s_waitcnt lgkmcnt(0)
  v_readfirstlane_b32 s50, v2
  s_waitcnt lgkmcnt(0)
  s_barrier
  v_and_b32 v0, 63, v0
  s_cmp_ge_u32 s50, 32
  s_cbranch_scc1 WORKER
  s_waitcnt vmcnt(0)
  v_lshrrev_b32 v12, 4, v0
  v_and_b32 v13, 15, v0
  v_lshrrev_b32 v14, 5, v0
  v_and_b32 v15, 1, v12
  v_lshlrev_b32 v18, 1, v12
  v_lshlrev_b32 v1, 4, v0
  s_mul_i32 s60, s51, 34816
  s_add_u32 s60, s60, 23552
  v_add_u32 v2, s60, v1
  s_lshl_b32 s78, s51, 11
  s_lshl_b32 s79, s51, 9
  v_and_b32 v16, 7, v0
  v_lshrrev_b32 v17, 3, v0
  v_xor_b32 v10, v16, v17
  v_lshlrev_b32 v10, 4, v10
  v_lshl_add_u32 v9, v16, 7, v10
  v_add_u32 v9, s78, v9
  v_lshrrev_b32 v16, 2, v13
  v_and_b32 v17, 1, v13
  v_lshl_add_u32 v15, v16, 1, v17
  v_bfe_u32 v17, v13, 1, 1
  v_add_u32 v17, v17, v18
  v_xor_b32 v10, v15, v17
  v_lshlrev_b32 v10, 4, v10
  v_lshl_add_u32 v10, v17, 7, v10
  v_bfe_u32 v16, v0, 2, 3
  s_lshl_b32 s60, s51, 1
  v_add_u32 v17, s60, v14
  v_xor_b32 v17, v16, v17
  v_lshlrev_b32 v17, 4, v17
  v_lshl_add_u32 v17, v16, 7, v17
  v_and_b32 v16, 3, v0
  v_lshl_add_u32 v8, v16, 2, v17
  v_add_u32 v8, 8192, v8
  v_lshrrev_b32 v16, 2, v13
  v_lshlrev_b32 v3, 8, v16
  v_and_b32 v16, 1, v13
  v_lshl_add_u32 v3, v16, 7, v3
  v_lshl_add_u32 v3, v18, 4, v3
  v_bfe_u32 v16, v13, 1, 1
  v_lshl_add_u32 v3, v16, 3, v3
  s_lshl_b32 s60, s51, 10
  v_add_u32 v3, s60, v3
  v_lshrrev_b32 v16, 2, v13
  v_lshlrev_b32 v16, 5, v16
  v_xor_b32 v3, v3, v16
  s_cmp_lt_u32 s51, 2
  s_cselect_b32 s60, 32, 0
  v_xor_b32 v3, s60, v3
  v_lshlrev_b32 v4, 4, v15
  v_lshl_add_u32 v4, v12, 7, v4
  v_bfe_u32 v17, v13, 1, 1
  v_xor_b32 v17, 1, v17
  v_lshl_add_u32 v4, v17, 11, v4
  v_and_b32 v16, 7, v13
  v_lshrrev_b32 v17, 3, v13
  s_mul_i32 s60, s51, 33792
  s_lshl_b32 s61, s50, 7
  s_add_u32 s61, s61, 131072
  s_add_u32 s60, s60, s61
  v_lshl_add_u32 v17, v17, 2, v12
  v_mul_u32_u24 v5, 4224, v17
  v_lshl_add_u32 v5, v16, 4, v5
  v_add_u32 v5, s60, v5
  s_lshr_b32 s60, s51, 1
  s_mul_i32 s60, s60, 4096
  s_lshl_b32 s62, s51, 6
  s_add_u32 s60, s60, s62
  s_add_u32 s60, s60, s61
  s_add_u32 s60, s60, 270336
  v_mul_u32_u24 v6, 4224, v18
  v_lshl_add_u32 v6, v13, 2, v6
  v_add_u32 v6, s60, v6
  s_lshl_b32 s70, s51, 5
  s_add_u32 s70, s70, s50
  s_mul_i32 s71, s70, 4224
  s_add_u32 s71, s71, 131072
  s_lshl_b32 s60, s70, 7
  s_lshl_b32 s62, s50, 5
  s_add_u32 s62, s62, s51
  s_lshl_b32 s62, s62, 3
  s_cmp_lt_u32 s51, 2
  s_cselect_b32 s60, s62, s60
  s_cselect_b32 s62, 7, 6
  s_cselect_b32 s63, 4, 3
  s_add_u32 s60, s60, 65536
  s_mov_b32 s3, 135168
  s_add_u32 s59, s78, 65536
  s_lshl_b32 s2, s51, 8
  s_add_u32 s2, s2, 73728
  v_lshlrev_b32 v7, s63, v16
  v_lshl_add_u32 v7, v12, s62, v7
  v_add_u32 v7, s60, v7
  v_and_b32 v17, 40, v0
  v_cmp_ne_u32 vcc, 0, v17
  v_mov_b32 v17, 0x40003100
  s_nop 0
  v_cndmask_b32 v7, v7, v17, vcc
  v_lshrrev_b32 v17, 3, v13
  v_lshl_add_u32 v17, v17, 4, v16
  v_lshlrev_b32 v17, 4, v17
  v_lshl_add_u32 v17, v12, 9, v17
  s_cmp_eq_u32 s51, 3
  s_cselect_b64 vcc, -1, 0
  v_cndmask_b32 v7, v7, v17, vcc
  s_mov_b32 s96, 0x00030003
  s_mov_b32 s97, 0x00030003
  s_mov_b32 s98, 0xaaaaaaaa
  s_mov_b32 s99, 0xaaaaaaaa
  s_mov_b32 s100, -1
  s_mov_b32 s101, 0
  s_mov_b32 s68, 0x3e0293ee
  s_mov_b32 s69, 0
  s_mov_b32 s77, 0
  s_cmp_eq_u32 s51, 3
  s_cselect_b32 s43, 7, 3
  s_cselect_b32 s27, 4096, -1
  s_mov_b32 s26, 0x40000000
  s_cmp_eq_u32 s51, 1
  s_cselect_b32 s26, -16517120, s26
  s_cmp_eq_u32 s51, 2
  s_cselect_b32 s26, 258048, s26
  v_mov_b32 v16, 0
  v_lshlrev_b32 v17, 2, v0
  v_add_u32 v17, 163584, v17
  ds_write_b32 v17, v16
  s_lshl_b32 s75, s50, 6
  s_add_u32 s75, s75, 8192
  s_cmp_eq_u32 s51, 3
  s_cselect_b32 s28, s75, 0x40000000
  v_mov_b32 v20, 0
  v_mov_b32 v21, 0
  v_mov_b32 v22, 0
  v_mov_b32 v23, 0
  buffer_store_dwordx4 v[20:23], v5, s[4:7], 0 offen sc1
  buffer_store_dwordx4 v[20:23], v5, s[4:7], s3 offen sc1
  buffer_store_dword v20, v6, s[4:7], 0 offen sc1
  s_cmp_ge_u32 s70, 72
  s_cbranch_scc1 CH_NZ
  buffer_store_dwordx2 v[20:21], v7, s[4:7], 0 offen sc1
CH_NZ:
  s_waitcnt vmcnt(0) lgkmcnt(0)
  s_barrier
  s_cmp_lg_u32 s51, 0
  s_cbranch_scc1 CH_NA
  s_mov_b64 exec, 1
  v_mov_b32 v20, 4
  v_mov_b32 v21, 1
  buffer_atomic_add v21, v20, s[20:23], 0 offen sc1
  s_mov_b64 exec, -1
CH_NA:
  v_lshrrev_b32 v12, 4, v0
  v_and_b32 v13, 15, v0
  v_lshrrev_b32 v14, 1, v12
  v_lshlrev_b32 v14, 4, v14
  v_and_b32 v15, 1, v12
  v_lshl_add_u32 v14, v15, 2, v14
  s_cmp_lt_u32 s51, 2
  s_cselect_b32 s12, s34, s36
  s_cselect_b32 s13, s35, s37
  s_mov_b32 s14, 4718592
  s_and_b32 s60, s51, 1
  s_lshl_b32 s60, s60, 7
  s_lshl_b32 s61, s50, 8
  s_add_u32 s60, s60, s61
  v_lshlrev_b32 v15, 13, v14
  v_lshl_add_u32 v15, v13, 3, v15
  v_add_u32 v15, s60, v15
  s_mov_b32 s62, 0
  buffer_load_dwordx2 v[72:73], v15, s[12:15], s62 offen
  s_mov_b32 s62, 8192
  buffer_load_dwordx2 v[74:75], v15, s[12:15], s62 offen
  s_mov_b32 s62, 65536
  buffer_load_dwordx2 v[76:77], v15, s[12:15], s62 offen
  s_mov_b32 s62, 73728
  buffer_load_dwordx2 v[78:79], v15, s[12:15], s62 offen
  s_mov_b32 s62, 16384
  buffer_load_dwordx2 v[80:81], v15, s[12:15], s62 offen
  s_mov_b32 s62, 24576
  buffer_load_dwordx2 v[82:83], v15, s[12:15], s62 offen
  s_mov_b32 s62, 81920
  buffer_load_dwordx2 v[84:85], v15, s[12:15], s62 offen
  s_mov_b32 s62, 90112
  buffer_load_dwordx2 v[86:87], v15, s[12:15], s62 offen
  s_mov_b32 s62, 262144
  buffer_load_dwordx2 v[88:89], v15, s[12:15], s62 offen
  s_mov_b32 s62, 270336
  buffer_load_dwordx2 v[90:91], v15, s[12:15], s62 offen
  s_mov_b32 s62, 327680
  buffer_load_dwordx2 v[92:93], v15, s[12:15], s62 offen
  s_mov_b32 s62, 335872
  buffer_load_dwordx2 v[94:95], v15, s[12:15], s62 offen
  s_mov_b32 s62, 278528
  buffer_load_dwordx2 v[96:97], v15, s[12:15], s62 offen
  s_mov_b32 s62, 286720
  buffer_load_dwordx2 v[98:99], v15, s[12:15], s62 offen
  s_mov_b32 s62, 344064
  buffer_load_dwordx2 v[100:101], v15, s[12:15], s62 offen
  s_mov_b32 s62, 352256
  buffer_load_dwordx2 v[102:103], v15, s[12:15], s62 offen
  s_mov_b32 s62, 524288
  buffer_load_dwordx2 v[104:105], v15, s[12:15], s62 offen
  s_mov_b32 s62, 532480
  buffer_load_dwordx2 v[106:107], v15, s[12:15], s62 offen
  s_mov_b32 s62, 589824
  buffer_load_dwordx2 v[108:109], v15, s[12:15], s62 offen
  s_mov_b32 s62, 598016
  buffer_load_dwordx2 v[110:111], v15, s[12:15], s62 offen
  s_mov_b32 s62, 540672
  buffer_load_dwordx2 v[112:113], v15, s[12:15], s62 offen
  s_mov_b32 s62, 548864
  buffer_load_dwordx2 v[114:115], v15, s[12:15], s62 offen
  s_mov_b32 s62, 606208
  buffer_load_dwordx2 v[116:117], v15, s[12:15], s62 offen
  s_mov_b32 s62, 614400
  buffer_load_dwordx2 v[118:119], v15, s[12:15], s62 offen
  s_mov_b32 s62, 786432
  buffer_load_dwordx2 v[120:121], v15, s[12:15], s62 offen
  s_mov_b32 s62, 794624
  buffer_load_dwordx2 v[122:123], v15, s[12:15], s62 offen
  s_mov_b32 s62, 851968
  buffer_load_dwordx2 v[124:125], v15, s[12:15], s62 offen
  s_mov_b32 s62, 860160
  buffer_load_dwordx2 v[126:127], v15, s[12:15], s62 offen
  s_mov_b32 s62, 802816
  buffer_load_dwordx2 v[128:129], v15, s[12:15], s62 offen
  s_mov_b32 s62, 811008
  buffer_load_dwordx2 v[130:131], v15, s[12:15], s62 offen
  s_mov_b32 s62, 868352
  buffer_load_dwordx2 v[132:133], v15, s[12:15], s62 offen
  s_mov_b32 s62, 876544
  buffer_load_dwordx2 v[134:135], v15, s[12:15], s62 offen
  s_mov_b32 s62, 1048576
  buffer_load_dwordx2 v[136:137], v15, s[12:15], s62 offen
  s_mov_b32 s62, 1056768
  buffer_load_dwordx2 v[138:139], v15, s[12:15], s62 offen
  s_mov_b32 s62, 1114112
  buffer_load_dwordx2 v[140:141], v15, s[12:15], s62 offen
  s_mov_b32 s62, 1122304
  buffer_load_dwordx2 v[142:143], v15, s[12:15], s62 offen
  s_mov_b32 s62, 1064960
  buffer_load_dwordx2 v[144:145], v15, s[12:15], s62 offen
  s_mov_b32 s62, 1073152
  buffer_load_dwordx2 v[146:147], v15, s[12:15], s62 offen
  s_mov_b32 s62, 1130496
  buffer_load_dwordx2 v[148:149], v15, s[12:15], s62 offen
  s_mov_b32 s62, 1138688
  buffer_load_dwordx2 v[150:151], v15, s[12:15], s62 offen
  s_mov_b32 s62, 1310720
  buffer_load_dwordx2 v[152:153], v15, s[12:15], s62 offen
  s_mov_b32 s62, 1318912
  buffer_load_dwordx2 v[154:155], v15, s[12:15], s62 offen
  s_mov_b32 s62, 1376256
  buffer_load_dwordx2 v[156:157], v15, s[12:15], s62 offen
  s_mov_b32 s62, 1384448
  buffer_load_dwordx2 v[158:159], v15, s[12:15], s62 offen
  s_mov_b32 s62, 1327104
  buffer_load_dwordx2 v[160:161], v15, s[12:15], s62 offen
  s_mov_b32 s62, 1335296
  buffer_load_dwordx2 v[162:163], v15, s[12:15], s62 offen
  s_mov_b32 s62, 1392640
  buffer_load_dwordx2 v[164:165], v15, s[12:15], s62 offen
  s_mov_b32 s62, 1400832
  buffer_load_dwordx2 v[166:167], v15, s[12:15], s62 offen
  s_waitcnt vmcnt(46)
  v_perm_b32 v28, v74, v72, s56
  v_perm_b32 v11, v74, v72, s57
  v_accvgpr_write_b32 a0, v11
  v_perm_b32 v11, v75, v73, s56
  v_accvgpr_write_b32 a8, v11
  v_perm_b32 v52, v75, v73, s57
  s_waitcnt vmcnt(44)
  v_perm_b32 v29, v78, v76, s56
  v_perm_b32 v11, v78, v76, s57
  v_accvgpr_write_b32 a1, v11
  v_perm_b32 v11, v79, v77, s56
  v_accvgpr_write_b32 a9, v11
  v_perm_b32 v53, v79, v77, s57
  s_waitcnt vmcnt(42)
  v_perm_b32 v30, v82, v80, s56
  v_perm_b32 v11, v82, v80, s57
  v_accvgpr_write_b32 a2, v11
  v_perm_b32 v11, v83, v81, s56
  v_accvgpr_write_b32 a10, v11
  v_perm_b32 v54, v83, v81, s57
  s_waitcnt vmcnt(40)
  v_perm_b32 v31, v86, v84, s56
  v_perm_b32 v11, v86, v84, s57
  v_accvgpr_write_b32 a3, v11
  v_perm_b32 v11, v87, v85, s56
  v_accvgpr_write_b32 a11, v11
  v_perm_b32 v55, v87, v85, s57
  s_waitcnt vmcnt(38)
  v_perm_b32 v32, v90, v88, s56
  v_perm_b32 v11, v90, v88, s57
  v_accvgpr_write_b32 a4, v11
  v_perm_b32 v11, v91, v89, s56
  v_accvgpr_write_b32 a12, v11
  v_perm_b32 v56, v91, v89, s57
  s_waitcnt vmcnt(36)
  v_perm_b32 v33, v94, v92, s56
  v_perm_b32 v11, v94, v92, s57
  v_accvgpr_write_b32 a5, v11
  v_perm_b32 v11, v95, v93, s56
  v_accvgpr_write_b32 a13, v11
  v_perm_b32 v57, v95, v93, s57
  s_waitcnt vmcnt(34)
  v_perm_b32 v34, v98, v96, s56
  v_perm_b32 v11, v98, v96, s57
  v_accvgpr_write_b32 a6, v11
  v_perm_b32 v11, v99, v97, s56
  v_accvgpr_write_b32 a14, v11
  v_perm_b32 v58, v99, v97, s57
  s_waitcnt vmcnt(32)
  v_perm_b32 v35, v102, v100, s56
  v_perm_b32 v11, v102, v100, s57
  v_accvgpr_write_b32 a7, v11
  v_perm_b32 v11, v103, v101, s56
  v_accvgpr_write_b32 a15, v11
  v_perm_b32 v59, v103, v101, s57
  ds_write_b128 v2, v[28:31] offset:0
  ds_write_b128 v2, v[32:35] offset:1024
  ds_write_b128 v2, v[52:55] offset:2048
  ds_write_b128 v2, v[56:59] offset:3072
  s_mov_b32 s62, 1572864
  buffer_load_dwordx2 v[168:169], v15, s[12:15], s62 offen
  s_mov_b32 s62, 1581056
  buffer_load_dwordx2 v[170:171], v15, s[12:15], s62 offen
  s_mov_b32 s62, 1638400
  buffer_load_dwordx2 v[172:173], v15, s[12:15], s62 offen
  s_mov_b32 s62, 1646592
  buffer_load_dwordx2 v[174:175], v15, s[12:15], s62 offen
  s_mov_b32 s62, 1589248
  buffer_load_dwordx2 v[176:177], v15, s[12:15], s62 offen
  s_mov_b32 s62, 1597440
  buffer_load_dwordx2 v[178:179], v15, s[12:15], s62 offen
  s_mov_b32 s62, 1654784
  buffer_load_dwordx2 v[180:181], v15, s[12:15], s62 offen
  s_mov_b32 s62, 1662976
  buffer_load_dwordx2 v[182:183], v15, s[12:15], s62 offen
  s_mov_b32 s62, 1835008
  buffer_load_dwordx2 v[184:185], v15, s[12:15], s62 offen
  s_mov_b32 s62, 1843200
  buffer_load_dwordx2 v[186:187], v15, s[12:15], s62 offen
  s_mov_b32 s62, 1900544
  buffer_load_dwordx2 v[188:189], v15, s[12:15], s62 offen
  s_mov_b32 s62, 1908736
  buffer_load_dwordx2 v[190:191], v15, s[12:15], s62 offen
  s_mov_b32 s62, 1851392
  buffer_load_dwordx2 v[192:193], v15, s[12:15], s62 offen
  s_mov_b32 s62, 1859584
  buffer_load_dwordx2 v[194:195], v15, s[12:15], s62 offen
  s_mov_b32 s62, 1916928
  buffer_load_dwordx2 v[196:197], v15, s[12:15], s62 offen
  s_mov_b32 s62, 1925120
  buffer_load_dwordx2 v[198:199], v15, s[12:15], s62 offen
  s_waitcnt lgkmcnt(0)
  s_waitcnt vmcnt(46)
  v_perm_b32 v11, v106, v104, s56
  v_accvgpr_write_b32 a16, v11
  v_perm_b32 v11, v106, v104, s57
  v_accvgpr_write_b32 a24, v11
  v_perm_b32 v44, v107, v105, s56
  v_perm_b32 v11, v107, v105, s57
  v_accvgpr_write_b32 a32, v11
  s_waitcnt vmcnt(44)
  v_perm_b32 v11, v110, v108, s56
  v_accvgpr_write_b32 a17, v11
  v_perm_b32 v11, v110, v108, s57
  v_accvgpr_write_b32 a25, v11
  v_perm_b32 v45, v111, v109, s56
  v_perm_b32 v11, v111, v109, s57
  v_accvgpr_write_b32 a33, v11
  s_waitcnt vmcnt(42)
  v_perm_b32 v11, v114, v112, s56
  v_accvgpr_write_b32 a18, v11
  v_perm_b32 v11, v114, v112, s57
  v_accvgpr_write_b32 a26, v11
  v_perm_b32 v46, v115, v113, s56
  v_perm_b32 v11, v115, v113, s57
  v_accvgpr_write_b32 a34, v11
  s_waitcnt vmcnt(40)
  v_perm_b32 v11, v118, v116, s56
  v_accvgpr_write_b32 a19, v11
  v_perm_b32 v11, v118, v116, s57
  v_accvgpr_write_b32 a27, v11
  v_perm_b32 v47, v119, v117, s56
  v_perm_b32 v11, v119, v117, s57
  v_accvgpr_write_b32 a35, v11
  s_waitcnt vmcnt(38)
  v_perm_b32 v11, v122, v120, s56
  v_accvgpr_write_b32 a20, v11
  v_perm_b32 v11, v122, v120, s57
  v_accvgpr_write_b32 a28, v11
  v_perm_b32 v48, v123, v121, s56
  v_perm_b32 v11, v123, v121, s57
  v_accvgpr_write_b32 a36, v11
  s_waitcnt vmcnt(36)
  v_perm_b32 v11, v126, v124, s56
  v_accvgpr_write_b32 a21, v11
  v_perm_b32 v11, v126, v124, s57
  v_accvgpr_write_b32 a29, v11
  v_perm_b32 v49, v127, v125, s56
  v_perm_b32 v11, v127, v125, s57
  v_accvgpr_write_b32 a37, v11
  s_waitcnt vmcnt(34)
  v_perm_b32 v11, v130, v128, s56
  v_accvgpr_write_b32 a22, v11
  v_perm_b32 v11, v130, v128, s57
  v_accvgpr_write_b32 a30, v11
  v_perm_b32 v50, v131, v129, s56
  v_perm_b32 v11, v131, v129, s57
  v_accvgpr_write_b32 a38, v11
  s_waitcnt vmcnt(32)
  v_perm_b32 v11, v134, v132, s56
  v_accvgpr_write_b32 a23, v11
  v_perm_b32 v11, v134, v132, s57
  v_accvgpr_write_b32 a31, v11
  v_perm_b32 v51, v135, v133, s56
  v_perm_b32 v11, v135, v133, s57
  v_accvgpr_write_b32 a39, v11
  ds_write_b128 v2, v[44:47] offset:4096
  ds_write_b128 v2, v[48:51] offset:5120
  s_mov_b32 s62, 2097152
  buffer_load_dwordx2 v[72:73], v15, s[12:15], s62 offen
  s_mov_b32 s62, 2105344
  buffer_load_dwordx2 v[74:75], v15, s[12:15], s62 offen
  s_mov_b32 s62, 2162688
  buffer_load_dwordx2 v[76:77], v15, s[12:15], s62 offen
  s_mov_b32 s62, 2170880
  buffer_load_dwordx2 v[78:79], v15, s[12:15], s62 offen
  s_mov_b32 s62, 2113536
  buffer_load_dwordx2 v[80:81], v15, s[12:15], s62 offen
  s_mov_b32 s62, 2121728
  buffer_load_dwordx2 v[82:83], v15, s[12:15], s62 offen
  s_mov_b32 s62, 2179072
  buffer_load_dwordx2 v[84:85], v15, s[12:15], s62 offen
  s_mov_b32 s62, 2187264
  buffer_load_dwordx2 v[86:87], v15, s[12:15], s62 offen
  s_mov_b32 s62, 2359296
  buffer_load_dwordx2 v[88:89], v15, s[12:15], s62 offen
  s_mov_b32 s62, 2367488
  buffer_load_dwordx2 v[90:91], v15, s[12:15], s62 offen
  s_mov_b32 s62, 2424832
  buffer_load_dwordx2 v[92:93], v15, s[12:15], s62 offen
  s_mov_b32 s62, 2433024
  buffer_load_dwordx2 v[94:95], v15, s[12:15], s62 offen
  s_mov_b32 s62, 2375680
  buffer_load_dwordx2 v[96:97], v15, s[12:15], s62 offen
  s_mov_b32 s62, 2383872
  buffer_load_dwordx2 v[98:99], v15, s[12:15], s62 offen
  s_mov_b32 s62, 2441216
  buffer_load_dwordx2 v[100:101], v15, s[12:15], s62 offen
  s_mov_b32 s62, 2449408
  buffer_load_dwordx2 v[102:103], v15, s[12:15], s62 offen
  s_waitcnt lgkmcnt(0)
  s_waitcnt vmcnt(46)
  v_perm_b32 v11, v138, v136, s56
  v_accvgpr_write_b32 a40, v11
  v_perm_b32 v36, v138, v136, s57
  v_perm_b32 v11, v139, v137, s56
  v_accvgpr_write_b32 a48, v11
  v_perm_b32 v11, v139, v137, s57
  v_accvgpr_write_b32 a56, v11
  s_waitcnt vmcnt(44)
  v_perm_b32 v11, v142, v140, s56
  v_accvgpr_write_b32 a41, v11
  v_perm_b32 v37, v142, v140, s57
  v_perm_b32 v11, v143, v141, s56
  v_accvgpr_write_b32 a49, v11
  v_perm_b32 v11, v143, v141, s57
  v_accvgpr_write_b32 a57, v11
  s_waitcnt vmcnt(42)
  v_perm_b32 v11, v146, v144, s56
  v_accvgpr_write_b32 a42, v11
  v_perm_b32 v38, v146, v144, s57
  v_perm_b32 v11, v147, v145, s56
  v_accvgpr_write_b32 a50, v11
  v_perm_b32 v11, v147, v145, s57
  v_accvgpr_write_b32 a58, v11
  s_waitcnt vmcnt(40)
  v_perm_b32 v11, v150, v148, s56
  v_accvgpr_write_b32 a43, v11
  v_perm_b32 v39, v150, v148, s57
  v_perm_b32 v11, v151, v149, s56
  v_accvgpr_write_b32 a51, v11
  v_perm_b32 v11, v151, v149, s57
  v_accvgpr_write_b32 a59, v11
  s_waitcnt vmcnt(38)
  v_perm_b32 v11, v154, v152, s56
  v_accvgpr_write_b32 a44, v11
  v_perm_b32 v40, v154, v152, s57
  v_perm_b32 v11, v155, v153, s56
  v_accvgpr_write_b32 a52, v11
  v_perm_b32 v11, v155, v153, s57
  v_accvgpr_write_b32 a60, v11
  s_waitcnt vmcnt(36)
  v_perm_b32 v11, v158, v156, s56
  v_accvgpr_write_b32 a45, v11
  v_perm_b32 v41, v158, v156, s57
  v_perm_b32 v11, v159, v157, s56
  v_accvgpr_write_b32 a53, v11
  v_perm_b32 v11, v159, v157, s57
  v_accvgpr_write_b32 a61, v11
  s_waitcnt vmcnt(34)
  v_perm_b32 v11, v162, v160, s56
  v_accvgpr_write_b32 a46, v11
  v_perm_b32 v42, v162, v160, s57
  v_perm_b32 v11, v163, v161, s56
  v_accvgpr_write_b32 a54, v11
  v_perm_b32 v11, v163, v161, s57
  v_accvgpr_write_b32 a62, v11
  s_waitcnt vmcnt(32)
  v_perm_b32 v11, v166, v164, s56
  v_accvgpr_write_b32 a47, v11
  v_perm_b32 v43, v166, v164, s57
  v_perm_b32 v11, v167, v165, s56
  v_accvgpr_write_b32 a55, v11
  v_perm_b32 v11, v167, v165, s57
  v_accvgpr_write_b32 a63, v11
  ds_write_b128 v2, v[36:39] offset:6144
  ds_write_b128 v2, v[40:43] offset:7168
  s_mov_b32 s62, 2621440
  buffer_load_dwordx2 v[104:105], v15, s[12:15], s62 offen
  s_mov_b32 s62, 2629632
  buffer_load_dwordx2 v[106:107], v15, s[12:15], s62 offen
  s_mov_b32 s62, 2686976
  buffer_load_dwordx2 v[108:109], v15, s[12:15], s62 offen
  s_mov_b32 s62, 2695168
  buffer_load_dwordx2 v[110:111], v15, s[12:15], s62 offen
  s_mov_b32 s62, 2637824
  buffer_load_dwordx2 v[112:113], v15, s[12:15], s62 offen
  s_mov_b32 s62, 2646016
  buffer_load_dwordx2 v[114:115], v15, s[12:15], s62 offen
  s_mov_b32 s62, 2703360
  buffer_load_dwordx2 v[116:117], v15, s[12:15], s62 offen
  s_mov_b32 s62, 2711552
  buffer_load_dwordx2 v[118:119], v15, s[12:15], s62 offen
  s_mov_b32 s62, 2883584
  buffer_load_dwordx2 v[120:121], v15, s[12:15], s62 offen
  s_mov_b32 s62, 2891776
  buffer_load_dwordx2 v[122:123], v15, s[12:15], s62 offen
  s_mov_b32 s62, 2949120
  buffer_load_dwordx2 v[124:125], v15, s[12:15], s62 offen
  s_mov_b32 s62, 2957312
  buffer_load_dwordx2 v[126:127], v15, s[12:15], s62 offen
  s_mov_b32 s62, 2899968
  buffer_load_dwordx2 v[128:129], v15, s[12:15], s62 offen
  s_mov_b32 s62, 2908160
  buffer_load_dwordx2 v[130:131], v15, s[12:15], s62 offen
  s_mov_b32 s62, 2965504
  buffer_load_dwordx2 v[132:133], v15, s[12:15], s62 offen
  s_mov_b32 s62, 2973696
  buffer_load_dwordx2 v[134:135], v15, s[12:15], s62 offen
  s_waitcnt lgkmcnt(0)
  s_waitcnt vmcnt(46)
  v_perm_b32 v28, v170, v168, s56
  v_perm_b32 v11, v170, v168, s57
  v_accvgpr_write_b32 a64, v11
  v_perm_b32 v11, v171, v169, s56
  v_accvgpr_write_b32 a72, v11
  v_perm_b32 v52, v171, v169, s57
  s_waitcnt vmcnt(44)
  v_perm_b32 v29, v174, v172, s56
  v_perm_b32 v11, v174, v172, s57
  v_accvgpr_write_b32 a65, v11
  v_perm_b32 v11, v175, v173, s56
  v_accvgpr_write_b32 a73, v11
  v_perm_b32 v53, v175, v173, s57
  s_waitcnt vmcnt(42)
  v_perm_b32 v30, v178, v176, s56
  v_perm_b32 v11, v178, v176, s57
  v_accvgpr_write_b32 a66, v11
  v_perm_b32 v11, v179, v177, s56
  v_accvgpr_write_b32 a74, v11
  v_perm_b32 v54, v179, v177, s57
  s_waitcnt vmcnt(40)
  v_perm_b32 v31, v182, v180, s56
  v_perm_b32 v11, v182, v180, s57
  v_accvgpr_write_b32 a67, v11
  v_perm_b32 v11, v183, v181, s56
  v_accvgpr_write_b32 a75, v11
  v_perm_b32 v55, v183, v181, s57
  s_waitcnt vmcnt(38)
  v_perm_b32 v32, v186, v184, s56
  v_perm_b32 v11, v186, v184, s57
  v_accvgpr_write_b32 a68, v11
  v_perm_b32 v11, v187, v185, s56
  v_accvgpr_write_b32 a76, v11
  v_perm_b32 v56, v187, v185, s57
  s_waitcnt vmcnt(36)
  v_perm_b32 v33, v190, v188, s56
  v_perm_b32 v11, v190, v188, s57
  v_accvgpr_write_b32 a69, v11
  v_perm_b32 v11, v191, v189, s56
  v_accvgpr_write_b32 a77, v11
  v_perm_b32 v57, v191, v189, s57
  s_waitcnt vmcnt(34)
  v_perm_b32 v34, v194, v192, s56
  v_perm_b32 v11, v194, v192, s57
  v_accvgpr_write_b32 a70, v11
  v_perm_b32 v11, v195, v193, s56
  v_accvgpr_write_b32 a78, v11
  v_perm_b32 v58, v195, v193, s57
  s_waitcnt vmcnt(32)
  v_perm_b32 v35, v198, v196, s56
  v_perm_b32 v11, v198, v196, s57
  v_accvgpr_write_b32 a71, v11
  v_perm_b32 v11, v199, v197, s56
  v_accvgpr_write_b32 a79, v11
  v_perm_b32 v59, v199, v197, s57
  ds_write_b128 v2, v[28:31] offset:8192
  ds_write_b128 v2, v[32:35] offset:9216
  ds_write_b128 v2, v[52:55] offset:10240
  ds_write_b128 v2, v[56:59] offset:11264
  s_mov_b32 s62, 3145728
  buffer_load_dwordx2 v[136:137], v15, s[12:15], s62 offen
  s_mov_b32 s62, 3153920
  buffer_load_dwordx2 v[138:139], v15, s[12:15], s62 offen
  s_mov_b32 s62, 3211264
  buffer_load_dwordx2 v[140:141], v15, s[12:15], s62 offen
  s_mov_b32 s62, 3219456
  buffer_load_dwordx2 v[142:143], v15, s[12:15], s62 offen
  s_mov_b32 s62, 3162112
  buffer_load_dwordx2 v[144:145], v15, s[12:15], s62 offen
  s_mov_b32 s62, 3170304
  buffer_load_dwordx2 v[146:147], v15, s[12:15], s62 offen
  s_mov_b32 s62, 3227648
  buffer_load_dwordx2 v[148:149], v15, s[12:15], s62 offen
  s_mov_b32 s62, 3235840
  buffer_load_dwordx2 v[150:151], v15, s[12:15], s62 offen
  s_mov_b32 s62, 3407872
  buffer_load_dwordx2 v[152:153], v15, s[12:15], s62 offen
  s_mov_b32 s62, 3416064
  buffer_load_dwordx2 v[154:155], v15, s[12:15], s62 offen
  s_mov_b32 s62, 3473408
  buffer_load_dwordx2 v[156:157], v15, s[12:15], s62 offen
  s_mov_b32 s62, 3481600
  buffer_load_dwordx2 v[158:159], v15, s[12:15], s62 offen
  s_mov_b32 s62, 3424256
  buffer_load_dwordx2 v[160:161], v15, s[12:15], s62 offen
  s_mov_b32 s62, 3432448
  buffer_load_dwordx2 v[162:163], v15, s[12:15], s62 offen
  s_mov_b32 s62, 3489792
  buffer_load_dwordx2 v[164:165], v15, s[12:15], s62 offen
  s_mov_b32 s62, 3497984
  buffer_load_dwordx2 v[166:167], v15, s[12:15], s62 offen
  s_waitcnt lgkmcnt(0)
  s_waitcnt vmcnt(46)
  v_perm_b32 v11, v74, v72, s56
  v_accvgpr_write_b32 a80, v11
  v_perm_b32 v11, v74, v72, s57
  v_accvgpr_write_b32 a88, v11
  v_perm_b32 v44, v75, v73, s56
  v_perm_b32 v11, v75, v73, s57
  v_accvgpr_write_b32 a96, v11
  s_waitcnt vmcnt(44)
  v_perm_b32 v11, v78, v76, s56
  v_accvgpr_write_b32 a81, v11
  v_perm_b32 v11, v78, v76, s57
  v_accvgpr_write_b32 a89, v11
  v_perm_b32 v45, v79, v77, s56
  v_perm_b32 v11, v79, v77, s57
  v_accvgpr_write_b32 a97, v11
  s_waitcnt vmcnt(42)
  v_perm_b32 v11, v82, v80, s56
  v_accvgpr_write_b32 a82, v11
  v_perm_b32 v11, v82, v80, s57
  v_accvgpr_write_b32 a90, v11
  v_perm_b32 v46, v83, v81, s56
  v_perm_b32 v11, v83, v81, s57
  v_accvgpr_write_b32 a98, v11
  s_waitcnt vmcnt(40)
  v_perm_b32 v11, v86, v84, s56
  v_accvgpr_write_b32 a83, v11
  v_perm_b32 v11, v86, v84, s57
  v_accvgpr_write_b32 a91, v11
  v_perm_b32 v47, v87, v85, s56
  v_perm_b32 v11, v87, v85, s57
  v_accvgpr_write_b32 a99, v11
  s_waitcnt vmcnt(38)
  v_perm_b32 v11, v90, v88, s56
  v_accvgpr_write_b32 a84, v11
  v_perm_b32 v11, v90, v88, s57
  v_accvgpr_write_b32 a92, v11
  v_perm_b32 v48, v91, v89, s56
  v_perm_b32 v11, v91, v89, s57
  v_accvgpr_write_b32 a100, v11
  s_waitcnt vmcnt(36)
  v_perm_b32 v11, v94, v92, s56
  v_accvgpr_write_b32 a85, v11
  v_perm_b32 v11, v94, v92, s57
  v_accvgpr_write_b32 a93, v11
  v_perm_b32 v49, v95, v93, s56
  v_perm_b32 v11, v95, v93, s57
  v_accvgpr_write_b32 a101, v11
  s_waitcnt vmcnt(34)
  v_perm_b32 v11, v98, v96, s56
  v_accvgpr_write_b32 a86, v11
  v_perm_b32 v11, v98, v96, s57
  v_accvgpr_write_b32 a94, v11
  v_perm_b32 v50, v99, v97, s56
  v_perm_b32 v11, v99, v97, s57
  v_accvgpr_write_b32 a102, v11
  s_waitcnt vmcnt(32)
  v_perm_b32 v11, v102, v100, s56
  v_accvgpr_write_b32 a87, v11
  v_perm_b32 v11, v102, v100, s57
  v_accvgpr_write_b32 a95, v11
  v_perm_b32 v51, v103, v101, s56
  v_perm_b32 v11, v103, v101, s57
  v_accvgpr_write_b32 a103, v11
  ds_write_b128 v2, v[44:47] offset:12288
  ds_write_b128 v2, v[48:51] offset:13312
  s_mov_b32 s62, 3670016
  buffer_load_dwordx2 v[168:169], v15, s[12:15], s62 offen
  s_mov_b32 s62, 3678208
  buffer_load_dwordx2 v[170:171], v15, s[12:15], s62 offen
  s_mov_b32 s62, 3735552
  buffer_load_dwordx2 v[172:173], v15, s[12:15], s62 offen
  s_mov_b32 s62, 3743744
  buffer_load_dwordx2 v[174:175], v15, s[12:15], s62 offen
  s_mov_b32 s62, 3686400
  buffer_load_dwordx2 v[176:177], v15, s[12:15], s62 offen
  s_mov_b32 s62, 3694592
  buffer_load_dwordx2 v[178:179], v15, s[12:15], s62 offen
  s_mov_b32 s62, 3751936
  buffer_load_dwordx2 v[180:181], v15, s[12:15], s62 offen
  s_mov_b32 s62, 3760128
  buffer_load_dwordx2 v[182:183], v15, s[12:15], s62 offen
  s_mov_b32 s62, 3932160
  buffer_load_dwordx2 v[184:185], v15, s[12:15], s62 offen
  s_mov_b32 s62, 3940352
  buffer_load_dwordx2 v[186:187], v15, s[12:15], s62 offen
  s_mov_b32 s62, 3997696
  buffer_load_dwordx2 v[188:189], v15, s[12:15], s62 offen
  s_mov_b32 s62, 4005888
  buffer_load_dwordx2 v[190:191], v15, s[12:15], s62 offen
  s_mov_b32 s62, 3948544
  buffer_load_dwordx2 v[192:193], v15, s[12:15], s62 offen
  s_mov_b32 s62, 3956736
  buffer_load_dwordx2 v[194:195], v15, s[12:15], s62 offen
  s_mov_b32 s62, 4014080
  buffer_load_dwordx2 v[196:197], v15, s[12:15], s62 offen
  s_mov_b32 s62, 4022272
  buffer_load_dwordx2 v[198:199], v15, s[12:15], s62 offen
  s_waitcnt lgkmcnt(0)
  s_waitcnt vmcnt(46)
  v_perm_b32 v11, v106, v104, s56
  v_accvgpr_write_b32 a104, v11
  v_perm_b32 v36, v106, v104, s57
  v_perm_b32 v11, v107, v105, s56
  v_accvgpr_write_b32 a112, v11
  v_perm_b32 v11, v107, v105, s57
  v_accvgpr_write_b32 a120, v11
  s_waitcnt vmcnt(44)
  v_perm_b32 v11, v110, v108, s56
  v_accvgpr_write_b32 a105, v11
  v_perm_b32 v37, v110, v108, s57
  v_perm_b32 v11, v111, v109, s56
  v_accvgpr_write_b32 a113, v11
  v_perm_b32 v11, v111, v109, s57
  v_accvgpr_write_b32 a121, v11
  s_waitcnt vmcnt(42)
  v_perm_b32 v11, v114, v112, s56
  v_accvgpr_write_b32 a106, v11
  v_perm_b32 v38, v114, v112, s57
  v_perm_b32 v11, v115, v113, s56
  v_accvgpr_write_b32 a114, v11
  v_perm_b32 v11, v115, v113, s57
  v_accvgpr_write_b32 a122, v11
  s_waitcnt vmcnt(40)
  v_perm_b32 v11, v118, v116, s56
  v_accvgpr_write_b32 a107, v11
  v_perm_b32 v39, v118, v116, s57
  v_perm_b32 v11, v119, v117, s56
  v_accvgpr_write_b32 a115, v11
  v_perm_b32 v11, v119, v117, s57
  v_accvgpr_write_b32 a123, v11
  s_waitcnt vmcnt(38)
  v_perm_b32 v11, v122, v120, s56
  v_accvgpr_write_b32 a108, v11
  v_perm_b32 v40, v122, v120, s57
  v_perm_b32 v11, v123, v121, s56
  v_accvgpr_write_b32 a116, v11
  v_perm_b32 v11, v123, v121, s57
  v_accvgpr_write_b32 a124, v11
  s_waitcnt vmcnt(36)
  v_perm_b32 v11, v126, v124, s56
  v_accvgpr_write_b32 a109, v11
  v_perm_b32 v41, v126, v124, s57
  v_perm_b32 v11, v127, v125, s56
  v_accvgpr_write_b32 a117, v11
  v_perm_b32 v11, v127, v125, s57
  v_accvgpr_write_b32 a125, v11
  s_waitcnt vmcnt(34)
  v_perm_b32 v11, v130, v128, s56
  v_accvgpr_write_b32 a110, v11
  v_perm_b32 v42, v130, v128, s57
  v_perm_b32 v11, v131, v129, s56
  v_accvgpr_write_b32 a118, v11
  v_perm_b32 v11, v131, v129, s57
  v_accvgpr_write_b32 a126, v11
  s_waitcnt vmcnt(32)
  v_perm_b32 v11, v134, v132, s56
  v_accvgpr_write_b32 a111, v11
  v_perm_b32 v43, v134, v132, s57
  v_perm_b32 v11, v135, v133, s56
  v_accvgpr_write_b32 a119, v11
  v_perm_b32 v11, v135, v133, s57
  v_accvgpr_write_b32 a127, v11
  ds_write_b128 v2, v[36:39] offset:14336
  ds_write_b128 v2, v[40:43] offset:15360
  s_mov_b32 s62, 4194304
  buffer_load_dwordx2 v[72:73], v15, s[12:15], s62 offen
  s_mov_b32 s62, 4202496
  buffer_load_dwordx2 v[74:75], v15, s[12:15], s62 offen
  s_mov_b32 s62, 4259840
  buffer_load_dwordx2 v[76:77], v15, s[12:15], s62 offen
  s_mov_b32 s62, 4268032
  buffer_load_dwordx2 v[78:79], v15, s[12:15], s62 offen
  s_mov_b32 s62, 4210688
  buffer_load_dwordx2 v[80:81], v15, s[12:15], s62 offen
  s_mov_b32 s62, 4218880
  buffer_load_dwordx2 v[82:83], v15, s[12:15], s62 offen
  s_mov_b32 s62, 4276224
  buffer_load_dwordx2 v[84:85], v15, s[12:15], s62 offen
  s_mov_b32 s62, 4284416
  buffer_load_dwordx2 v[86:87], v15, s[12:15], s62 offen
  s_mov_b32 s62, 4456448
  buffer_load_dwordx2 v[88:89], v15, s[12:15], s62 offen
  s_mov_b32 s62, 4464640
  buffer_load_dwordx2 v[90:91], v15, s[12:15], s62 offen
  s_mov_b32 s62, 4521984
  buffer_load_dwordx2 v[92:93], v15, s[12:15], s62 offen
  s_mov_b32 s62, 4530176
  buffer_load_dwordx2 v[94:95], v15, s[12:15], s62 offen
  s_mov_b32 s62, 4472832
  buffer_load_dwordx2 v[96:97], v15, s[12:15], s62 offen
  s_mov_b32 s62, 4481024
  buffer_load_dwordx2 v[98:99], v15, s[12:15], s62 offen
  s_mov_b32 s62, 4538368
  buffer_load_dwordx2 v[100:101], v15, s[12:15], s62 offen
  s_mov_b32 s62, 4546560
  buffer_load_dwordx2 v[102:103], v15, s[12:15], s62 offen
  s_waitcnt lgkmcnt(0)
  s_waitcnt vmcnt(46)
  v_perm_b32 v28, v138, v136, s56
  v_perm_b32 v11, v138, v136, s57
  v_accvgpr_write_b32 a128, v11
  v_perm_b32 v11, v139, v137, s56
  v_accvgpr_write_b32 a136, v11
  v_perm_b32 v52, v139, v137, s57
  s_waitcnt vmcnt(44)
  v_perm_b32 v29, v142, v140, s56
  v_perm_b32 v11, v142, v140, s57
  v_accvgpr_write_b32 a129, v11
  v_perm_b32 v11, v143, v141, s56
  v_accvgpr_write_b32 a137, v11
  v_perm_b32 v53, v143, v141, s57
  s_waitcnt vmcnt(42)
  v_perm_b32 v30, v146, v144, s56
  v_perm_b32 v11, v146, v144, s57
  v_accvgpr_write_b32 a130, v11
  v_perm_b32 v11, v147, v145, s56
  v_accvgpr_write_b32 a138, v11
  v_perm_b32 v54, v147, v145, s57
  s_waitcnt vmcnt(40)
  v_perm_b32 v31, v150, v148, s56
  v_perm_b32 v11, v150, v148, s57
  v_accvgpr_write_b32 a131, v11
  v_perm_b32 v11, v151, v149, s56
  v_accvgpr_write_b32 a139, v11
  v_perm_b32 v55, v151, v149, s57
  s_waitcnt vmcnt(38)
  v_perm_b32 v32, v154, v152, s56
  v_perm_b32 v11, v154, v152, s57
  v_accvgpr_write_b32 a132, v11
  v_perm_b32 v11, v155, v153, s56
  v_accvgpr_write_b32 a140, v11
  v_perm_b32 v56, v155, v153, s57
  s_waitcnt vmcnt(36)
  v_perm_b32 v33, v158, v156, s56
  v_perm_b32 v11, v158, v156, s57
  v_accvgpr_write_b32 a133, v11
  v_perm_b32 v11, v159, v157, s56
  v_accvgpr_write_b32 a141, v11
  v_perm_b32 v57, v159, v157, s57
  s_waitcnt vmcnt(34)
  v_perm_b32 v34, v162, v160, s56
  v_perm_b32 v11, v162, v160, s57
  v_accvgpr_write_b32 a134, v11
  v_perm_b32 v11, v163, v161, s56
  v_accvgpr_write_b32 a142, v11
  v_perm_b32 v58, v163, v161, s57
  s_waitcnt vmcnt(32)
  v_perm_b32 v35, v166, v164, s56
  v_perm_b32 v11, v166, v164, s57
  v_accvgpr_write_b32 a135, v11
  v_perm_b32 v11, v167, v165, s56
  v_accvgpr_write_b32 a143, v11
  v_perm_b32 v59, v167, v165, s57
  ds_write_b128 v2, v[28:31] offset:16384
  ds_write_b128 v2, v[32:35] offset:17408
  ds_write_b128 v2, v[52:55] offset:18432
  ds_write_b128 v2, v[56:59] offset:19456
  s_waitcnt lgkmcnt(0)
  s_waitcnt vmcnt(30)
  v_perm_b32 v11, v170, v168, s56
  v_accvgpr_write_b32 a144, v11
  v_perm_b32 v11, v170, v168, s57
  v_accvgpr_write_b32 a152, v11
  v_perm_b32 v44, v171, v169, s56
  v_perm_b32 v11, v171, v169, s57
  v_accvgpr_write_b32 a160, v11
  s_waitcnt vmcnt(28)
  v_perm_b32 v11, v174, v172, s56
  v_accvgpr_write_b32 a145, v11
  v_perm_b32 v11, v174, v172, s57
  v_accvgpr_write_b32 a153, v11
  v_perm_b32 v45, v175, v173, s56
  v_perm_b32 v11, v175, v173, s57
  v_accvgpr_write_b32 a161, v11
  s_waitcnt vmcnt(26)
  v_perm_b32 v11, v178, v176, s56
  v_accvgpr_write_b32 a146, v11
  v_perm_b32 v11, v178, v176, s57
  v_accvgpr_write_b32 a154, v11
  v_perm_b32 v46, v179, v177, s56
  v_perm_b32 v11, v179, v177, s57
  v_accvgpr_write_b32 a162, v11
  s_waitcnt vmcnt(24)
  v_perm_b32 v11, v182, v180, s56
  v_accvgpr_write_b32 a147, v11
  v_perm_b32 v11, v182, v180, s57
  v_accvgpr_write_b32 a155, v11
  v_perm_b32 v47, v183, v181, s56
  v_perm_b32 v11, v183, v181, s57
  v_accvgpr_write_b32 a163, v11
  s_waitcnt vmcnt(22)
  v_perm_b32 v11, v186, v184, s56
  v_accvgpr_write_b32 a148, v11
  v_perm_b32 v11, v186, v184, s57
  v_accvgpr_write_b32 a156, v11
  v_perm_b32 v48, v187, v185, s56
  v_perm_b32 v11, v187, v185, s57
  v_accvgpr_write_b32 a164, v11
  s_waitcnt vmcnt(20)
  v_perm_b32 v11, v190, v188, s56
  v_accvgpr_write_b32 a149, v11
  v_perm_b32 v11, v190, v188, s57
  v_accvgpr_write_b32 a157, v11
  v_perm_b32 v49, v191, v189, s56
  v_perm_b32 v11, v191, v189, s57
  v_accvgpr_write_b32 a165, v11
  s_waitcnt vmcnt(18)
  v_perm_b32 v11, v194, v192, s56
  v_accvgpr_write_b32 a150, v11
  v_perm_b32 v11, v194, v192, s57
  v_accvgpr_write_b32 a158, v11
  v_perm_b32 v50, v195, v193, s56
  v_perm_b32 v11, v195, v193, s57
  v_accvgpr_write_b32 a166, v11
  s_waitcnt vmcnt(16)
  v_perm_b32 v11, v198, v196, s56
  v_accvgpr_write_b32 a151, v11
  v_perm_b32 v11, v198, v196, s57
  v_accvgpr_write_b32 a159, v11
  v_perm_b32 v51, v199, v197, s56
  v_perm_b32 v11, v199, v197, s57
  v_accvgpr_write_b32 a167, v11
  ds_write_b128 v2, v[44:47] offset:20480
  ds_write_b128 v2, v[48:51] offset:21504
  s_waitcnt lgkmcnt(0)
  s_waitcnt vmcnt(14)
  v_perm_b32 v11, v74, v72, s56
  v_accvgpr_write_b32 a168, v11
  v_perm_b32 v11, v74, v72, s57
  v_accvgpr_write_b32 a176, v11
  v_perm_b32 v11, v75, v73, s56
  v_accvgpr_write_b32 a184, v11
  v_perm_b32 v11, v75, v73, s57
  v_accvgpr_write_b32 a192, v11
  s_waitcnt vmcnt(12)
  v_perm_b32 v11, v78, v76, s56
  v_accvgpr_write_b32 a169, v11
  v_perm_b32 v11, v78, v76, s57
  v_accvgpr_write_b32 a177, v11
  v_perm_b32 v11, v79, v77, s56
  v_accvgpr_write_b32 a185, v11
  v_perm_b32 v11, v79, v77, s57
  v_accvgpr_write_b32 a193, v11
  s_waitcnt vmcnt(10)
  v_perm_b32 v11, v82, v80, s56
  v_accvgpr_write_b32 a170, v11
  v_perm_b32 v11, v82, v80, s57
  v_accvgpr_write_b32 a178, v11
  v_perm_b32 v11, v83, v81, s56
  v_accvgpr_write_b32 a186, v11
  v_perm_b32 v11, v83, v81, s57
  v_accvgpr_write_b32 a194, v11
  s_waitcnt vmcnt(8)
  v_perm_b32 v11, v86, v84, s56
  v_accvgpr_write_b32 a171, v11
  v_perm_b32 v11, v86, v84, s57
  v_accvgpr_write_b32 a179, v11
  v_perm_b32 v11, v87, v85, s56
  v_accvgpr_write_b32 a187, v11
  v_perm_b32 v11, v87, v85, s57
  v_accvgpr_write_b32 a195, v11
  s_waitcnt vmcnt(6)
  v_perm_b32 v11, v90, v88, s56
  v_accvgpr_write_b32 a172, v11
  v_perm_b32 v11, v90, v88, s57
  v_accvgpr_write_b32 a180, v11
  v_perm_b32 v11, v91, v89, s56
  v_accvgpr_write_b32 a188, v11
  v_perm_b32 v11, v91, v89, s57
  v_accvgpr_write_b32 a196, v11
  s_waitcnt vmcnt(4)
  v_perm_b32 v11, v94, v92, s56
  v_accvgpr_write_b32 a173, v11
  v_perm_b32 v11, v94, v92, s57
  v_accvgpr_write_b32 a181, v11
  v_perm_b32 v11, v95, v93, s56
  v_accvgpr_write_b32 a189, v11
  v_perm_b32 v11, v95, v93, s57
  v_accvgpr_write_b32 a197, v11
  s_waitcnt vmcnt(2)
  v_perm_b32 v11, v98, v96, s56
  v_accvgpr_write_b32 a174, v11
  v_perm_b32 v11, v98, v96, s57
  v_accvgpr_write_b32 a182, v11
  v_perm_b32 v11, v99, v97, s56
  v_accvgpr_write_b32 a190, v11
  v_perm_b32 v11, v99, v97, s57
  v_accvgpr_write_b32 a198, v11
  s_waitcnt vmcnt(0)
  v_perm_b32 v11, v102, v100, s56
  v_accvgpr_write_b32 a175, v11
  v_perm_b32 v11, v102, v100, s57
  v_accvgpr_write_b32 a183, v11
  v_perm_b32 v11, v103, v101, s56
  v_accvgpr_write_b32 a191, v11
  v_perm_b32 v11, v103, v101, s57
  v_accvgpr_write_b32 a199, v11
  s_waitcnt lgkmcnt(0)
  s_mov_b32 s12, s40
  s_mov_b32 s13, s41
  s_mov_b32 s14, 4718592
  s_mov_b32 s15, 0x00020000
  s_mul_i32 s61, s50, 147456
  s_lshl_b32 s60, s51, 8
  s_add_u32 s60, s60, s61
  v_mul_u32_u24 v15, 4608, v12
  v_mul_u32_u24 v16, 1152, v14
  v_lshl_add_u32 v15, v13, 4, v15
  v_add_u32 v15, s60, v15
  s_lshl_b32 s60, s51, 5
  s_add_u32 s60, s60, s61
  s_add_u32 s60, s60, 1024
  v_lshl_add_u32 v16, v13, 1, v16
  v_add_u32 v16, s60, v16
  s_mov_b32 s63, 0
  buffer_load_dwordx4 v[72:75], v15, s[12:15], s63 offen
  s_mov_b32 s62, 0
  buffer_load_ushort v20, v16, s[12:15], s62 offen
  s_mov_b32 s63, 1152
  buffer_load_dwordx4 v[76:79], v15, s[12:15], s63 offen
  s_mov_b32 s62, 1152
  buffer_load_ushort v21, v16, s[12:15], s62 offen
  s_mov_b32 s63, 2304
  buffer_load_dwordx4 v[80:83], v15, s[12:15], s63 offen
  s_mov_b32 s62, 9216
  buffer_load_ushort v22, v16, s[12:15], s62 offen
  s_mov_b32 s63, 3456
  buffer_load_dwordx4 v[84:87], v15, s[12:15], s63 offen
  s_mov_b32 s62, 10368
  buffer_load_ushort v23, v16, s[12:15], s62 offen
  s_mov_b32 s63, 18432
  buffer_load_dwordx4 v[88:91], v15, s[12:15], s63 offen
  s_mov_b32 s62, 2304
  buffer_load_ushort v24, v16, s[12:15], s62 offen
  s_mov_b32 s63, 19584
  buffer_load_dwordx4 v[92:95], v15, s[12:15], s63 offen
  s_mov_b32 s62, 3456
  buffer_load_ushort v25, v16, s[12:15], s62 offen
  s_mov_b32 s63, 20736
  buffer_load_dwordx4 v[96:99], v15, s[12:15], s63 offen
  s_mov_b32 s62, 11520
  buffer_load_ushort v26, v16, s[12:15], s62 offen
  s_mov_b32 s63, 21888
  buffer_load_dwordx4 v[100:103], v15, s[12:15], s63 offen
  s_mov_b32 s62, 12672
  buffer_load_ushort v27, v16, s[12:15], s62 offen
  s_mov_b32 s63, 36864
  buffer_load_dwordx4 v[104:107], v15, s[12:15], s63 offen
  s_mov_b32 s62, 36864
  buffer_load_ushort v28, v16, s[12:15], s62 offen
  s_mov_b32 s63, 38016
  buffer_load_dwordx4 v[108:111], v15, s[12:15], s63 offen
  s_mov_b32 s62, 38016
  buffer_load_ushort v29, v16, s[12:15], s62 offen
  s_mov_b32 s63, 39168
  buffer_load_dwordx4 v[112:115], v15, s[12:15], s63 offen
  s_mov_b32 s62, 46080
  buffer_load_ushort v30, v16, s[12:15], s62 offen
  s_mov_b32 s63, 40320
  buffer_load_dwordx4 v[116:119], v15, s[12:15], s63 offen
  s_mov_b32 s62, 47232
  buffer_load_ushort v31, v16, s[12:15], s62 offen
  s_mov_b32 s63, 55296
  buffer_load_dwordx4 v[120:123], v15, s[12:15], s63 offen
  s_mov_b32 s62, 39168
  buffer_load_ushort v32, v16, s[12:15], s62 offen
  s_mov_b32 s63, 56448
  buffer_load_dwordx4 v[124:127], v15, s[12:15], s63 offen
  s_mov_b32 s62, 40320
  buffer_load_ushort v33, v16, s[12:15], s62 offen
  s_mov_b32 s63, 57600
  buffer_load_dwordx4 v[128:131], v15, s[12:15], s63 offen
  s_mov_b32 s62, 48384
  buffer_load_ushort v34, v16, s[12:15], s62 offen
  s_mov_b32 s63, 58752
  buffer_load_dwordx4 v[132:135], v15, s[12:15], s63 offen
  s_mov_b32 s62, 49536
  buffer_load_ushort v35, v16, s[12:15], s62 offen
  s_mov_b32 s63, 73728
  buffer_load_dwordx4 v[136:139], v15, s[12:15], s63 offen
  s_mov_b32 s62, 73728
  buffer_load_ushort v36, v16, s[12:15], s62 offen
  s_mov_b32 s63, 74880
  buffer_load_dwordx4 v[140:143], v15, s[12:15], s63 offen
  s_mov_b32 s62, 74880
  buffer_load_ushort v37, v16, s[12:15], s62 offen
  s_mov_b32 s63, 76032
  buffer_load_dwordx4 v[144:147], v15, s[12:15], s63 offen
  s_mov_b32 s62, 82944
  buffer_load_ushort v38, v16, s[12:15], s62 offen
  s_mov_b32 s63, 77184
  buffer_load_dwordx4 v[148:151], v15, s[12:15], s63 offen
  s_mov_b32 s62, 84096
  buffer_load_ushort v39, v16, s[12:15], s62 offen
  s_mov_b32 s63, 92160
  buffer_load_dwordx4 v[152:155], v15, s[12:15], s63 offen
  s_mov_b32 s62, 76032
  buffer_load_ushort v40, v16, s[12:15], s62 offen
  s_mov_b32 s63, 93312
  buffer_load_dwordx4 v[156:159], v15, s[12:15], s63 offen
  s_mov_b32 s62, 77184
  buffer_load_ushort v41, v16, s[12:15], s62 offen
  s_mov_b32 s63, 94464
  buffer_load_dwordx4 v[160:163], v15, s[12:15], s63 offen
  s_mov_b32 s62, 85248
  buffer_load_ushort v42, v16, s[12:15], s62 offen
  s_mov_b32 s63, 95616
  buffer_load_dwordx4 v[164:167], v15, s[12:15], s63 offen
  s_mov_b32 s62, 86400
  buffer_load_ushort v43, v16, s[12:15], s62 offen
  s_mov_b32 s63, 110592
  buffer_load_dwordx4 v[168:171], v15, s[12:15], s63 offen
  s_mov_b32 s62, 110592
  buffer_load_ushort v44, v16, s[12:15], s62 offen
  s_mov_b32 s63, 111744
  buffer_load_dwordx4 v[172:175], v15, s[12:15], s63 offen
  s_mov_b32 s62, 111744
  buffer_load_ushort v45, v16, s[12:15], s62 offen
  s_mov_b32 s63, 112896
  buffer_load_dwordx4 v[176:179], v15, s[12:15], s63 offen
  s_mov_b32 s62, 119808
  buffer_load_ushort v46, v16, s[12:15], s62 offen
  s_mov_b32 s63, 114048
  buffer_load_dwordx4 v[180:183], v15, s[12:15], s63 offen
  s_mov_b32 s62, 120960
  buffer_load_ushort v47, v16, s[12:15], s62 offen
  s_mov_b32 s63, 129024
  buffer_load_dwordx4 v[184:187], v15, s[12:15], s63 offen
  s_mov_b32 s62, 112896
  buffer_load_ushort v48, v16, s[12:15], s62 offen
  s_mov_b32 s63, 130176
  buffer_load_dwordx4 v[188:191], v15, s[12:15], s63 offen
  s_mov_b32 s62, 114048
  buffer_load_ushort v49, v16, s[12:15], s62 offen
  s_mov_b32 s63, 131328
  buffer_load_dwordx4 v[192:195], v15, s[12:15], s63 offen
  s_mov_b32 s62, 122112
  buffer_load_ushort v50, v16, s[12:15], s62 offen
  s_mov_b32 s63, 132480
  buffer_load_dwordx4 v[196:199], v15, s[12:15], s63 offen
  s_mov_b32 s62, 123264
  buffer_load_ushort v51, v16, s[12:15], s62 offen
  s_waitcnt vmcnt(61)
  v_perm_b32 v11, v76, v72, s56
  v_accvgpr_write_b32 a200, v11
  v_perm_b32 v11, v76, v72, s57
  v_accvgpr_write_b32 a201, v11
  s_waitcnt vmcnt(57)
  v_perm_b32 v11, v84, v80, s56
  v_accvgpr_write_b32 a202, v11
  v_perm_b32 v11, v84, v80, s57
  v_accvgpr_write_b32 a203, v11
  s_waitcnt vmcnt(53)
  v_perm_b32 v11, v92, v88, s56
  v_accvgpr_write_b32 a204, v11
  v_perm_b32 v11, v92, v88, s57
  v_accvgpr_write_b32 a205, v11
  s_waitcnt vmcnt(49)
  v_perm_b32 v11, v100, v96, s56
  v_accvgpr_write_b32 a206, v11
  v_perm_b32 v11, v100, v96, s57
  v_accvgpr_write_b32 a207, v11
  s_waitcnt lgkmcnt(0)
  s_waitcnt vmcnt(29)
  v_perm_b32 v11, v140, v136, s56
  v_accvgpr_write_b32 a216, v11
  v_perm_b32 v11, v140, v136, s57
  v_accvgpr_write_b32 a217, v11
  s_waitcnt vmcnt(25)
  v_perm_b32 v11, v148, v144, s56
  v_accvgpr_write_b32 a218, v11
  v_perm_b32 v11, v148, v144, s57
  v_accvgpr_write_b32 a219, v11
  s_waitcnt vmcnt(21)
  v_perm_b32 v11, v156, v152, s56
  v_accvgpr_write_b32 a220, v11
  v_perm_b32 v11, v156, v152, s57
  v_accvgpr_write_b32 a221, v11
  s_waitcnt vmcnt(17)
  v_perm_b32 v11, v164, v160, s56
  v_accvgpr_write_b32 a222, v11
  v_perm_b32 v11, v164, v160, s57
  v_accvgpr_write_b32 a223, v11
  s_waitcnt lgkmcnt(0)
  v_perm_b32 v11, v77, v73, s56
  v_accvgpr_write_b32 a232, v11
  v_perm_b32 v11, v77, v73, s57
  v_accvgpr_write_b32 a233, v11
  v_perm_b32 v11, v85, v81, s56
  v_accvgpr_write_b32 a234, v11
  v_perm_b32 v11, v85, v81, s57
  v_accvgpr_write_b32 a235, v11
  v_perm_b32 v11, v93, v89, s56
  v_accvgpr_write_b32 a236, v11
  v_perm_b32 v11, v93, v89, s57
  v_accvgpr_write_b32 a237, v11
  v_perm_b32 v11, v101, v97, s56
  v_accvgpr_write_b32 a238, v11
  v_perm_b32 v11, v101, v97, s57
  v_accvgpr_write_b32 a239, v11
  s_waitcnt lgkmcnt(0)
  v_perm_b32 v56, v141, v137, s56
  v_perm_b32 v57, v141, v137, s57
  v_perm_b32 v58, v149, v145, s56
  v_perm_b32 v59, v149, v145, s57
  v_perm_b32 v60, v157, v153, s56
  v_perm_b32 v61, v157, v153, s57
  v_perm_b32 v62, v165, v161, s56
  v_perm_b32 v63, v165, v161, s57
  ds_write_b128 v2, v[56:59] offset:22528
  ds_write_b128 v2, v[60:63] offset:23552
  s_waitcnt lgkmcnt(0)
  v_perm_b32 v11, v78, v74, s56
  v_accvgpr_write_b32 a248, v11
  v_perm_b32 v11, v78, v74, s57
  v_accvgpr_write_b32 a249, v11
  v_perm_b32 v11, v86, v82, s56
  v_accvgpr_write_b32 a250, v11
  v_perm_b32 v11, v86, v82, s57
  v_accvgpr_write_b32 a251, v11
  v_perm_b32 v11, v94, v90, s56
  v_accvgpr_write_b32 a252, v11
  v_perm_b32 v11, v94, v90, s57
  v_accvgpr_write_b32 a253, v11
  v_perm_b32 v11, v102, v98, s56
  v_accvgpr_write_b32 a254, v11
  v_perm_b32 v11, v102, v98, s57
  v_accvgpr_write_b32 a255, v11
  s_waitcnt lgkmcnt(0)
  v_perm_b32 v224, v142, v138, s56
  v_perm_b32 v225, v142, v138, s57
  v_perm_b32 v226, v150, v146, s56
  v_perm_b32 v227, v150, v146, s57
  v_perm_b32 v228, v158, v154, s56
  v_perm_b32 v229, v158, v154, s57
  v_perm_b32 v230, v166, v162, s56
  v_perm_b32 v231, v166, v162, s57
  s_waitcnt lgkmcnt(0)
  v_perm_b32 v240, v79, v75, s56
  v_perm_b32 v241, v79, v75, s57
  v_perm_b32 v242, v87, v83, s56
  v_perm_b32 v243, v87, v83, s57
  v_perm_b32 v244, v95, v91, s56
  v_perm_b32 v245, v95, v91, s57
  v_perm_b32 v246, v103, v99, s56
  v_perm_b32 v247, v103, v99, s57
  s_waitcnt lgkmcnt(0)
  v_perm_b32 v56, v143, v139, s56
  v_perm_b32 v57, v143, v139, s57
  v_perm_b32 v58, v151, v147, s56
  v_perm_b32 v59, v151, v147, s57
  v_perm_b32 v60, v159, v155, s56
  v_perm_b32 v61, v159, v155, s57
  v_perm_b32 v62, v167, v163, s56
  v_perm_b32 v63, v167, v163, s57
  ds_write_b128 v2, v[56:59] offset:26624
  ds_write_b128 v2, v[60:63] offset:27648
  s_waitcnt lgkmcnt(0)
  v_perm_b32 v56, v21, v20, s56
  v_perm_b32 v57, v23, v22, s56
  v_perm_b32 v58, v25, v24, s56
  v_perm_b32 v59, v27, v26, s56
  v_perm_b32 v60, v29, v28, s56
  v_perm_b32 v61, v31, v30, s56
  v_perm_b32 v62, v33, v32, s56
  v_perm_b32 v63, v35, v34, s56
  ds_write_b128 v2, v[56:59] offset:30720
  ds_write_b128 v2, v[60:63] offset:31744
  s_waitcnt lgkmcnt(0)
  v_perm_b32 v11, v108, v104, s56
  v_accvgpr_write_b32 a208, v11
  v_perm_b32 v11, v108, v104, s57
  v_accvgpr_write_b32 a209, v11
  v_perm_b32 v11, v116, v112, s56
  v_accvgpr_write_b32 a210, v11
  v_perm_b32 v11, v116, v112, s57
  v_accvgpr_write_b32 a211, v11
  v_perm_b32 v11, v124, v120, s56
  v_accvgpr_write_b32 a212, v11
  v_perm_b32 v11, v124, v120, s57
  v_accvgpr_write_b32 a213, v11
  v_perm_b32 v11, v132, v128, s56
  v_accvgpr_write_b32 a214, v11
  v_perm_b32 v11, v132, v128, s57
  v_accvgpr_write_b32 a215, v11
  s_waitcnt lgkmcnt(0)
  s_waitcnt vmcnt(13)
  v_perm_b32 v11, v172, v168, s56
  v_accvgpr_write_b32 a224, v11
  v_perm_b32 v11, v172, v168, s57
  v_accvgpr_write_b32 a225, v11
  s_waitcnt vmcnt(9)
  v_perm_b32 v11, v180, v176, s56
  v_accvgpr_write_b32 a226, v11
  v_perm_b32 v11, v180, v176, s57
  v_accvgpr_write_b32 a227, v11
  s_waitcnt vmcnt(5)
  v_perm_b32 v11, v188, v184, s56
  v_accvgpr_write_b32 a228, v11
  v_perm_b32 v11, v188, v184, s57
  v_accvgpr_write_b32 a229, v11
  s_waitcnt vmcnt(1)
  v_perm_b32 v11, v196, v192, s56
  v_accvgpr_write_b32 a230, v11
  v_perm_b32 v11, v196, v192, s57
  v_accvgpr_write_b32 a231, v11
  s_waitcnt lgkmcnt(0)
  v_perm_b32 v11, v109, v105, s56
  v_accvgpr_write_b32 a240, v11
  v_perm_b32 v11, v109, v105, s57
  v_accvgpr_write_b32 a241, v11
  v_perm_b32 v11, v117, v113, s56
  v_accvgpr_write_b32 a242, v11
  v_perm_b32 v11, v117, v113, s57
  v_accvgpr_write_b32 a243, v11
  v_perm_b32 v11, v125, v121, s56
  v_accvgpr_write_b32 a244, v11
  v_perm_b32 v11, v125, v121, s57
  v_accvgpr_write_b32 a245, v11
  v_perm_b32 v11, v133, v129, s56
  v_accvgpr_write_b32 a246, v11
  v_perm_b32 v11, v133, v129, s57
  v_accvgpr_write_b32 a247, v11
  s_waitcnt lgkmcnt(0)
  v_perm_b32 v56, v173, v169, s56
  v_perm_b32 v57, v173, v169, s57
  v_perm_b32 v58, v181, v177, s56
  v_perm_b32 v59, v181, v177, s57
  v_perm_b32 v60, v189, v185, s56
  v_perm_b32 v61, v189, v185, s57
  v_perm_b32 v62, v197, v193, s56
  v_perm_b32 v63, v197, v193, s57
  ds_write_b128 v2, v[56:59] offset:24576
  ds_write_b128 v2, v[60:63] offset:25600
  s_waitcnt lgkmcnt(0)
  v_perm_b32 v216, v110, v106, s56
  v_perm_b32 v217, v110, v106, s57
  v_perm_b32 v218, v118, v114, s56
  v_perm_b32 v219, v118, v114, s57
  v_perm_b32 v220, v126, v122, s56
  v_perm_b32 v221, v126, v122, s57
  v_perm_b32 v222, v134, v130, s56
  v_perm_b32 v223, v134, v130, s57
  s_waitcnt lgkmcnt(0)
  v_perm_b32 v232, v174, v170, s56
  v_perm_b32 v233, v174, v170, s57
  v_perm_b32 v234, v182, v178, s56
  v_perm_b32 v235, v182, v178, s57
  v_perm_b32 v236, v190, v186, s56
  v_perm_b32 v237, v190, v186, s57
  v_perm_b32 v238, v198, v194, s56
  v_perm_b32 v239, v198, v194, s57
  s_waitcnt lgkmcnt(0)
  v_perm_b32 v248, v111, v107, s56
  v_perm_b32 v249, v111, v107, s57
  v_perm_b32 v250, v119, v115, s56
  v_perm_b32 v251, v119, v115, s57
  v_perm_b32 v252, v127, v123, s56
  v_perm_b32 v253, v127, v123, s57
  v_perm_b32 v254, v135, v131, s56
  v_perm_b32 v255, v135, v131, s57
  s_waitcnt lgkmcnt(0)
  v_perm_b32 v56, v175, v171, s56
  v_perm_b32 v57, v175, v171, s57
  v_perm_b32 v58, v183, v179, s56
  v_perm_b32 v59, v183, v179, s57
  v_perm_b32 v60, v191, v187, s56
  v_perm_b32 v61, v191, v187, s57
  v_perm_b32 v62, v199, v195, s56
  v_perm_b32 v63, v199, v195, s57
  ds_write_b128 v2, v[56:59] offset:28672
  ds_write_b128 v2, v[60:63] offset:29696
  s_waitcnt lgkmcnt(0)
  v_perm_b32 v56, v37, v36, s56
  v_perm_b32 v57, v39, v38, s56
  v_perm_b32 v58, v41, v40, s56
  v_perm_b32 v59, v43, v42, s56
  v_perm_b32 v60, v45, v44, s56
  v_perm_b32 v61, v47, v46, s56
  v_perm_b32 v62, v49, v48, s56
  s_waitcnt vmcnt(0)
  v_perm_b32 v63, v51, v50, s56
  ds_write_b128 v2, v[56:59] offset:32768
  ds_write_b128 v2, v[60:63] offset:33792
  s_waitcnt lgkmcnt(0)
  s_mov_b32 s12, s38
  s_mov_b32 s13, s39
  s_mov_b32 s14, 4718592
  s_mov_b32 s15, 0x00020000
  s_lshl_b32 s60, s51, 6
  s_lshl_b32 s61, s50, 8
  s_add_u32 s60, s60, s61
  v_lshlrev_b32 v15, 13, v14
  v_lshl_add_u32 v15, v13, 2, v15
  v_add_u32 v15, s60, v15
  s_mov_b32 s62, 0
  buffer_load_dword v72, v15, s[12:15], s62 offen
  s_mov_b32 s62, 8192
  buffer_load_dword v80, v15, s[12:15], s62 offen
  s_mov_b32 s62, 65536
  buffer_load_dword v73, v15, s[12:15], s62 offen
  s_mov_b32 s62, 73728
  buffer_load_dword v81, v15, s[12:15], s62 offen
  s_mov_b32 s62, 16384
  buffer_load_dword v74, v15, s[12:15], s62 offen
  s_mov_b32 s62, 24576
  buffer_load_dword v82, v15, s[12:15], s62 offen
  s_mov_b32 s62, 81920
  buffer_load_dword v75, v15, s[12:15], s62 offen
  s_mov_b32 s62, 90112
  buffer_load_dword v83, v15, s[12:15], s62 offen
  s_mov_b32 s62, 262144
  buffer_load_dword v76, v15, s[12:15], s62 offen
  s_mov_b32 s62, 270336
  buffer_load_dword v84, v15, s[12:15], s62 offen
  s_mov_b32 s62, 327680
  buffer_load_dword v77, v15, s[12:15], s62 offen
  s_mov_b32 s62, 335872
  buffer_load_dword v85, v15, s[12:15], s62 offen
  s_mov_b32 s62, 278528
  buffer_load_dword v78, v15, s[12:15], s62 offen
  s_mov_b32 s62, 286720
  buffer_load_dword v86, v15, s[12:15], s62 offen
  s_mov_b32 s62, 344064
  buffer_load_dword v79, v15, s[12:15], s62 offen
  s_mov_b32 s62, 352256
  buffer_load_dword v87, v15, s[12:15], s62 offen
  s_mov_b32 s62, 524288
  buffer_load_dword v88, v15, s[12:15], s62 offen
  s_mov_b32 s62, 532480
  buffer_load_dword v96, v15, s[12:15], s62 offen
  s_mov_b32 s62, 589824
  buffer_load_dword v89, v15, s[12:15], s62 offen
  s_mov_b32 s62, 598016
  buffer_load_dword v97, v15, s[12:15], s62 offen
  s_mov_b32 s62, 540672
  buffer_load_dword v90, v15, s[12:15], s62 offen
  s_mov_b32 s62, 548864
  buffer_load_dword v98, v15, s[12:15], s62 offen
  s_mov_b32 s62, 606208
  buffer_load_dword v91, v15, s[12:15], s62 offen
  s_mov_b32 s62, 614400
  buffer_load_dword v99, v15, s[12:15], s62 offen
  s_mov_b32 s62, 786432
  buffer_load_dword v92, v15, s[12:15], s62 offen
  s_mov_b32 s62, 794624
  buffer_load_dword v100, v15, s[12:15], s62 offen
  s_mov_b32 s62, 851968
  buffer_load_dword v93, v15, s[12:15], s62 offen
  s_mov_b32 s62, 860160
  buffer_load_dword v101, v15, s[12:15], s62 offen
  s_mov_b32 s62, 802816
  buffer_load_dword v94, v15, s[12:15], s62 offen
  s_mov_b32 s62, 811008
  buffer_load_dword v102, v15, s[12:15], s62 offen
  s_mov_b32 s62, 868352
  buffer_load_dword v95, v15, s[12:15], s62 offen
  s_mov_b32 s62, 876544
  buffer_load_dword v103, v15, s[12:15], s62 offen
  s_mov_b32 s62, 1048576
  buffer_load_dword v104, v15, s[12:15], s62 offen
  s_mov_b32 s62, 1056768
  buffer_load_dword v112, v15, s[12:15], s62 offen
  s_mov_b32 s62, 1114112
  buffer_load_dword v105, v15, s[12:15], s62 offen
  s_mov_b32 s62, 1122304
  buffer_load_dword v113, v15, s[12:15], s62 offen
  s_mov_b32 s62, 1064960
  buffer_load_dword v106, v15, s[12:15], s62 offen
  s_mov_b32 s62, 1073152
  buffer_load_dword v114, v15, s[12:15], s62 offen
  s_mov_b32 s62, 1130496
  buffer_load_dword v107, v15, s[12:15], s62 offen
  s_mov_b32 s62, 1138688
  buffer_load_dword v115, v15, s[12:15], s62 offen
  s_mov_b32 s62, 1310720
  buffer_load_dword v108, v15, s[12:15], s62 offen
  s_mov_b32 s62, 1318912
  buffer_load_dword v116, v15, s[12:15], s62 offen
  s_mov_b32 s62, 1376256
  buffer_load_dword v109, v15, s[12:15], s62 offen
  s_mov_b32 s62, 1384448
  buffer_load_dword v117, v15, s[12:15], s62 offen
  s_mov_b32 s62, 1327104
  buffer_load_dword v110, v15, s[12:15], s62 offen
  s_mov_b32 s62, 1335296
  buffer_load_dword v118, v15, s[12:15], s62 offen
  s_mov_b32 s62, 1392640
  buffer_load_dword v111, v15, s[12:15], s62 offen
  s_mov_b32 s62, 1400832
  buffer_load_dword v119, v15, s[12:15], s62 offen
  s_waitcnt vmcnt(46)
  v_perm_b32 v11, v80, v72, s56
  v_perm_b32 v80, v80, v72, s57
  v_mov_b32 v72, v11
  s_waitcnt vmcnt(44)
  v_perm_b32 v11, v81, v73, s56
  v_perm_b32 v81, v81, v73, s57
  v_mov_b32 v73, v11
  s_waitcnt vmcnt(42)
  v_perm_b32 v11, v82, v74, s56
  v_perm_b32 v82, v82, v74, s57
  v_mov_b32 v74, v11
  s_waitcnt vmcnt(40)
  v_perm_b32 v11, v83, v75, s56
  v_perm_b32 v83, v83, v75, s57
  v_mov_b32 v75, v11
  s_waitcnt vmcnt(38)
  v_perm_b32 v11, v84, v76, s56
  v_perm_b32 v84, v84, v76, s57
  v_mov_b32 v76, v11
  s_waitcnt vmcnt(36)
  v_perm_b32 v11, v85, v77, s56
  v_perm_b32 v85, v85, v77, s57
  v_mov_b32 v77, v11
  s_waitcnt vmcnt(34)
  v_perm_b32 v11, v86, v78, s56
  v_perm_b32 v86, v86, v78, s57
  v_mov_b32 v78, v11
  s_waitcnt vmcnt(32)
  v_perm_b32 v11, v87, v79, s56
  v_perm_b32 v87, v87, v79, s57
  v_mov_b32 v79, v11
  s_mov_b32 s62, 1572864
  buffer_load_dword v120, v15, s[12:15], s62 offen
  s_mov_b32 s62, 1581056
  buffer_load_dword v128, v15, s[12:15], s62 offen
  s_mov_b32 s62, 1638400
  buffer_load_dword v121, v15, s[12:15], s62 offen
  s_mov_b32 s62, 1646592
  buffer_load_dword v129, v15, s[12:15], s62 offen
  s_mov_b32 s62, 1589248
  buffer_load_dword v122, v15, s[12:15], s62 offen
  s_mov_b32 s62, 1597440
  buffer_load_dword v130, v15, s[12:15], s62 offen
  s_mov_b32 s62, 1654784
  buffer_load_dword v123, v15, s[12:15], s62 offen
  s_mov_b32 s62, 1662976
  buffer_load_dword v131, v15, s[12:15], s62 offen
  s_mov_b32 s62, 1835008
  buffer_load_dword v124, v15, s[12:15], s62 offen
  s_mov_b32 s62, 1843200
  buffer_load_dword v132, v15, s[12:15], s62 offen
  s_mov_b32 s62, 1900544
  buffer_load_dword v125, v15, s[12:15], s62 offen
  s_mov_b32 s62, 1908736
  buffer_load_dword v133, v15, s[12:15], s62 offen
  s_mov_b32 s62, 1851392
  buffer_load_dword v126, v15, s[12:15], s62 offen
  s_mov_b32 s62, 1859584
  buffer_load_dword v134, v15, s[12:15], s62 offen
  s_mov_b32 s62, 1916928
  buffer_load_dword v127, v15, s[12:15], s62 offen
  s_mov_b32 s62, 1925120
  buffer_load_dword v135, v15, s[12:15], s62 offen
  s_waitcnt vmcnt(46)
  v_perm_b32 v11, v96, v88, s56
  v_perm_b32 v96, v96, v88, s57
  v_mov_b32 v88, v11
  s_waitcnt vmcnt(44)
  v_perm_b32 v11, v97, v89, s56
  v_perm_b32 v97, v97, v89, s57
  v_mov_b32 v89, v11
  s_waitcnt vmcnt(42)
  v_perm_b32 v11, v98, v90, s56
  v_perm_b32 v98, v98, v90, s57
  v_mov_b32 v90, v11
  s_waitcnt vmcnt(40)
  v_perm_b32 v11, v99, v91, s56
  v_perm_b32 v99, v99, v91, s57
  v_mov_b32 v91, v11
  s_waitcnt vmcnt(38)
  v_perm_b32 v11, v100, v92, s56
  v_perm_b32 v100, v100, v92, s57
  v_mov_b32 v92, v11
  s_waitcnt vmcnt(36)
  v_perm_b32 v11, v101, v93, s56
  v_perm_b32 v101, v101, v93, s57
  v_mov_b32 v93, v11
  s_waitcnt vmcnt(34)
  v_perm_b32 v11, v102, v94, s56
  v_perm_b32 v102, v102, v94, s57
  v_mov_b32 v94, v11
  s_waitcnt vmcnt(32)
  v_perm_b32 v11, v103, v95, s56
  v_perm_b32 v103, v103, v95, s57
  v_mov_b32 v95, v11
  s_mov_b32 s62, 2097152
  buffer_load_dword v136, v15, s[12:15], s62 offen
  s_mov_b32 s62, 2105344
  buffer_load_dword v144, v15, s[12:15], s62 offen
  s_mov_b32 s62, 2162688
  buffer_load_dword v137, v15, s[12:15], s62 offen
  s_mov_b32 s62, 2170880
  buffer_load_dword v145, v15, s[12:15], s62 offen
  s_mov_b32 s62, 2113536
  buffer_load_dword v138, v15, s[12:15], s62 offen
  s_mov_b32 s62, 2121728
  buffer_load_dword v146, v15, s[12:15], s62 offen
  s_mov_b32 s62, 2179072
  buffer_load_dword v139, v15, s[12:15], s62 offen
  s_mov_b32 s62, 2187264
  buffer_load_dword v147, v15, s[12:15], s62 offen
  s_mov_b32 s62, 2359296
  buffer_load_dword v140, v15, s[12:15], s62 offen
  s_mov_b32 s62, 2367488
  buffer_load_dword v148, v15, s[12:15], s62 offen
  s_mov_b32 s62, 2424832
  buffer_load_dword v141, v15, s[12:15], s62 offen
  s_mov_b32 s62, 2433024
  buffer_load_dword v149, v15, s[12:15], s62 offen
  s_mov_b32 s62, 2375680
  buffer_load_dword v142, v15, s[12:15], s62 offen
  s_mov_b32 s62, 2383872
  buffer_load_dword v150, v15, s[12:15], s62 offen
  s_mov_b32 s62, 2441216
  buffer_load_dword v143, v15, s[12:15], s62 offen
  s_mov_b32 s62, 2449408
  buffer_load_dword v151, v15, s[12:15], s62 offen
  s_waitcnt vmcnt(46)
  v_perm_b32 v11, v112, v104, s56
  v_perm_b32 v112, v112, v104, s57
  v_mov_b32 v104, v11
  s_waitcnt vmcnt(44)
  v_perm_b32 v11, v113, v105, s56
  v_perm_b32 v113, v113, v105, s57
  v_mov_b32 v105, v11
  s_waitcnt vmcnt(42)
  v_perm_b32 v11, v114, v106, s56
  v_perm_b32 v114, v114, v106, s57
  v_mov_b32 v106, v11
  s_waitcnt vmcnt(40)
  v_perm_b32 v11, v115, v107, s56
  v_perm_b32 v115, v115, v107, s57
  v_mov_b32 v107, v11
  s_waitcnt vmcnt(38)
  v_perm_b32 v11, v116, v108, s56
  v_perm_b32 v116, v116, v108, s57
  v_mov_b32 v108, v11
  s_waitcnt vmcnt(36)
  v_perm_b32 v11, v117, v109, s56
  v_perm_b32 v117, v117, v109, s57
  v_mov_b32 v109, v11
  s_waitcnt vmcnt(34)
  v_perm_b32 v11, v118, v110, s56
  v_perm_b32 v118, v118, v110, s57
  v_mov_b32 v110, v11
  s_waitcnt vmcnt(32)
  v_perm_b32 v11, v119, v111, s56
  v_perm_b32 v119, v119, v111, s57
  v_mov_b32 v111, v11
  s_mov_b32 s62, 2621440
  buffer_load_dword v152, v15, s[12:15], s62 offen
  s_mov_b32 s62, 2629632
  buffer_load_dword v160, v15, s[12:15], s62 offen
  s_mov_b32 s62, 2686976
  buffer_load_dword v153, v15, s[12:15], s62 offen
  s_mov_b32 s62, 2695168
  buffer_load_dword v161, v15, s[12:15], s62 offen
  s_mov_b32 s62, 2637824
  buffer_load_dword v154, v15, s[12:15], s62 offen
  s_mov_b32 s62, 2646016
  buffer_load_dword v162, v15, s[12:15], s62 offen
  s_mov_b32 s62, 2703360
  buffer_load_dword v155, v15, s[12:15], s62 offen
  s_mov_b32 s62, 2711552
  buffer_load_dword v163, v15, s[12:15], s62 offen
  s_mov_b32 s62, 2883584
  buffer_load_dword v156, v15, s[12:15], s62 offen
  s_mov_b32 s62, 2891776
  buffer_load_dword v164, v15, s[12:15], s62 offen
  s_mov_b32 s62, 2949120
  buffer_load_dword v157, v15, s[12:15], s62 offen
  s_mov_b32 s62, 2957312
  buffer_load_dword v165, v15, s[12:15], s62 offen
  s_mov_b32 s62, 2899968
  buffer_load_dword v158, v15, s[12:15], s62 offen
  s_mov_b32 s62, 2908160
  buffer_load_dword v166, v15, s[12:15], s62 offen
  s_mov_b32 s62, 2965504
  buffer_load_dword v159, v15, s[12:15], s62 offen
  s_mov_b32 s62, 2973696
  buffer_load_dword v167, v15, s[12:15], s62 offen
  s_waitcnt vmcnt(46)
  v_perm_b32 v11, v128, v120, s56
  v_perm_b32 v128, v128, v120, s57
  v_mov_b32 v120, v11
  s_waitcnt vmcnt(44)
  v_perm_b32 v11, v129, v121, s56
  v_perm_b32 v129, v129, v121, s57
  v_mov_b32 v121, v11
  s_waitcnt vmcnt(42)
  v_perm_b32 v11, v130, v122, s56
  v_perm_b32 v130, v130, v122, s57
  v_mov_b32 v122, v11
  s_waitcnt vmcnt(40)
  v_perm_b32 v11, v131, v123, s56
  v_perm_b32 v131, v131, v123, s57
  v_mov_b32 v123, v11
  s_waitcnt vmcnt(38)
  v_perm_b32 v11, v132, v124, s56
  v_perm_b32 v132, v132, v124, s57
  v_mov_b32 v124, v11
  s_waitcnt vmcnt(36)
  v_perm_b32 v11, v133, v125, s56
  v_perm_b32 v133, v133, v125, s57
  v_mov_b32 v125, v11
  s_waitcnt vmcnt(34)
  v_perm_b32 v11, v134, v126, s56
  v_perm_b32 v134, v134, v126, s57
  v_mov_b32 v126, v11
  s_waitcnt vmcnt(32)
  v_perm_b32 v11, v135, v127, s56
  v_perm_b32 v135, v135, v127, s57
  v_mov_b32 v127, v11
  s_mov_b32 s62, 3145728
  buffer_load_dword v168, v15, s[12:15], s62 offen
  s_mov_b32 s62, 3153920
  buffer_load_dword v176, v15, s[12:15], s62 offen
  s_mov_b32 s62, 3211264
  buffer_load_dword v169, v15, s[12:15], s62 offen
  s_mov_b32 s62, 3219456
  buffer_load_dword v177, v15, s[12:15], s62 offen
  s_mov_b32 s62, 3162112
  buffer_load_dword v170, v15, s[12:15], s62 offen
  s_mov_b32 s62, 3170304
  buffer_load_dword v178, v15, s[12:15], s62 offen
  s_mov_b32 s62, 3227648
  buffer_load_dword v171, v15, s[12:15], s62 offen
  s_mov_b32 s62, 3235840
  buffer_load_dword v179, v15, s[12:15], s62 offen
  s_mov_b32 s62, 3407872
  buffer_load_dword v172, v15, s[12:15], s62 offen
  s_mov_b32 s62, 3416064
  buffer_load_dword v180, v15, s[12:15], s62 offen
  s_mov_b32 s62, 3473408
  buffer_load_dword v173, v15, s[12:15], s62 offen
  s_mov_b32 s62, 3481600
  buffer_load_dword v181, v15, s[12:15], s62 offen
  s_mov_b32 s62, 3424256
  buffer_load_dword v174, v15, s[12:15], s62 offen
  s_mov_b32 s62, 3432448
  buffer_load_dword v182, v15, s[12:15], s62 offen
  s_mov_b32 s62, 3489792
  buffer_load_dword v175, v15, s[12:15], s62 offen
  s_mov_b32 s62, 3497984
  buffer_load_dword v183, v15, s[12:15], s62 offen
  s_waitcnt vmcnt(46)
  v_perm_b32 v11, v144, v136, s56
  v_perm_b32 v144, v144, v136, s57
  v_mov_b32 v136, v11
  s_waitcnt vmcnt(44)
  v_perm_b32 v11, v145, v137, s56
  v_perm_b32 v145, v145, v137, s57
  v_mov_b32 v137, v11
  s_waitcnt vmcnt(42)
  v_perm_b32 v11, v146, v138, s56
  v_perm_b32 v146, v146, v138, s57
  v_mov_b32 v138, v11
  s_waitcnt vmcnt(40)
  v_perm_b32 v11, v147, v139, s56
  v_perm_b32 v147, v147, v139, s57
  v_mov_b32 v139, v11
  s_waitcnt vmcnt(38)
  v_perm_b32 v11, v148, v140, s56
  v_perm_b32 v148, v148, v140, s57
  v_mov_b32 v140, v11
  s_waitcnt vmcnt(36)
  v_perm_b32 v11, v149, v141, s56
  v_perm_b32 v149, v149, v141, s57
  v_mov_b32 v141, v11
  s_waitcnt vmcnt(34)
  v_perm_b32 v11, v150, v142, s56
  v_perm_b32 v150, v150, v142, s57
  v_mov_b32 v142, v11
  s_waitcnt vmcnt(32)
  v_perm_b32 v11, v151, v143, s56
  v_perm_b32 v151, v151, v143, s57
  v_mov_b32 v143, v11
  s_mov_b32 s62, 3670016
  buffer_load_dword v184, v15, s[12:15], s62 offen
  s_mov_b32 s62, 3678208
  buffer_load_dword v192, v15, s[12:15], s62 offen
  s_mov_b32 s62, 3735552
  buffer_load_dword v185, v15, s[12:15], s62 offen
  s_mov_b32 s62, 3743744
  buffer_load_dword v193, v15, s[12:15], s62 offen
  s_mov_b32 s62, 3686400
  buffer_load_dword v186, v15, s[12:15], s62 offen
  s_mov_b32 s62, 3694592
  buffer_load_dword v194, v15, s[12:15], s62 offen
  s_mov_b32 s62, 3751936
  buffer_load_dword v187, v15, s[12:15], s62 offen
  s_mov_b32 s62, 3760128
  buffer_load_dword v195, v15, s[12:15], s62 offen
  s_mov_b32 s62, 3932160
  buffer_load_dword v188, v15, s[12:15], s62 offen
  s_mov_b32 s62, 3940352
  buffer_load_dword v196, v15, s[12:15], s62 offen
  s_mov_b32 s62, 3997696
  buffer_load_dword v189, v15, s[12:15], s62 offen
  s_mov_b32 s62, 4005888
  buffer_load_dword v197, v15, s[12:15], s62 offen
  s_mov_b32 s62, 3948544
  buffer_load_dword v190, v15, s[12:15], s62 offen
  s_mov_b32 s62, 3956736
  buffer_load_dword v198, v15, s[12:15], s62 offen
  s_mov_b32 s62, 4014080
  buffer_load_dword v191, v15, s[12:15], s62 offen
  s_mov_b32 s62, 4022272
  buffer_load_dword v199, v15, s[12:15], s62 offen
  s_waitcnt vmcnt(46)
  v_perm_b32 v11, v160, v152, s56
  v_perm_b32 v160, v160, v152, s57
  v_mov_b32 v152, v11
  s_waitcnt vmcnt(44)
  v_perm_b32 v11, v161, v153, s56
  v_perm_b32 v161, v161, v153, s57
  v_mov_b32 v153, v11
  s_waitcnt vmcnt(42)
  v_perm_b32 v11, v162, v154, s56
  v_perm_b32 v162, v162, v154, s57
  v_mov_b32 v154, v11
  s_waitcnt vmcnt(40)
  v_perm_b32 v11, v163, v155, s56
  v_perm_b32 v163, v163, v155, s57
  v_mov_b32 v155, v11
  s_waitcnt vmcnt(38)
  v_perm_b32 v11, v164, v156, s56
  v_perm_b32 v164, v164, v156, s57
  v_mov_b32 v156, v11
  s_waitcnt vmcnt(36)
  v_perm_b32 v11, v165, v157, s56
  v_perm_b32 v165, v165, v157, s57
  v_mov_b32 v157, v11
  s_waitcnt vmcnt(34)
  v_perm_b32 v11, v166, v158, s56
  v_perm_b32 v166, v166, v158, s57
  v_mov_b32 v158, v11
  s_waitcnt vmcnt(32)
  v_perm_b32 v11, v167, v159, s56
  v_perm_b32 v167, v167, v159, s57
  v_mov_b32 v159, v11
  s_mov_b32 s62, 4194304
  buffer_load_dword v200, v15, s[12:15], s62 offen
  s_mov_b32 s62, 4202496
  buffer_load_dword v208, v15, s[12:15], s62 offen
  s_mov_b32 s62, 4259840
  buffer_load_dword v201, v15, s[12:15], s62 offen
  s_mov_b32 s62, 4268032
  buffer_load_dword v209, v15, s[12:15], s62 offen
  s_mov_b32 s62, 4210688
  buffer_load_dword v202, v15, s[12:15], s62 offen
  s_mov_b32 s62, 4218880
  buffer_load_dword v210, v15, s[12:15], s62 offen
  s_mov_b32 s62, 4276224
  buffer_load_dword v203, v15, s[12:15], s62 offen
  s_mov_b32 s62, 4284416
  buffer_load_dword v211, v15, s[12:15], s62 offen
  s_mov_b32 s62, 4456448
  buffer_load_dword v204, v15, s[12:15], s62 offen
  s_mov_b32 s62, 4464640
  buffer_load_dword v212, v15, s[12:15], s62 offen
  s_mov_b32 s62, 4521984
  buffer_load_dword v205, v15, s[12:15], s62 offen
  s_mov_b32 s62, 4530176
  buffer_load_dword v213, v15, s[12:15], s62 offen
  s_mov_b32 s62, 4472832
  buffer_load_dword v206, v15, s[12:15], s62 offen
  s_mov_b32 s62, 4481024
  buffer_load_dword v214, v15, s[12:15], s62 offen
  s_mov_b32 s62, 4538368
  buffer_load_dword v207, v15, s[12:15], s62 offen
  s_mov_b32 s62, 4546560
  buffer_load_dword v215, v15, s[12:15], s62 offen
  s_waitcnt vmcnt(46)
  v_perm_b32 v11, v176, v168, s56
  v_perm_b32 v176, v176, v168, s57
  v_mov_b32 v168, v11
  s_waitcnt vmcnt(44)
  v_perm_b32 v11, v177, v169, s56
  v_perm_b32 v177, v177, v169, s57
  v_mov_b32 v169, v11
  s_waitcnt vmcnt(42)
  v_perm_b32 v11, v178, v170, s56
  v_perm_b32 v178, v178, v170, s57
  v_mov_b32 v170, v11
  s_waitcnt vmcnt(40)
  v_perm_b32 v11, v179, v171, s56
  v_perm_b32 v179, v179, v171, s57
  v_mov_b32 v171, v11
  s_waitcnt vmcnt(38)
  v_perm_b32 v11, v180, v172, s56
  v_perm_b32 v180, v180, v172, s57
  v_mov_b32 v172, v11
  s_waitcnt vmcnt(36)
  v_perm_b32 v11, v181, v173, s56
  v_perm_b32 v181, v181, v173, s57
  v_mov_b32 v173, v11
  s_waitcnt vmcnt(34)
  v_perm_b32 v11, v182, v174, s56
  v_perm_b32 v182, v182, v174, s57
  v_mov_b32 v174, v11
  s_waitcnt vmcnt(32)
  v_perm_b32 v11, v183, v175, s56
  v_perm_b32 v183, v183, v175, s57
  v_mov_b32 v175, v11
  s_waitcnt vmcnt(30)
  v_perm_b32 v11, v192, v184, s56
  v_perm_b32 v192, v192, v184, s57
  v_mov_b32 v184, v11
  s_waitcnt vmcnt(28)
  v_perm_b32 v11, v193, v185, s56
  v_perm_b32 v193, v193, v185, s57
  v_mov_b32 v185, v11
  s_waitcnt vmcnt(26)
  v_perm_b32 v11, v194, v186, s56
  v_perm_b32 v194, v194, v186, s57
  v_mov_b32 v186, v11
  s_waitcnt vmcnt(24)
  v_perm_b32 v11, v195, v187, s56
  v_perm_b32 v195, v195, v187, s57
  v_mov_b32 v187, v11
  s_waitcnt vmcnt(22)
  v_perm_b32 v11, v196, v188, s56
  v_perm_b32 v196, v196, v188, s57
  v_mov_b32 v188, v11
  s_waitcnt vmcnt(20)
  v_perm_b32 v11, v197, v189, s56
  v_perm_b32 v197, v197, v189, s57
  v_mov_b32 v189, v11
  s_waitcnt vmcnt(18)
  v_perm_b32 v11, v198, v190, s56
  v_perm_b32 v198, v198, v190, s57
  v_mov_b32 v190, v11
  s_waitcnt vmcnt(16)
  v_perm_b32 v11, v199, v191, s56
  v_perm_b32 v199, v199, v191, s57
  v_mov_b32 v191, v11
  s_waitcnt vmcnt(14)
  v_perm_b32 v11, v208, v200, s56
  v_perm_b32 v208, v208, v200, s57
  v_mov_b32 v200, v11
  s_waitcnt vmcnt(12)
  v_perm_b32 v11, v209, v201, s56
  v_perm_b32 v209, v209, v201, s57
  v_mov_b32 v201, v11
  s_waitcnt vmcnt(10)
  v_perm_b32 v11, v210, v202, s56
  v_perm_b32 v210, v210, v202, s57
  v_mov_b32 v202, v11
  s_waitcnt vmcnt(8)
  v_perm_b32 v11, v211, v203, s56
  v_perm_b32 v211, v211, v203, s57
  v_mov_b32 v203, v11
  s_waitcnt vmcnt(6)
  v_perm_b32 v11, v212, v204, s56
  v_perm_b32 v212, v212, v204, s57
  v_mov_b32 v204, v11
  s_waitcnt vmcnt(4)
  v_perm_b32 v11, v213, v205, s56
  v_perm_b32 v213, v213, v205, s57
  v_mov_b32 v205, v11
  s_waitcnt vmcnt(2)
  v_perm_b32 v11, v214, v206, s56
  v_perm_b32 v214, v214, v206, s57
  v_mov_b32 v206, v11
  s_waitcnt vmcnt(0)
  v_perm_b32 v11, v215, v207, s56
  v_perm_b32 v215, v215, v207, s57
  v_mov_b32 v207, v11
  v_and_b32 v12, 2, v0
  v_cmp_ne_u32 vcc, 0, v12
  v_mov_b32 v12, 0x44444444
  v_mov_b32 v13, 0xeeeeeeee
  v_cndmask_b32 v0, v12, v13, vcc
  v_mov_b32 v12, 4
  s_mov_b32 s55, 150000
poll_1:
  buffer_load_dword v13, v12, s[20:23], 0 offen sc1
  s_waitcnt vmcnt(0)
  v_cmp_gt_u32 vcc, 56, v13
  s_nop 0
  s_cbranch_vccz pdone_2
  s_sleep 2
  s_mov_b32 s58, 1
  s_sub_u32 s55, s55, 1
  s_cbranch_scc0 poll_1
  s_branch ABORT
pdone_2:
  s_mov_b32 s12, s32
  s_mov_b32 s13, s33
  s_mov_b32 s14, 9216
  s_mov_b32 s15, 0x00020000
  s_mov_b32 s52, 0
  s_mov_b32 s54, 4194304
CH_LAYER:
  s_mov_b32 s53, 0
  s_lshl_b32 s76, s52, 6
  s_lshl_b32 s60, s50, 13
  s_add_u32 s60, s60, s54
  s_add_u32 s74, s60, 39845888
  s_add_u32 s74, s74, s78
  s_lshl_b32 s60, s50, 11
  s_add_u32 s60, s60, s54
  s_add_u32 s60, s60, s79
  s_add_u32 s72, s60, 73400320
  s_mov_b32 s29, 0x40000000
  v_mov_b32 v62, 0
  v_mov_b32 v63, s76
  s_add_u32 s73, s60, 77594624
  v_mov_b64 v[20:21], 0
  v_mov_b64 v[22:23], 0
  v_mov_b64 v[24:25], 0
  v_mov_b64 v[26:27], 0
  v_mov_b64 v[12:13], 0
  v_mov_b64 v[14:15], 0
  v_mov_b64 v[16:17], 0
  v_mov_b64 v[18:19], 0
  v_mov_b32 v68, 163584
  ds_read_b32 v69, v68 offset:8
  ds_read_b32 v68, v68 offset:4
  s_waitcnt lgkmcnt(0)
  v_min_u32 v68, v68, v69
  s_nop 0
  v_readfirstlane_b32 s60, v68
  s_nop 0
  s_max_u32 s77, s77, s60
  s_add_u32 s60, s26, s74
  s_add_u32 s61, s76, 2
  s_cmp_ge_u32 s77, s61
  s_cselect_b32 s60, s60, 0x40000000
  s_cmp_ge_u32 s53, 62
  s_cselect_b32 s60, 0x40000000, s60
  s_add_u32 s61, s75, -6144
  s_cmp_eq_u32 s51, 3
  s_cselect_b32 s42, s61, s60
  s_lshr_b32 s60, s79, 1
  s_add_u32 m0, s60, 162816
  v_lshrrev_b32 v68, 2, v1
  v_add_u32 v69, 64, v68
  v_bfe_i32 v69, v69, 7, 1
  v_and_b32 v69, 192, v69
  v_xor_b32 v68, v68, v69
  ds_read_b128 v[28:31], v2 offset:0
  ds_read_b128 v[32:35], v2 offset:1024
  ds_read_b128 v[36:39], v2 offset:2048
  ds_read_b128 v[40:43], v2 offset:3072
  ds_read_b128 v[52:55], v2 offset:4096
  ds_read_b128 v[56:59], v2 offset:5120
  s_waitcnt lgkmcnt(0)
  s_barrier
  v_lshrrev_b32 v69, 7, v1
  v_mul_u32_u24 v69, 1152, v69
  v_and_b32 v70, 127, v1
  v_add_u32 v69, v69, v70
  s_lshl_b32 s60, s51, 8
  buffer_load_dwordx4 v[44:47], v69, s[12:15], s60 offen
  buffer_load_dwordx4 v[48:51], v69, s[12:15], s60 offen offset:128
  v_lshrrev_b32 v69, 9, v1
  v_mul_u32_u24 v69, 1152, v69
  v_bfe_u32 v70, v1, 2, 7
  v_add_u32 v69, v69, v70
  s_mul_i32 s60, s51, 2304
  buffer_load_dword v11, v69, s[12:15], s60 offen offset:1024
  s_waitcnt vmcnt(0)
  ds_write_b128 v9, v[44:47] offset:2048
  ds_write_b128 v9, v[48:51] offset:3072
  ds_write_b32 v8, v11 offset:2048
  s_branch CH_BODY
CH_R2:
  s_waitcnt lgkmcnt(0)
CH_P2:
  s_mov_b64 exec, vcc
  buffer_load_dwordx4 v[44:47], v1, s[4:7], s59 offen sc1
  buffer_load_dwordx4 v[48:51], v1, s[4:7], s59 offen offset:1024 sc1
  buffer_load_dword v11, v68, s[4:7], s2 offen sc1
  s_and_b32 s60, s55, 31
  s_cbranch_scc1 nowb_3
  buffer_wbl2 sc1
  s_waitcnt vmcnt(0)
nowb_3:
  s_mov_b32 s58, 4
  s_sub_u32 s55, s55, 1
  s_cbranch_scc0 CH_X2
  s_branch ABORT
CH_X2:
  s_waitcnt vmcnt(0)
  v_bitop3_b32 v69, v44, v46, s69 bitop3:0x7e
  v_bitop3_b32 v70, v48, v50, s69 bitop3:0x7e
  v_bitop3_b32 v69, v69, v11, s69 bitop3:0xf6
  v_bitop3_b32 v69, v69, v70, 1 bitop3:0xa8
  v_cmp_ne_u32 vcc, 0, v69
  s_nop 0
  s_cbranch_vccnz CH_P2
  s_mov_b64 exec, -1
  ds_write_b128 v9, v[44:47] offset:2048
  ds_write_b128 v9, v[48:51] offset:3072
  ds_write_b32 v8, v11 offset:2048
  s_branch CH_BODY
CH_R2M:
  s_mov_b64 exec, vcc
  buffer_load_dwordx4 v[44:47], v1, s[4:7], s59 offen sc1
  buffer_load_dwordx4 v[48:51], v1, s[4:7], s59 offen offset:1024 sc1
  buffer_load_dword v11, v68, s[4:7], s2 offen sc1
  s_and_b32 s60, s55, 31
  s_cbranch_scc1 nowb_4
  buffer_wbl2 sc1
  s_waitcnt vmcnt(0)
nowb_4:
  s_mov_b32 s58, 4
  s_sub_u32 s55, s55, 1
  s_cbranch_scc0 CH_D2
  s_branch ABORT
CH_STEP:
  s_waitcnt vmcnt(0)
  s_barrier
  buffer_load_dwordx4 v[44:47], v1, s[4:7], s59 offen sc1
  buffer_load_dwordx4 v[48:51], v1, s[4:7], s59 offen offset:1024 sc1
  buffer_load_dword v11, v68, s[4:7], s2 offen sc1
  s_mov_b32 s55, 400031
CH_D2:
  s_waitcnt vmcnt(0)
  v_bitop3_b32 v69, v44, v46, s69 bitop3:0x7e
  v_bitop3_b32 v70, v48, v50, s69 bitop3:0x7e
  v_bitop3_b32 v69, v69, v11, s69 bitop3:0xf6
  v_bitop3_b32 v69, v69, v70, 1 bitop3:0xa8
  v_cmp_ne_u32 vcc, 0, v69
  s_nop 0
  s_andn2_b64 exec, exec, vcc
  ds_write_b128 v9, v[44:47] offset:2048
  ds_write_b128 v9, v[48:51] offset:3072
  ds_write_b32 v8, v11 offset:2048
  s_cbranch_vccnz CH_R2M
CH_OK2:
  s_mov_b64 exec, -1
CH_BODY:
  s_waitcnt lgkmcnt(0)
  s_barrier
  ds_read_b128 v[68:71], v10 offset:2048
  ds_read_b128 v[44:47], v10 offset:3072
  ds_read_b128 v[48:51], v10 offset:4096
  v_lshlrev_b32 v11, s43, v1
  v_min_u32 v11, s27, v11
  buffer_load_dword v11, s[4:7], s42 offen sc1 lds
  s_waitcnt lgkmcnt(2)
  v_smfmac_f32_16x16x64_bf16 v[12:15], v[68:71], v[28:35], v0
  ds_read_b128 v[28:31], v2 offset:6144
  v_smfmac_f32_16x16x64_bf16 v[16:19], v[68:71], a[0:7], v0
  ds_read_b128 v[32:35], v2 offset:7168
  v_smfmac_f32_16x16x64_bf16 v[20:23], v[68:71], a[8:15], v0
  v_smfmac_f32_16x16x64_bf16 v[24:27], v[68:71], v[36:43], v0
  ds_read_b128 v[36:39], v2 offset:8192
  s_waitcnt lgkmcnt(4)
  v_smfmac_f32_16x16x64_bf16 v[12:15], v[44:47], a[16:23], v0
  ds_read_b128 v[40:43], v2 offset:9216
  v_smfmac_f32_16x16x64_bf16 v[16:19], v[44:47], a[24:31], v0
  ds_read_b128 v[68:71], v10 offset:5120
  v_smfmac_f32_16x16x64_bf16 v[20:23], v[44:47], v[52:59], v0
  ds_read_b128 v[52:55], v2 offset:10240
  v_smfmac_f32_16x16x64_bf16 v[24:27], v[44:47], a[32:39], v0
  ds_read_b128 v[56:59], v2 offset:11264
  s_waitcnt lgkmcnt(7)
  v_smfmac_f32_16x16x64_bf16 v[12:15], v[48:51], a[40:47], v0
  ds_read_b128 v[44:47], v10 offset:6144
  s_waitcnt lgkmcnt(6)
  v_smfmac_f32_16x16x64_bf16 v[16:19], v[48:51], v[28:35], v0
  buffer_store_dwordx2 v[60:61], v62, s[4:7], s29 offen sc1
  v_smfmac_f32_16x16x64_bf16 v[20:23], v[48:51], a[48:55], v0
  buffer_store_dword v63, off, s[4:7], s28 sc1
  v_smfmac_f32_16x16x64_bf16 v[24:27], v[48:51], a[56:63], v0
  ds_read_b128 v[28:31], v2 offset:12288
  s_waitcnt lgkmcnt(4)
  v_smfmac_f32_16x16x64_bf16 v[12:15], v[68:71], v[36:43], v0
  ds_read_b128 v[32:35], v2 offset:13312
  v_smfmac_f32_16x16x64_bf16 v[16:19], v[68:71], a[64:71], v0
  ds_read_b128 v[48:51], v10 offset:7168
  v_smfmac_f32_16x16x64_bf16 v[20:23], v[68:71], a[72:79], v0
  ds_read_b128 v[36:39], v2 offset:14336
  s_waitcnt lgkmcnt(5)
  v_smfmac_f32_16x16x64_bf16 v[24:27], v[68:71], v[52:59], v0
  ds_read_b128 v[40:43], v2 offset:15360
  s_waitcnt lgkmcnt(5)
  v_smfmac_f32_16x16x64_bf16 v[12:15], v[44:47], a[80:87], v0
  ds_read_b128 v[52:55], v2 offset:16384
  v_smfmac_f32_16x16x64_bf16 v[16:19], v[44:47], a[88:95], v0
  ds_read_b128 v[56:59], v2 offset:17408
  s_waitcnt lgkmcnt(5)
  v_smfmac_f32_16x16x64_bf16 v[20:23], v[44:47], v[28:35], v0
  ds_read_b128 v[68:71], v10 offset:8192
  v_smfmac_f32_16x16x64_bf16 v[24:27], v[44:47], a[96:103], v0
  ds_read_b128 v[28:31], v2 offset:18432
  s_waitcnt lgkmcnt(6)
  v_smfmac_f32_16x16x64_bf16 v[12:15], v[48:51], a[104:111], v0
  ds_read_b128 v[32:35], v2 offset:19456
  s_waitcnt lgkmcnt(5)
  v_smfmac_f32_16x16x64_bf16 v[16:19], v[48:51], v[36:43], v0
  ds_read_b128 v[44:47], v10 offset:9216
  v_smfmac_f32_16x16x64_bf16 v[20:23], v[48:51], a[112:119], v0
  ds_read_b128 v[36:39], v2 offset:20480
  v_smfmac_f32_16x16x64_bf16 v[24:27], v[48:51], a[120:127], v0
  ds_read_b128 v[40:43], v2 offset:21504
  s_waitcnt lgkmcnt(5)
  v_smfmac_f32_16x16x64_bf16 v[12:15], v[68:71], v[52:59], v0
  ds_read_b128 v[48:51], v10 offset:10240
  v_smfmac_f32_16x16x64_bf16 v[16:19], v[68:71], a[128:135], v0
  v_mov_b64 v[52:53], 0
  v_smfmac_f32_16x16x64_bf16 v[20:23], v[68:71], a[136:143], v0
  v_mov_b64 v[54:55], 0
  s_waitcnt lgkmcnt(4)
  v_smfmac_f32_16x16x64_bf16 v[24:27], v[68:71], v[28:35], v0
  v_mov_b64 v[56:57], 0
  s_waitcnt lgkmcnt(3)
  v_smfmac_f32_16x16x64_bf16 v[12:15], v[44:47], a[144:151], v0
  v_mov_b64 v[58:59], 0
  v_smfmac_f32_16x16x64_bf16 v[16:19], v[44:47], a[152:159], v0
  ds_read_b128 v[28:31], v10 offset:2048
  s_waitcnt lgkmcnt(2)
  v_smfmac_f32_16x16x64_bf16 v[20:23], v[44:47], v[36:43], v0
  ds_read_b128 v[32:35], v10 offset:3072
  v_smfmac_f32_16x16x64_bf16 v[24:27], v[44:47], a[160:167], v0
  ds_read_b128 v[36:39], v10 offset:4096
  s_cmp_eq_u32 s53, 0
  s_cbranch_scc1 CH_K0
CH_K0R:
  s_waitcnt lgkmcnt(3)
  v_smfmac_f32_16x16x64_bf16 v[12:15], v[48:51], a[168:175], v0
  ds_read_b128 v[40:43], v10 offset:5120
  v_smfmac_f32_16x16x64_bf16 v[16:19], v[48:51], a[176:183], v0
  v_and_b32 v11, -256, v1
  v_smfmac_f32_16x16x64_bf16 v[20:23], v[48:51], a[184:191], v0
  v_add_u32 v11, v11, v1
  v_smfmac_f32_16x16x64_bf16 v[24:27], v[48:51], a[192:199], v0
  buffer_load_dwordx4 v[60:63], v11, s[4:7], s74 offen sc1
  buffer_load_dwordx4 v[64:67], v11, s[4:7], s74 offen offset:256 sc1
  v_smfmac_f32_16x16x64_bf16 v[52:55], v[68:71], v[168:175], v0
  v_smfmac_f32_16x16x64_bf16 v[56:59], v[68:71], v[176:183], v0
  v_add_f32 v12, v12, v14
  v_add_f32 v13, v13, v15
  v_add_f32 v16, v16, v18
  v_add_f32 v17, v17, v19
  v_cvt_pk_bf16_f32 v68, v12, v16
  v_cvt_pk_bf16_f32 v70, v13, v17
  v_add_f32 v20, v20, v22
  v_add_f32 v21, v21, v23
  v_add_f32 v24, v24, v26
  v_add_f32 v25, v25, v27
  v_cvt_pk_bf16_f32 v69, v20, v24
  v_cvt_pk_bf16_f32 v71, v21, v25
  ds_write_b64 v3, v[68:69] offset:11264
  ds_write_b64 v3, v[70:71] offset:11280
  v_smfmac_f32_16x16x64_bf16 v[52:55], v[44:47], v[184:191], v0
  v_lshrrev_b32 v20, 4, v1
  v_xor_b32 v20, v20, v1
  v_smfmac_f32_16x16x64_bf16 v[56:59], v[44:47], v[192:199], v0
  ds_read_b128 v[44:47], v10 offset:6144
  v_smfmac_f32_16x16x64_bf16 v[52:55], v[48:51], v[200:207], v0
  v_bitop3_b32 v20, v4, v20, 32 bitop3:0x78
  v_smfmac_f32_16x16x64_bf16 v[56:59], v[48:51], v[208:215], v0
  ds_read_b128 v[48:51], v10 offset:7168
  s_waitcnt lgkmcnt(7)
  v_smfmac_f32_16x16x64_bf16 v[52:55], v[28:31], v[72:79], v0
  v_xor_b32 v24, 64, v20
  v_smfmac_f32_16x16x64_bf16 v[56:59], v[28:31], v[80:87], v0
  ds_read_b128 v[28:31], v1 offset:15360
  s_waitcnt lgkmcnt(3)
  s_barrier
  ds_read_b128 v[12:15], v20 offset:11264
  ds_read_b128 v[16:19], v24 offset:11776
  v_smfmac_f32_16x16x64_bf16 v[52:55], v[32:35], v[88:95], v0
  s_add_u32 s63, s76, 2
  v_smfmac_f32_16x16x64_bf16 v[56:59], v[32:35], v[96:103], v0
  ds_read_b128 v[32:35], v1 offset:16384
  v_smfmac_f32_16x16x64_bf16 v[52:55], v[36:39], v[104:111], v0
  v_smfmac_f32_16x16x64_bf16 v[56:59], v[36:39], v[112:119], v0
  ds_read_b128 v[36:39], v1 offset:17408
  v_smfmac_f32_16x16x64_bf16 v[52:55], v[40:43], v[120:127], v0
  s_add_u32 s74, s74, 262144
  v_smfmac_f32_16x16x64_bf16 v[56:59], v[40:43], v[128:135], v0
  ds_read_b128 v[40:43], v1 offset:18432
  s_waitcnt lgkmcnt(7)
  v_smfmac_f32_16x16x64_bf16 v[52:55], v[44:47], v[136:143], v0
  s_add_u32 s64, s74, -16777216
  v_smfmac_f32_16x16x64_bf16 v[56:59], v[44:47], v[144:151], v0
  ds_read_b128 v[44:47], v20 offset:12288
  s_waitcnt lgkmcnt(7)
  v_smfmac_f32_16x16x64_bf16 v[52:55], v[48:51], v[152:159], v0
  s_add_u32 m0, s78, 15360
  v_smfmac_f32_16x16x64_bf16 v[56:59], v[48:51], v[160:167], v0
  ds_read_b128 v[48:51], v24 offset:12800
  s_waitcnt lgkmcnt(6)
  v_mfma_f32_16x16x32_bf16 v[20:23], v[28:31], v[12:15], 0
  s_waitcnt lgkmcnt(4)
  v_mfma_f32_16x16x32_bf16 v[24:27], v[32:35], v[12:15], 0
  ds_read_b128 v[28:31], v1 offset:19456
  ds_read_b128 v[32:35], v1 offset:20480
  s_waitcnt lgkmcnt(5)
  v_mfma_f32_16x16x32_bf16 v[20:23], v[36:39], v[16:19], v[20:23]
  s_waitcnt lgkmcnt(4)
  v_mfma_f32_16x16x32_bf16 v[24:27], v[40:43], v[16:19], v[24:27]
  ds_read_b128 v[36:39], v1 offset:21504
  ds_read_b128 v[40:43], v1 offset:22528
  v_mfma_f32_16x16x32_bf16 v[68:71], v[12:15], v[12:15], 0
  v_add_f32 v52, v52, v54
  v_add_f32 v53, v53, v55
  v_mfma_f32_16x16x32_bf16 v[68:71], v[16:19], v[16:19], v[68:71]
  v_add_f32 v56, v56, v58
  v_add_f32 v57, v57, v59
  s_waitcnt lgkmcnt(5)
  v_mfma_f32_16x16x32_bf16 v[68:71], v[44:47], v[44:47], v[68:71]
  v_cvt_pk_bf16_f32 v52, v52, v53
  s_waitcnt lgkmcnt(4)
  v_mfma_f32_16x16x32_bf16 v[68:71], v[48:51], v[48:51], v[68:71]
  v_cvt_pk_bf16_f32 v53, v56, v57
  v_lshrrev_b32 v11, 1, v1
  buffer_store_dwordx2 v[52:53], v11, s[4:7], s73 offen sc1
  s_cmp_eq_u32 s53, 63
  s_cbranch_scc1 CH_LAST
  s_waitcnt lgkmcnt(3)
  v_mfma_f32_16x16x32_bf16 v[20:23], v[28:31], v[44:47], v[20:23]
  v_mov_b32 v59, 0x3f803f80
  s_waitcnt lgkmcnt(2)
  v_mfma_f32_16x16x32_bf16 v[24:27], v[32:35], v[44:47], v[24:27]
  v_mov_b32 v58, 0x3f803f80
  s_waitcnt lgkmcnt(1)
  v_mfma_f32_16x16x32_bf16 v[20:23], v[36:39], v[48:51], v[20:23]
  v_mov_b32 v57, 0x3f803f80
  s_waitcnt lgkmcnt(0)
  v_mfma_f32_16x16x32_bf16 v[24:27], v[40:43], v[48:51], v[24:27]
  v_mov_b32 v56, 0x3f803f80
  ds_read_b128 v[28:31], v2 offset:30720
  ds_read_b128 v[32:35], v2 offset:31744
  ds_read_b128 v[36:39], v2 offset:32768
  ds_read_b128 v[40:43], v2 offset:33792
  v_max_f32 v54, v68, v69
  v_mov_b32 v17, 0
  v_mov_b32 v18, 0
  v_max3_f32 v54, v54, v20, v21
  v_max3_f32 v54, v54, v22, v23
  v_max3_f32 v54, v54, v24, v25
  v_max3_f32 v11, v54, v26, v27
  v_max3_f32 v54, v54, v26, v27
  s_nop 1
  v_permlane16_swap_b32 v54, v11
  v_max_f32 v55, v54, v11
  v_max_f32 v54, v54, v11
  s_nop 1
  v_permlane32_swap_b32 v54, v55
  v_max_f32 v54, v54, v55
  v_mul_f32 v54, s68, v54
  v_fma_f32 v68, v68, s68, -v54
  v_fma_f32 v69, v69, s68, -v54
  v_exp_f32 v68, v68
  v_exp_f32 v69, v69
  v_fma_f32 v20, v20, s68, -v54
  v_fma_f32 v21, v21, s68, -v54
  v_exp_f32 v20, v20
  v_exp_f32 v21, v21
  v_cvt_pk_bf16_f32 v16, v68, v69
  v_cvt_pk_bf16_f32 v19, v68, v69
  v_cvt_pk_bf16_f32 v12, v20, v21
  v_fma_f32 v22, v22, s68, -v54
  v_fma_f32 v23, v23, s68, -v54
  v_exp_f32 v22, v22
  v_exp_f32 v23, v23
  v_mfma_f32_16x16x16_bf16 v[68:71], v[56:57], v[16:17], 0
  v_cvt_pk_bf16_f32 v13, v22, v23
  v_fma_f32 v24, v24, s68, -v54
  v_fma_f32 v25, v25, s68, -v54
  v_exp_f32 v24, v24
  v_exp_f32 v25, v25
  v_mfma_f32_16x16x16_bf16 v[44:47], v[52:53], v[16:17], 0
  v_cvt_pk_bf16_f32 v14, v24, v25
  v_fma_f32 v26, v26, s68, -v54
  v_fma_f32 v27, v27, s68, -v54
  v_exp_f32 v26, v26
  v_exp_f32 v27, v27
  v_mfma_f32_16x16x16_bf16 v[48:51], v[52:53], v[18:19], 0
  v_cvt_pk_bf16_f32 v15, v26, v27
  v_add_u32 v11, s79, v4
  v_bfe_u32 v54, v11, 7, 3
  v_mfma_f32_16x16x32_bf16 v[68:71], v[56:59], v[12:15], v[68:71]
  s_waitcnt vmcnt(2)
  v_mfma_f32_16x16x32_bf16 v[44:47], v[60:63], v[12:15], v[44:47]
  s_waitcnt vmcnt(1)
  v_mfma_f32_16x16x32_bf16 v[48:51], v[64:67], v[12:15], v[48:51]
  v_lshlrev_b32 v54, 4, v54
  v_xor_b32 v11, v11, v54
  v_mov_b64 v[20:21], 0
  v_mov_b64 v[22:23], 0
  v_mov_b64 v[24:25], 0
  v_mov_b64 v[26:27], 0
  v_rcp_f32 v68, v68
  v_mov_b64 v[12:13], 0
  v_mov_b64 v[14:15], 0
  v_pk_mul_f32 v[44:45], v[44:45], v[68:69] op_sel_hi:[1,0]
  v_pk_mul_f32 v[48:49], v[48:49], v[68:69] op_sel_hi:[1,0]
  v_pk_mul_f32 v[46:47], v[46:47], v[68:69] op_sel_hi:[1,0]
  v_pk_mul_f32 v[50:51], v[50:51], v[68:69] op_sel_hi:[1,0]
  v_cvt_pk_bf16_f32 v44, v44, v48
  v_cvt_pk_bf16_f32 v45, v45, v49
  v_cvt_pk_bf16_f32 v46, v46, v50
  v_cvt_pk_bf16_f32 v47, v47, v51
  ds_write_b128 v11, v[44:47] offset:0
  v_mov_b64 v[16:17], 0
  v_mov_b64 v[18:19], 0
  v_mov_b64 v[68:69], 0
  v_mov_b64 v[70:71], 0
  v_lshrrev_b32 v60, 4, v1
  v_and_b32 v60, 48, v60
  v_and_b32 v64, 0x7ff, v4
  v_xor_b32 v60, v60, v64
  v_xor_b32 v64, 576, v60
  s_xor_b32 s69, s69, 1
  s_cmp_ge_u32 s77, s63
  s_cbranch_scc0 CH_KS
CH_KR:
  v_and_b32 v11, -128, v1
  v_add_u32 v11, v11, v1
  s_waitcnt lgkmcnt(0)
  s_barrier
  ds_read_b128 v[52:55], v10 offset:0
  ds_read_b128 v[56:59], v10 offset:1024
  ds_read_b128 v[44:47], v60 offset:0
  ds_read_b128 v[48:51], v64 offset:0
  ds_read_b128 v[60:63], v60 offset:1024
  ds_read_b128 v[64:67], v64 offset:1024
  buffer_load_dwordx4 v11, s[4:7], s64 offen sc1 lds
  s_add_u32 m0, m0, 896
  s_nop 0
  buffer_load_dwordx4 v11, s[4:7], s64 offen offset:128 sc1 lds
  s_waitcnt lgkmcnt(5)
  v_smfmac_f32_16x16x64_bf16 v[68:71], v[52:55], v[28:35], v0
  ds_read_b128 v[28:31], v2 offset:22528
  s_waitcnt lgkmcnt(5)
  v_smfmac_f32_16x16x64_bf16 v[68:71], v[56:59], v[36:43], v0
  ds_read_b128 v[36:39], v2 offset:24576
  s_waitcnt lgkmcnt(5)
  v_smfmac_f32_16x16x64_bf16 v[12:15], v[44:47], a[200:207], v0
  ds_read_b128 v[40:43], v2 offset:25600
  s_waitcnt lgkmcnt(5)
  v_smfmac_f32_16x16x64_bf16 v[12:15], v[48:51], a[208:215], v0
  ds_read_b128 v[32:35], v2 offset:23552
  s_waitcnt lgkmcnt(5)
  v_smfmac_f32_16x16x64_bf16 v[12:15], v[60:63], a[216:223], v0
  s_waitcnt lgkmcnt(4)
  v_smfmac_f32_16x16x64_bf16 v[12:15], v[64:67], a[224:231], v0
  v_add_f32 v68, v68, v70
  v_add_f32 v69, v69, v71
  v_smfmac_f32_16x16x64_bf16 v[16:19], v[44:47], a[232:239], v0
  v_mov_b32_dpp v70, v68 quad_perm:[1,0,3,2] row_mask:0xf bank_mask:0xf
  v_mov_b32_dpp v71, v69 quad_perm:[1,0,3,2] row_mask:0xf bank_mask:0xf
  v_smfmac_f32_16x16x64_bf16 v[16:19], v[48:51], a[240:247], v0
  v_cvt_pk_bf16_f32 v68, v68, v70
  s_waitcnt lgkmcnt(0)
  v_smfmac_f32_16x16x64_bf16 v[16:19], v[60:63], v[28:35], v0
  ds_read_b128 v[28:31], v2 offset:26624
  ds_read_b128 v[32:35], v2 offset:27648
  v_smfmac_f32_16x16x64_bf16 v[16:19], v[64:67], v[36:43], v0
  ds_read_b128 v[36:39], v2 offset:28672
  ds_read_b128 v[40:43], v2 offset:29696
  v_smfmac_f32_16x16x64_bf16 v[20:23], v[44:47], a[248:255], v0
  v_cvt_pk_bf16_f32 v69, v71, v69
  v_cndmask_b32 v68, v68, v69, s[98:99]
  v_smfmac_f32_16x16x64_bf16 v[20:23], v[48:51], v[216:223], v0
  v_and_or_b32 v68, v68, -2, s69
  buffer_store_dword v68, v6, s[4:7], 0 offen
  v_smfmac_f32_16x16x64_bf16 v[20:23], v[60:63], v[224:231], v0
  v_cvt_pk_bf16_f32 v52, v12, v14
  v_cvt_pk_bf16_f32 v54, v13, v15
  v_smfmac_f32_16x16x64_bf16 v[20:23], v[64:67], v[232:239], v0
  v_and_or_b32 v52, v52, -2, s69
  v_cvt_pk_bf16_f32 v53, v16, v18
  v_smfmac_f32_16x16x64_bf16 v[24:27], v[44:47], v[240:247], v0
  v_cvt_pk_bf16_f32 v55, v17, v19
  buffer_store_dwordx4 v[52:55], v5, s[4:7], 0 offen
  v_smfmac_f32_16x16x64_bf16 v[24:27], v[48:51], v[248:255], v0
  s_waitcnt lgkmcnt(2)
  v_smfmac_f32_16x16x64_bf16 v[24:27], v[60:63], v[28:35], v0
  s_waitcnt lgkmcnt(0)
  v_smfmac_f32_16x16x64_bf16 v[24:27], v[64:67], v[36:43], v0
  v_cvt_pk_bf16_f32 v56, v20, v22
  v_cvt_pk_bf16_f32 v58, v21, v23
  v_and_or_b32 v56, v56, -2, s69
  s_nop 4
  v_cvt_pk_bf16_f32 v57, v24, v26
  v_cvt_pk_bf16_f32 v59, v25, v27
  buffer_store_dwordx4 v[56:59], v5, s[4:7], s3 offen
  v_lshrrev_b32 v62, 1, v1
  v_add_u32 v60, s79, v62
  v_lshrrev_b32 v61, 3, v60
  v_and_b32 v61, 96, v61
  v_xor_b32 v60, v60, v61
  ds_read_b64 v[60:61], v60 offset:13312
  v_mov_b32 v63, s76
  s_mov_b32 s29, s72
  s_add_u32 s72, s72, 65536
  s_add_u32 s53, s53, 1
  s_add_u32 s76, s76, 1
  s_add_u32 s73, s73, 65536
  v_mov_b64 v[20:21], 0
  v_mov_b64 v[22:23], 0
  v_mov_b64 v[24:25], 0
  v_mov_b64 v[26:27], 0
  v_mov_b64 v[12:13], 0
  v_mov_b64 v[14:15], 0
  v_mov_b64 v[16:17], 0
  v_mov_b64 v[18:19], 0
  v_mov_b32 v68, 163584
  ds_read_b32 v69, v68 offset:8
  ds_read_b32 v68, v68 offset:4
  s_waitcnt lgkmcnt(0)
  v_min_u32 v68, v68, v69
  s_nop 0
  v_readfirstlane_b32 s60, v68
  s_nop 0
  s_max_u32 s77, s77, s60
  s_add_u32 s60, s26, s74
  s_add_u32 s61, s76, 2
  s_cmp_ge_u32 s77, s61
  s_cselect_b32 s60, s60, 0x40000000
  s_cmp_ge_u32 s53, 62
  s_cselect_b32 s60, 0x40000000, s60
  s_add_u32 s61, s75, -6144
  s_cmp_eq_u32 s51, 3
  s_cselect_b32 s42, s61, s60
  s_lshr_b32 s60, s79, 1
  s_add_u32 m0, s60, 162816
  v_lshrrev_b32 v68, 2, v1
  v_add_u32 v69, 64, v68
  v_bfe_i32 v69, v69, 7, 1
  v_and_b32 v69, 192, v69
  v_xor_b32 v68, v68, v69
  s_cmp_ge_u32 s70, 72
  s_cbranch_scc1 CH_F2
  v_mov_b32 v11, 0x3f80
  v_cndmask_b32 v11, v11, 1.0, s[98:99]
  s_lshl_b64 s[62:63], s[96:97], 0
  v_cndmask_b32 v44, 0, v11, s[62:63]
  s_lshl_b64 s[62:63], s[96:97], 2
  v_cndmask_b32 v45, 0, v11, s[62:63]
  s_lshl_b64 s[62:63], s[96:97], 4
  v_cndmask_b32 v46, 0, v11, s[62:63]
  s_lshl_b64 s[62:63], s[96:97], 6
  v_cndmask_b32 v47, 0, v11, s[62:63]
  s_mov_b32 s55, 400031
  s_cmp_eq_u32 s51, 2
  s_cbranch_scc1 CH_P1V
  s_waitcnt vmcnt(0)
CH_P1:
  buffer_load_dwordx4 v[28:31], v1, s[4:7], s71 offen offset:0 sc1
  buffer_load_dwordx4 v[32:35], v1, s[4:7], s71 offen offset:1024 sc1
  buffer_load_dwordx4 v[36:39], v1, s[4:7], s71 offen offset:2048 sc1
  buffer_load_dwordx4 v[40:43], v1, s[4:7], s71 offen offset:3072 sc1
  s_waitcnt vmcnt(3)
  v_mfma_f32_16x16x32_bf16 v[48:51], v[44:47], v[28:31], 0
  s_waitcnt vmcnt(2)
  v_mfma_f32_16x16x32_bf16 v[48:51], v[44:47], v[32:35], v[48:51]
  s_waitcnt vmcnt(1)
  v_mfma_f32_16x16x32_bf16 v[48:51], v[44:47], v[36:39], v[48:51]
  s_waitcnt vmcnt(0)
  v_mfma_f32_16x16x32_bf16 v[48:51], v[44:47], v[40:43], v[48:51]
  v_bitop3_b32 v69, v28, v32, s69 bitop3:0x7e
  v_bitop3_b32 v70, v36, v40, s69 bitop3:0x7e
  v_bitop3_b32 v69, v69, v70, 1 bitop3:0xa8
  v_cmp_ne_u32 vcc, 0, v69
  s_nop 0
  s_cbranch_vccnz CH_R1
CH_G1:
  s_nop 1
  v_add_f32_dpp v48, v48, v48 row_ror:8 row_mask:0xf bank_mask:0xf
  v_add_f32_dpp v49, v49, v49 row_ror:8 row_mask:0xf bank_mask:0xf
  v_add_f32_dpp v50, v50, v50 row_ror:8 row_mask:0xf bank_mask:0xf
  v_add_f32_dpp v51, v51, v51 row_ror:8 row_mask:0xf bank_mask:0xf
  v_cvt_pk_bf16_f32 v48, v48, v49
  v_and_or_b32 v48, v48, -2, s69
  v_cvt_pk_bf16_f32 v49, v50, v51
  v_and_or_b32 v49, v49, -2, s69
  buffer_store_dwordx2 v[48:49], v7, s[4:7], 0 offen
CH_F2:
  ds_read_b128 v[28:31], v2 offset:0
  ds_read_b128 v[32:35], v2 offset:1024
  ds_read_b128 v[36:39], v2 offset:2048
  ds_read_b128 v[40:43], v2 offset:3072
  ds_read_b128 v[52:55], v2 offset:4096
  ds_read_b128 v[56:59], v2 offset:5120
  s_branch CH_STEP
CH_R1:
  s_mov_b64 exec, vcc
  buffer_load_dwordx4 v[28:31], v1, s[4:7], s71 offen offset:0 sc1
  buffer_load_dwordx4 v[32:35], v1, s[4:7], s71 offen offset:1024 sc1
  buffer_load_dwordx4 v[36:39], v1, s[4:7], s71 offen offset:2048 sc1
  buffer_load_dwordx4 v[40:43], v1, s[4:7], s71 offen offset:3072 sc1
  s_and_b32 s60, s55, 31
  s_cbranch_scc1 nowb_5
  buffer_wbl2 sc1
  s_waitcnt vmcnt(0)
nowb_5:
  s_mov_b32 s58, 5
  s_sub_u32 s55, s55, 1
  s_cbranch_scc0 CH_X1
  s_branch ABORT
CH_X1:
  s_mov_b64 exec, -1
  s_waitcnt vmcnt(3)
  v_mfma_f32_16x16x32_bf16 v[48:51], v[44:47], v[28:31], 0
  s_waitcnt vmcnt(2)
  v_mfma_f32_16x16x32_bf16 v[48:51], v[44:47], v[32:35], v[48:51]
  s_waitcnt vmcnt(1)
  v_mfma_f32_16x16x32_bf16 v[48:51], v[44:47], v[36:39], v[48:51]
  s_waitcnt vmcnt(0)
  v_mfma_f32_16x16x32_bf16 v[48:51], v[44:47], v[40:43], v[48:51]
  v_bitop3_b32 v69, v28, v32, s69 bitop3:0x7e
  v_bitop3_b32 v70, v36, v40, s69 bitop3:0x7e
  v_bitop3_b32 v69, v69, v70, 1 bitop3:0xa8
  v_cmp_ne_u32 vcc, 0, v69
  s_nop 0
  s_cbranch_vccz CH_G1
  s_branch CH_R1
CH_P1V:
  v_swap_b32 v45, v46
CH_P1W:
  buffer_load_dwordx4 v[28:31], v1, s[4:7], s71 offen offset:0 sc1
  buffer_load_dwordx4 v[32:35], v1, s[4:7], s71 offen offset:1024 sc1
  buffer_load_dwordx4 v[36:39], v1, s[4:7], s71 offen offset:2048 sc1
  buffer_load_dwordx4 v[40:43], v1, s[4:7], s71 offen offset:3072 sc1
  s_waitcnt vmcnt(3)
  v_mfma_f32_16x16x32_bf16 v[48:51], v[44:47], v[28:31], 0
  s_waitcnt vmcnt(2)
  v_mfma_f32_16x16x32_bf16 v[48:51], v[44:47], v[32:35], v[48:51]
  s_waitcnt vmcnt(1)
  v_mfma_f32_16x16x32_bf16 v[48:51], v[44:47], v[36:39], v[48:51]
  s_waitcnt vmcnt(0)
  v_mfma_f32_16x16x32_bf16 v[48:51], v[44:47], v[40:43], v[48:51]
  v_bitop3_b32 v69, v28, v29, s69 bitop3:0x7e
  v_bitop3_b32 v70, v30, v31, s69 bitop3:0x7e
  v_bitop3_b32 v71, v32, v33, s69 bitop3:0x7e
  v_or3_b32 v69, v69, v70, v71
  v_bitop3_b32 v70, v34, v35, s69 bitop3:0x7e
  v_bitop3_b32 v71, v36, v37, s69 bitop3:0x7e
  v_or3_b32 v69, v69, v70, v71
  v_bitop3_b32 v70, v38, v39, s69 bitop3:0x7e
  v_bitop3_b32 v71, v40, v41, s69 bitop3:0x7e
  v_or3_b32 v69, v69, v70, v71
  v_bitop3_b32 v70, v42, v43, s69 bitop3:0x7e
  v_bitop3_b32 v69, v69, v70, 1 bitop3:0xa8
  v_cmp_ne_u32 vcc, 0, v69
  s_nop 0
  s_cbranch_vccz CH_G1
  s_and_b32 s60, s55, 31
  s_cbranch_scc1 nowb_6
  buffer_wbl2 sc1
  s_waitcnt vmcnt(0)
nowb_6:
  s_mov_b32 s58, 5
  s_sub_u32 s55, s55, 1
  s_cbranch_scc0 CH_P1W
  s_branch ABORT
CH_K0:
  s_add_u32 s63, s76, 1
  v_bfe_u32 v66, v1, 4, 1
  v_lshlrev_b32 v66, 11, v66
  s_add_u32 s61, s75, -4096
  s_mov_b32 s55, 150000
poll_7:
  buffer_load_dword v67, v66, s[4:7], s61 offen sc1
  s_waitcnt vmcnt(0)
  v_cmp_gt_u32 vcc, s63, v67
  s_nop 0
  s_cbranch_vccz pdone_8
  s_sleep 1
  s_mov_b32 s58, 3
  s_sub_u32 s55, s55, 1
  s_cbranch_scc0 poll_7
  s_branch ABORT
pdone_8:
  v_readlane_b32 s60, v67, 0
  v_readlane_b32 s61, v67, 1
  s_nop 0
  s_min_u32 s77, s60, s61
  s_add_u32 s64, s74, -16777216
  s_add_u32 m0, s78, 15360
  v_and_b32 v11, -128, v1
  v_add_u32 v11, v11, v1
  buffer_load_dwordx4 v11, s[4:7], s64 offen sc1 lds
  s_add_u32 m0, m0, 896
  s_nop 0
  buffer_load_dwordx4 v11, s[4:7], s64 offen offset:128 sc1 lds
  v_and_b32 v11, -256, v1
  v_add_u32 v11, v11, v1
  buffer_load_dwordx4 v[60:63], v11, s[4:7], s74 offen sc1
  buffer_load_dwordx4 v[64:67], v11, s[4:7], s74 offen offset:256 sc1
  s_waitcnt vmcnt(2)
  s_barrier
  s_branch CH_K0R
CH_KS:
  v_mov_b32 v48, 163584
  ds_read_b32 v49, v48 offset:8
  ds_read_b32 v48, v48 offset:4
  s_waitcnt lgkmcnt(0)
  v_min_u32 v48, v48, v49
  s_nop 0
  v_readfirstlane_b32 s60, v48
  s_nop 0
  s_max_u32 s77, s77, s60
  s_cmp_ge_u32 s77, s63
  s_cbranch_scc1 CH_KR
  v_bfe_u32 v48, v1, 4, 1
  v_lshlrev_b32 v48, 11, v48
  s_add_u32 s61, s75, -4096
  s_mov_b32 s55, 150000
poll_9:
  buffer_load_dword v49, v48, s[4:7], s61 offen sc1
  s_waitcnt vmcnt(0)
  v_cmp_gt_u32 vcc, s63, v49
  s_nop 0
  s_cbranch_vccz pdone_10
  s_sleep 1
  s_mov_b32 s58, 3
  s_sub_u32 s55, s55, 1
  s_cbranch_scc0 poll_9
  s_branch ABORT
pdone_10:
  v_readlane_b32 s60, v49, 0
  v_readlane_b32 s61, v49, 1
  s_nop 0
  s_min_u32 s77, s60, s61
  s_branch CH_KR
CH_LAST:
  s_waitcnt lgkmcnt(0)
  v_lshrrev_b32 v30, 1, v1
  v_add_u32 v28, s79, v30
  v_lshrrev_b32 v29, 3, v28
  v_and_b32 v29, 96, v29
  v_xor_b32 v28, v28, v29
  ds_read_b64 v[28:29], v28 offset:13312
  v_mov_b32 v31, s76
  s_mov_b32 s29, s72
  s_add_u32 s72, s72, 65536
  s_waitcnt lgkmcnt(0)
  buffer_store_dwordx2 v[28:29], v30, s[4:7], s29 offen sc1
  s_waitcnt vmcnt(0) lgkmcnt(0)
  s_barrier
  s_add_u32 s76, s76, 1
  s_cmp_eq_u32 s51, 3
  s_cselect_b32 s60, s75, 0x40003100
  s_mov_b64 exec, 1
  v_mov_b32 v11, 0
  v_mov_b32 v68, s76
  buffer_store_dword v68, v11, s[4:7], s60 offen sc1
  s_mov_b64 exec, -1
  s_cmp_lg_u32 s51, 0
  s_cbranch_scc1 CH_NWB
  v_lshlrev_b32 v11, 2, v1
  v_and_b32 v11, 0x7c0, v11
  s_mov_b32 s55, 400031
  s_mov_b32 s61, 8192
CH_PE:
  s_sleep 32
  buffer_load_dword v68, v11, s[4:7], s61 offen sc1
  s_waitcnt vmcnt(0)
  v_cmp_gt_u32 vcc, s76, v68
  s_nop 0
  s_cbranch_vccz CH_NWB
  s_and_b32 s60, s55, 31
  s_cbranch_scc1 nowb_11
  buffer_wbl2 sc1
  s_waitcnt vmcnt(0)
nowb_11:
  s_mov_b32 s58, 6
  s_sub_u32 s55, s55, 1
  s_cbranch_scc0 CH_PE
  s_branch ABORT
CH_NWB:
  s_add_u32 s52, s52, 1
  s_mov_b32 s54, 104857600
  s_cmp_lt_u32 s52, 2
  s_cbranch_scc1 CH_LAYER
  s_branch END
WORKER:
  s_sub_u32 s68, s50, 32
  v_lshlrev_b32 v5, 4, v0
  v_lshrrev_b32 v6, 5, v0
  v_and_b32 v7, 31, v0
  v_lshrrev_b32 v8, 3, v0
  s_lshl_b32 s60, s51, 3
  v_add_u32 v8, s60, v8
  v_and_b32 v9, 7, v0
  v_mul_u32_u24 v1, 1152, v8
  v_lshl_add_u32 v1, v9, 4, v1
  v_mul_u32_u24 v2, 528, v9
  v_lshl_add_u32 v2, v8, 4, v2
  v_mul_u32_u24 v3, 528, v6
  v_lshl_add_u32 v3, v7, 4, v3
  s_mov_b32 s96, 0
  s_mov_b32 s97, -1
  s_mov_b32 s52, 0
  s_mov_b32 s53, 0
  s_mov_b32 s76, 0
  s_mov_b32 s54, 4194304
  s_cmp_ge_u32 s68, 216
  s_cbranch_scc1 END
  s_cmp_ge_u32 s68, 192
  s_cbranch_scc1 R_ATT
  s_lshr_b32 s53, s68, 3
  s_cmp_lt_u32 s53, 12
  s_cselect_b32 s60, 12, -12
  s_add_u32 s53, s53, s60
  s_mov_b32 s69, 24
  s_mul_i32 s60, s53, 36864
  buffer_load_dwordx4 v[20:23], v1, s[8:11], s60 offen offset:0 sc1
  buffer_load_dwordx4 v[24:27], v1, s[8:11], s60 offen offset:128 sc1
  buffer_load_dwordx4 v[28:31], v1, s[8:11], s60 offen offset:256 sc1
  buffer_load_dwordx4 v[32:35], v1, s[8:11], s60 offen offset:384 sc1
  buffer_load_dwordx4 v[36:39], v1, s[8:11], s60 offen offset:512 sc1
  buffer_load_dwordx4 v[40:43], v1, s[8:11], s60 offen offset:640 sc1
  buffer_load_dwordx4 v[44:47], v1, s[8:11], s60 offen offset:768 sc1
  buffer_load_dwordx4 v[48:51], v1, s[8:11], s60 offen offset:896 sc1
  buffer_load_dwordx4 v[52:55], v1, s[8:11], s60 offen offset:1024 sc1
  s_and_b32 s72, s68, 7
  s_and_b32 s73, s51, 1
  s_lshl_b32 s73, s73, 1
  v_add_u32 v8, s73, v6
  v_lshlrev_b32 v8, 2, v8
  v_xor_b32 v8, v8, v7
  v_min_u32 v8, 26, v8
  v_mul_u32_u24 v9, 57, v8
  v_lshrrev_b32 v9, 9, v9
  v_mul_u32_u24 v9, 1008, v9
  v_lshl_add_u32 v9, v8, 4, v9
  v_mul_u32_u24 v8, 3456, v6
  v_add_u32 v18, v8, v9
  s_mul_i32 s74, s72, 144
  s_mul_i32 s60, s51, 6912
  s_add_u32 s74, s74, s60
  s_mul_i32 s75, s51, 18
  s_sub_u32 s62, s75, s73
  s_lshl_b32 s62, s62, 1
  v_bfe_u32 v8, v0, 4, 1
  v_bfe_u32 v9, v0, 2, 2
  v_and_b32 v10, 3, v0
  v_lshl_add_u32 v8, v8, 2, v10
  v_cmp_gt_u32 vcc, 5, v8
  v_mov_b32 v10, -40
  v_mov_b32 v11, 144
  v_cndmask_b32 v10, v10, v11, vcc
  v_min_u32 v11, 7, v8
  v_lshl_add_u32 v10, v11, 3, v10
  v_add_u32 v10, s62, v10
  v_lshlrev_b32 v11, 6, v9
  v_xor_b32 v10, v10, v11
  v_lshl_add_u32 v10, v9, 9, v10
  v_lshl_add_u32 v12, v6, 12, v10
  v_mov_b32 v10, -16
  v_mov_b32 v11, 288
  v_cndmask_b32 v10, v10, v11, vcc
  v_min_u32 v11, 6, v8
  v_lshl_add_u32 v10, v11, 3, v10
  v_add_u32 v10, s62, v10
  v_lshlrev_b32 v11, 6, v9
  v_xor_b32 v10, v10, v11
  v_lshl_add_u32 v10, v9, 9, v10
  v_lshl_add_u32 v13, v6, 12, v10
  s_lshl_b32 s61, s51, 10
  s_mov_b32 m0, s61
  s_add_u32 s61, s61, 4096
  buffer_load_dwordx4 v18, s[12:15], s74 offen  lds
  s_add_u32 s74, s74, 27648
  s_mov_b32 m0, s61
  s_add_u32 s61, s61, 4096
  buffer_load_dwordx4 v18, s[12:15], s74 offen  lds
  s_add_u32 s74, s74, 27648
  s_mov_b32 m0, s61
  s_add_u32 s61, s61, 4096
  buffer_load_dwordx4 v18, s[12:15], s74 offen  lds
  s_add_u32 s74, s74, 27648
  s_mov_b32 m0, s61
  s_add_u32 s61, s61, 4096
  buffer_load_dwordx4 v18, s[12:15], s74 offen  lds
  s_add_u32 s74, s74, 27648
  s_mov_b32 m0, s61
  s_add_u32 s61, s61, 4096
  buffer_load_dwordx4 v18, s[12:15], s74 offen  lds
  s_add_u32 s74, s74, 27648
  s_mov_b32 m0, s61
  s_add_u32 s61, s61, 4096
  buffer_load_dwordx4 v18, s[12:15], s74 offen  lds
  s_add_u32 s74, s74, 27648
  s_mov_b32 m0, s61
  s_add_u32 s61, s61, 4096
  buffer_load_dwordx4 v18, s[12:15], s74 offen  lds
  s_add_u32 s74, s74, 27648
  s_mov_b32 m0, s61
  s_add_u32 s61, s61, 4096
  buffer_load_dwordx4 v18, s[12:15], s74 offen  lds
  s_add_u32 s74, s74, 27648
  s_mov_b32 m0, s61
  s_add_u32 s61, s61, 4096
  buffer_load_dwordx4 v18, s[12:15], s74 offen  lds
  s_add_u32 s74, s74, 27648
  s_mov_b32 m0, s61
  s_add_u32 s61, s61, 4096
  buffer_load_dwordx4 v18, s[12:15], s74 offen  lds
  s_add_u32 s74, s74, 27648
  s_mov_b32 m0, s61
  s_add_u32 s61, s61, 4096
  buffer_load_dwordx4 v18, s[12:15], s74 offen  lds
  s_add_u32 s74, s74, 27648
  s_mov_b32 m0, s61
  s_add_u32 s61, s61, 4096
  buffer_load_dwordx4 v18, s[12:15], s74 offen  lds
  s_add_u32 s74, s74, 27648
  s_mov_b32 m0, s61
  s_add_u32 s61, s61, 4096
  buffer_load_dwordx4 v18, s[12:15], s74 offen  lds
  s_add_u32 s74, s74, 27648
  s_mov_b32 m0, s61
  s_add_u32 s61, s61, 4096
  buffer_load_dwordx4 v18, s[12:15], s74 offen  lds
  s_add_u32 s74, s74, 27648
  s_mov_b32 m0, s61
  s_add_u32 s61, s61, 4096
  buffer_load_dwordx4 v18, s[12:15], s74 offen  lds
  s_add_u32 s74, s74, 27648
  s_mov_b32 m0, s61
  s_add_u32 s61, s61, 4096
  buffer_load_dwordx4 v18, s[12:15], s74 offen  lds
  s_add_u32 s74, s74, 27648
  s_mov_b32 m0, s61
  s_add_u32 s61, s61, 4096
  buffer_load_dwordx4 v18, s[12:15], s74 offen  lds
  s_add_u32 s74, s74, 27648
  s_mov_b32 m0, s61
  s_add_u32 s61, s61, 4096
  buffer_load_dwordx4 v18, s[12:15], s74 offen  lds
  s_add_u32 s74, s74, 27648
  s_mov_b32 m0, s61
  s_add_u32 s61, s61, 4096
  buffer_load_dwordx4 v18, s[12:15], s74 offen  lds
  s_add_u32 s74, s74, 27648
  s_mov_b32 m0, s61
  s_add_u32 s61, s61, 4096
  buffer_load_dwordx4 v18, s[12:15], s74 offen  lds
  s_add_u32 s74, s74, 27648
  s_mov_b32 m0, s61
  s_add_u32 s61, s61, 4096
  buffer_load_dwordx4 v18, s[12:15], s74 offen  lds
  s_add_u32 s74, s74, 27648
  s_mov_b32 m0, s61
  s_add_u32 s61, s61, 4096
  buffer_load_dwordx4 v18, s[12:15], s74 offen  lds
  s_add_u32 s74, s74, 27648
  s_mov_b32 m0, s61
  s_add_u32 s61, s61, 4096
  buffer_load_dwordx4 v18, s[12:15], s74 offen  lds
  s_add_u32 s74, s74, 27648
  s_mov_b32 m0, s61
  s_add_u32 s61, s61, 4096
  buffer_load_dwordx4 v18, s[12:15], s74 offen  lds
  s_add_u32 s74, s74, 27648
  s_mov_b32 m0, s61
  s_add_u32 s61, s61, 4096
  buffer_load_dwordx4 v18, s[12:15], s74 offen  lds
  s_add_u32 s74, s74, 27648
  s_mov_b32 m0, s61
  s_add_u32 s61, s61, 4096
  buffer_load_dwordx4 v18, s[12:15], s74 offen  lds
  s_add_u32 s74, s74, 27648
  s_mov_b32 m0, s61
  s_add_u32 s61, s61, 4096
  buffer_load_dwordx4 v18, s[12:15], s74 offen  lds
  s_add_u32 s74, s74, 27648
  s_mov_b32 m0, s61
  s_add_u32 s61, s61, 4096
  buffer_load_dwordx4 v18, s[12:15], s74 offen  lds
  s_add_u32 s74, s74, 27648
  s_mov_b32 m0, s61
  s_add_u32 s61, s61, 4096
  buffer_load_dwordx4 v18, s[12:15], s74 offen  lds
  s_add_u32 s74, s74, 27648
  s_mov_b32 m0, s61
  s_add_u32 s61, s61, 4096
  buffer_load_dwordx4 v18, s[12:15], s74 offen  lds
  s_add_u32 s74, s74, 27648
  s_mov_b32 m0, s61
  s_add_u32 s61, s61, 4096
  buffer_load_dwordx4 v18, s[12:15], s74 offen  lds
  s_add_u32 s74, s74, 27648
  s_mov_b32 m0, s61
  s_add_u32 s61, s61, 4096
  buffer_load_dwordx4 v18, s[12:15], s74 offen  lds
  s_add_u32 s74, s74, 27648
  s_mov_b32 m0, s61
  s_add_u32 s61, s61, 4096
  buffer_load_dwordx4 v18, s[12:15], s74 offen  lds
  s_add_u32 s74, s74, 27648
  s_mov_b32 m0, s61
  s_add_u32 s61, s61, 4096
  buffer_load_dwordx4 v18, s[12:15], s74 offen  lds
  s_add_u32 s74, s74, 27648
  s_mov_b32 m0, s61
  s_add_u32 s61, s61, 4096
  buffer_load_dwordx4 v18, s[12:15], s74 offen  lds
  s_add_u32 s74, s74, 27648
  s_mov_b32 m0, s61
  s_add_u32 s61, s61, 4096
  buffer_load_dwordx4 v18, s[12:15], s74 offen  lds
  s_add_u32 s74, s74, 27648
  s_waitcnt vmcnt(36)
  v_lshlrev_b32 v56, 16, v20
  v_and_b32 v57, 0xffff0000, v20
  v_lshlrev_b32 v58, 16, v21
  v_and_b32 v59, 0xffff0000, v21
  v_lshlrev_b32 v60, 16, v22
  v_and_b32 v61, 0xffff0000, v22
  v_lshlrev_b32 v62, 16, v23
  v_and_b32 v63, 0xffff0000, v23
  v_lshlrev_b32 v64, 16, v24
  v_and_b32 v65, 0xffff0000, v24
  v_lshlrev_b32 v66, 16, v25
  v_and_b32 v67, 0xffff0000, v25
  v_lshlrev_b32 v68, 16, v26
  v_and_b32 v69, 0xffff0000, v26
  v_lshlrev_b32 v70, 16, v27
  v_and_b32 v71, 0xffff0000, v27
  v_lshlrev_b32 v72, 16, v28
  v_and_b32 v73, 0xffff0000, v28
  v_lshlrev_b32 v74, 16, v29
  v_and_b32 v75, 0xffff0000, v29
  v_lshlrev_b32 v76, 16, v30
  v_and_b32 v77, 0xffff0000, v30
  v_lshlrev_b32 v78, 16, v31
  v_and_b32 v79, 0xffff0000, v31
  v_lshlrev_b32 v80, 16, v32
  v_and_b32 v81, 0xffff0000, v32
  v_lshlrev_b32 v82, 16, v33
  v_and_b32 v83, 0xffff0000, v33
  v_lshlrev_b32 v84, 16, v34
  v_and_b32 v85, 0xffff0000, v34
  v_lshlrev_b32 v86, 16, v35
  v_and_b32 v87, 0xffff0000, v35
  v_lshlrev_b32 v88, 16, v36
  v_and_b32 v89, 0xffff0000, v36
  v_lshlrev_b32 v90, 16, v37
  v_and_b32 v91, 0xffff0000, v37
  v_lshlrev_b32 v92, 16, v38
  v_and_b32 v93, 0xffff0000, v38
  v_lshlrev_b32 v94, 16, v39
  v_and_b32 v95, 0xffff0000, v39
  v_lshlrev_b32 v96, 16, v40
  v_and_b32 v97, 0xffff0000, v40
  v_lshlrev_b32 v98, 16, v41
  v_and_b32 v99, 0xffff0000, v41
  v_lshlrev_b32 v100, 16, v42
  v_and_b32 v101, 0xffff0000, v42
  v_lshlrev_b32 v102, 16, v43
  v_and_b32 v103, 0xffff0000, v43
  v_lshlrev_b32 v104, 16, v44
  v_and_b32 v105, 0xffff0000, v44
  v_lshlrev_b32 v106, 16, v45
  v_and_b32 v107, 0xffff0000, v45
  v_lshlrev_b32 v108, 16, v46
  v_and_b32 v109, 0xffff0000, v46
  v_lshlrev_b32 v110, 16, v47
  v_and_b32 v111, 0xffff0000, v47
  v_lshlrev_b32 v112, 16, v48
  v_and_b32 v113, 0xffff0000, v48
  v_lshlrev_b32 v114, 16, v49
  v_and_b32 v115, 0xffff0000, v49
  v_lshlrev_b32 v116, 16, v50
  v_and_b32 v117, 0xffff0000, v50
  v_lshlrev_b32 v118, 16, v51
  v_and_b32 v119, 0xffff0000, v51
  v_lshlrev_b32 v120, 16, v52
  v_and_b32 v121, 0xffff0000, v52
  v_lshlrev_b32 v122, 16, v53
  v_and_b32 v123, 0xffff0000, v53
  v_lshlrev_b32 v124, 16, v54
  v_and_b32 v125, 0xffff0000, v54
  v_lshlrev_b32 v126, 16, v55
  v_and_b32 v127, 0xffff0000, v55
  v_pk_add_f32 v[8:9], v[56:57], v[58:59]
  v_pk_add_f32 v[10:11], v[60:61], v[62:63]
  v_pk_add_f32 v[8:9], v[8:9], v[64:65]
  v_pk_add_f32 v[10:11], v[10:11], v[66:67]
  v_pk_add_f32 v[8:9], v[8:9], v[68:69]
  v_pk_add_f32 v[10:11], v[10:11], v[70:71]
  v_pk_add_f32 v[8:9], v[8:9], v[72:73]
  v_pk_add_f32 v[10:11], v[10:11], v[74:75]
  v_pk_add_f32 v[8:9], v[8:9], v[76:77]
  v_pk_add_f32 v[10:11], v[10:11], v[78:79]
  v_pk_add_f32 v[8:9], v[8:9], v[80:81]
  v_pk_add_f32 v[10:11], v[10:11], v[82:83]
  v_pk_add_f32 v[8:9], v[8:9], v[84:85]
  v_pk_add_f32 v[10:11], v[10:11], v[86:87]
  v_pk_add_f32 v[8:9], v[8:9], v[88:89]
  v_pk_add_f32 v[10:11], v[10:11], v[90:91]
  v_pk_add_f32 v[8:9], v[8:9], v[92:93]
  v_pk_add_f32 v[10:11], v[10:11], v[94:95]
  v_pk_add_f32 v[8:9], v[8:9], v[96:97]
  v_pk_add_f32 v[10:11], v[10:11], v[98:99]
  v_pk_add_f32 v[8:9], v[8:9], v[100:101]
  v_pk_add_f32 v[10:11], v[10:11], v[102:103]
  v_pk_add_f32 v[8:9], v[8:9], v[104:105]
  v_pk_add_f32 v[10:11], v[10:11], v[106:107]
  v_pk_add_f32 v[8:9], v[8:9], v[108:109]
  v_pk_add_f32 v[10:11], v[10:11], v[110:111]
  v_pk_add_f32 v[8:9], v[8:9], v[112:113]
  v_pk_add_f32 v[10:11], v[10:11], v[114:115]
  v_pk_add_f32 v[8:9], v[8:9], v[116:117]
  v_pk_add_f32 v[10:11], v[10:11], v[118:119]
  v_pk_add_f32 v[8:9], v[8:9], v[120:121]
  v_pk_add_f32 v[10:11], v[10:11], v[122:123]
  v_pk_add_f32 v[8:9], v[8:9], v[124:125]
  v_pk_add_f32 v[10:11], v[10:11], v[126:127]
  v_pk_add_f32 v[8:9], v[8:9], v[10:11]
  v_add_f32 v8, v8, v9
  s_nop 1
  v_add_f32_dpp v8, v8, v8 quad_perm:[1,0,3,2] row_mask:0xf bank_mask:0xf
  s_nop 1
  v_add_f32_dpp v8, v8, v8 quad_perm:[2,3,0,1] row_mask:0xf bank_mask:0xf
  s_nop 1
  v_add_f32_dpp v8, v8, v8 row_half_mirror row_mask:0xf bank_mask:0xf
  v_mul_f32 v8, 0xbae38e39, v8
  v_pk_add_f32 v[56:57], v[56:57], v[8:9] op_sel_hi:[1,0]
  v_pk_add_f32 v[58:59], v[58:59], v[8:9] op_sel_hi:[1,0]
  v_pk_add_f32 v[60:61], v[60:61], v[8:9] op_sel_hi:[1,0]
  v_pk_add_f32 v[62:63], v[62:63], v[8:9] op_sel_hi:[1,0]
  v_pk_add_f32 v[64:65], v[64:65], v[8:9] op_sel_hi:[1,0]
  v_pk_add_f32 v[66:67], v[66:67], v[8:9] op_sel_hi:[1,0]
  v_pk_add_f32 v[68:69], v[68:69], v[8:9] op_sel_hi:[1,0]
  v_pk_add_f32 v[70:71], v[70:71], v[8:9] op_sel_hi:[1,0]
  v_pk_add_f32 v[72:73], v[72:73], v[8:9] op_sel_hi:[1,0]
  v_pk_add_f32 v[74:75], v[74:75], v[8:9] op_sel_hi:[1,0]
  v_pk_add_f32 v[76:77], v[76:77], v[8:9] op_sel_hi:[1,0]
  v_pk_add_f32 v[78:79], v[78:79], v[8:9] op_sel_hi:[1,0]
  v_pk_add_f32 v[80:81], v[80:81], v[8:9] op_sel_hi:[1,0]
  v_pk_add_f32 v[82:83], v[82:83], v[8:9] op_sel_hi:[1,0]
  v_pk_add_f32 v[84:85], v[84:85], v[8:9] op_sel_hi:[1,0]
  v_pk_add_f32 v[86:87], v[86:87], v[8:9] op_sel_hi:[1,0]
  v_pk_add_f32 v[88:89], v[88:89], v[8:9] op_sel_hi:[1,0]
  v_pk_add_f32 v[90:91], v[90:91], v[8:9] op_sel_hi:[1,0]
  v_pk_add_f32 v[92:93], v[92:93], v[8:9] op_sel_hi:[1,0]
  v_pk_add_f32 v[94:95], v[94:95], v[8:9] op_sel_hi:[1,0]
  v_pk_add_f32 v[96:97], v[96:97], v[8:9] op_sel_hi:[1,0]
  v_pk_add_f32 v[98:99], v[98:99], v[8:9] op_sel_hi:[1,0]
  v_pk_add_f32 v[100:101], v[100:101], v[8:9] op_sel_hi:[1,0]
  v_pk_add_f32 v[102:103], v[102:103], v[8:9] op_sel_hi:[1,0]
  v_pk_add_f32 v[104:105], v[104:105], v[8:9] op_sel_hi:[1,0]
  v_pk_add_f32 v[106:107], v[106:107], v[8:9] op_sel_hi:[1,0]
  v_pk_add_f32 v[108:109], v[108:109], v[8:9] op_sel_hi:[1,0]
  v_pk_add_f32 v[110:111], v[110:111], v[8:9] op_sel_hi:[1,0]
  v_pk_add_f32 v[112:113], v[112:113], v[8:9] op_sel_hi:[1,0]
  v_pk_add_f32 v[114:115], v[114:115], v[8:9] op_sel_hi:[1,0]
  v_pk_add_f32 v[116:117], v[116:117], v[8:9] op_sel_hi:[1,0]
  v_pk_add_f32 v[118:119], v[118:119], v[8:9] op_sel_hi:[1,0]
  v_pk_add_f32 v[120:121], v[120:121], v[8:9] op_sel_hi:[1,0]
  v_pk_add_f32 v[122:123], v[122:123], v[8:9] op_sel_hi:[1,0]
  v_pk_add_f32 v[124:125], v[124:125], v[8:9] op_sel_hi:[1,0]
  v_pk_add_f32 v[126:127], v[126:127], v[8:9] op_sel_hi:[1,0]
  v_pk_mul_f32 v[8:9], v[56:57], v[56:57]
  v_pk_mul_f32 v[10:11], v[58:59], v[58:59]
  v_pk_fma_f32 v[8:9], v[60:61], v[60:61], v[8:9]
  v_pk_fma_f32 v[10:11], v[62:63], v[62:63], v[10:11]
  v_pk_fma_f32 v[8:9], v[64:65], v[64:65], v[8:9]
  v_pk_fma_f32 v[10:11], v[66:67], v[66:67], v[10:11]
  v_pk_fma_f32 v[8:9], v[68:69], v[68:69], v[8:9]
  v_pk_fma_f32 v[10:11], v[70:71], v[70:71], v[10:11]
  v_pk_fma_f32 v[8:9], v[72:73], v[72:73], v[8:9]
  v_pk_fma_f32 v[10:11], v[74:75], v[74:75], v[10:11]
  v_pk_fma_f32 v[8:9], v[76:77], v[76:77], v[8:9]
  v_pk_fma_f32 v[10:11], v[78:79], v[78:79], v[10:11]
  v_pk_fma_f32 v[8:9], v[80:81], v[80:81], v[8:9]
  v_pk_fma_f32 v[10:11], v[82:83], v[82:83], v[10:11]
  v_pk_fma_f32 v[8:9], v[84:85], v[84:85], v[8:9]
  v_pk_fma_f32 v[10:11], v[86:87], v[86:87], v[10:11]
  v_pk_fma_f32 v[8:9], v[88:89], v[88:89], v[8:9]
  v_pk_fma_f32 v[10:11], v[90:91], v[90:91], v[10:11]
  v_pk_fma_f32 v[8:9], v[92:93], v[92:93], v[8:9]
  v_pk_fma_f32 v[10:11], v[94:95], v[94:95], v[10:11]
  v_pk_fma_f32 v[8:9], v[96:97], v[96:97], v[8:9]
  v_pk_fma_f32 v[10:11], v[98:99], v[98:99], v[10:11]
  v_pk_fma_f32 v[8:9], v[100:101], v[100:101], v[8:9]
  v_pk_fma_f32 v[10:11], v[102:103], v[102:103], v[10:11]
  v_pk_fma_f32 v[8:9], v[104:105], v[104:105], v[8:9]
  v_pk_fma_f32 v[10:11], v[106:107], v[106:107], v[10:11]
  v_pk_fma_f32 v[8:9], v[108:109], v[108:109], v[8:9]
  v_pk_fma_f32 v[10:11], v[110:111], v[110:111], v[10:11]
  v_pk_fma_f32 v[8:9], v[112:113], v[112:113], v[8:9]
  v_pk_fma_f32 v[10:11], v[114:115], v[114:115], v[10:11]
  v_pk_fma_f32 v[8:9], v[116:117], v[116:117], v[8:9]
  v_pk_fma_f32 v[10:11], v[118:119], v[118:119], v[10:11]
  v_pk_fma_f32 v[8:9], v[120:121], v[120:121], v[8:9]
  v_pk_fma_f32 v[10:11], v[122:123], v[122:123], v[10:11]
  v_pk_fma_f32 v[8:9], v[124:125], v[124:125], v[8:9]
  v_pk_fma_f32 v[10:11], v[126:127], v[126:127], v[10:11]
  v_pk_add_f32 v[8:9], v[8:9], v[10:11]
  v_add_f32 v8, v8, v9
  s_nop 1
  v_add_f32_dpp v8, v8, v8 quad_perm:[1,0,3,2] row_mask:0xf bank_mask:0xf
  s_nop 1
  v_add_f32_dpp v8, v8, v8 quad_perm:[2,3,0,1] row_mask:0xf bank_mask:0xf
  s_nop 1
  v_add_f32_dpp v8, v8, v8 row_half_mirror row_mask:0xf bank_mask:0xf
  v_mov_b32 v9, 0x3727c5ac
  v_fmac_f32 v9, 0x3ae38e39, v8
  v_rsq_f32 v8, v9
  s_nop 0
  v_pk_mul_f32 v[56:57], v[56:57], v[8:9] op_sel_hi:[1,0]
  v_cvt_pk_bf16_f32 v128, v56, v57
  v_pk_mul_f32 v[58:59], v[58:59], v[8:9] op_sel_hi:[1,0]
  v_cvt_pk_bf16_f32 v129, v58, v59
  v_pk_mul_f32 v[60:61], v[60:61], v[8:9] op_sel_hi:[1,0]
  v_cvt_pk_bf16_f32 v130, v60, v61
  v_pk_mul_f32 v[62:63], v[62:63], v[8:9] op_sel_hi:[1,0]
  v_cvt_pk_bf16_f32 v131, v62, v63
  v_pk_mul_f32 v[64:65], v[64:65], v[8:9] op_sel_hi:[1,0]
  v_cvt_pk_bf16_f32 v132, v64, v65
  v_pk_mul_f32 v[66:67], v[66:67], v[8:9] op_sel_hi:[1,0]
  v_cvt_pk_bf16_f32 v133, v66, v67
  v_pk_mul_f32 v[68:69], v[68:69], v[8:9] op_sel_hi:[1,0]
  v_cvt_pk_bf16_f32 v134, v68, v69
  v_pk_mul_f32 v[70:71], v[70:71], v[8:9] op_sel_hi:[1,0]
  v_cvt_pk_bf16_f32 v135, v70, v71
  v_pk_mul_f32 v[72:73], v[72:73], v[8:9] op_sel_hi:[1,0]
  v_cvt_pk_bf16_f32 v136, v72, v73
  v_pk_mul_f32 v[74:75], v[74:75], v[8:9] op_sel_hi:[1,0]
  v_cvt_pk_bf16_f32 v137, v74, v75
  v_pk_mul_f32 v[76:77], v[76:77], v[8:9] op_sel_hi:[1,0]
  v_cvt_pk_bf16_f32 v138, v76, v77
  v_pk_mul_f32 v[78:79], v[78:79], v[8:9] op_sel_hi:[1,0]
  v_cvt_pk_bf16_f32 v139, v78, v79
  v_pk_mul_f32 v[80:81], v[80:81], v[8:9] op_sel_hi:[1,0]
  v_cvt_pk_bf16_f32 v140, v80, v81
  v_pk_mul_f32 v[82:83], v[82:83], v[8:9] op_sel_hi:[1,0]
  v_cvt_pk_bf16_f32 v141, v82, v83
  v_pk_mul_f32 v[84:85], v[84:85], v[8:9] op_sel_hi:[1,0]
  v_cvt_pk_bf16_f32 v142, v84, v85
  v_pk_mul_f32 v[86:87], v[86:87], v[8:9] op_sel_hi:[1,0]
  v_cvt_pk_bf16_f32 v143, v86, v87
  v_pk_mul_f32 v[88:89], v[88:89], v[8:9] op_sel_hi:[1,0]
  v_cvt_pk_bf16_f32 v144, v88, v89
  v_pk_mul_f32 v[90:91], v[90:91], v[8:9] op_sel_hi:[1,0]
  v_cvt_pk_bf16_f32 v145, v90, v91
  v_pk_mul_f32 v[92:93], v[92:93], v[8:9] op_sel_hi:[1,0]
  v_cvt_pk_bf16_f32 v146, v92, v93
  v_pk_mul_f32 v[94:95], v[94:95], v[8:9] op_sel_hi:[1,0]
  v_cvt_pk_bf16_f32 v147, v94, v95
  v_pk_mul_f32 v[96:97], v[96:97], v[8:9] op_sel_hi:[1,0]
  v_cvt_pk_bf16_f32 v148, v96, v97
  v_pk_mul_f32 v[98:99], v[98:99], v[8:9] op_sel_hi:[1,0]
  v_cvt_pk_bf16_f32 v149, v98, v99
  v_pk_mul_f32 v[100:101], v[100:101], v[8:9] op_sel_hi:[1,0]
  v_cvt_pk_bf16_f32 v150, v100, v101
  v_pk_mul_f32 v[102:103], v[102:103], v[8:9] op_sel_hi:[1,0]
  v_cvt_pk_bf16_f32 v151, v102, v103
  v_pk_mul_f32 v[104:105], v[104:105], v[8:9] op_sel_hi:[1,0]
  v_cvt_pk_bf16_f32 v152, v104, v105
  v_pk_mul_f32 v[106:107], v[106:107], v[8:9] op_sel_hi:[1,0]
  v_cvt_pk_bf16_f32 v153, v106, v107
  v_pk_mul_f32 v[108:109], v[108:109], v[8:9] op_sel_hi:[1,0]
  v_cvt_pk_bf16_f32 v154, v108, v109
  v_pk_mul_f32 v[110:111], v[110:111], v[8:9] op_sel_hi:[1,0]
  v_cvt_pk_bf16_f32 v155, v110, v111
  v_pk_mul_f32 v[112:113], v[112:113], v[8:9] op_sel_hi:[1,0]
  v_cvt_pk_bf16_f32 v156, v112, v113
  v_pk_mul_f32 v[114:115], v[114:115], v[8:9] op_sel_hi:[1,0]
  v_cvt_pk_bf16_f32 v157, v114, v115
  v_pk_mul_f32 v[116:117], v[116:117], v[8:9] op_sel_hi:[1,0]
  v_cvt_pk_bf16_f32 v158, v116, v117
  v_pk_mul_f32 v[118:119], v[118:119], v[8:9] op_sel_hi:[1,0]
  v_cvt_pk_bf16_f32 v159, v118, v119
  v_pk_mul_f32 v[120:121], v[120:121], v[8:9] op_sel_hi:[1,0]
  v_cvt_pk_bf16_f32 v160, v120, v121
  v_pk_mul_f32 v[122:123], v[122:123], v[8:9] op_sel_hi:[1,0]
  v_cvt_pk_bf16_f32 v161, v122, v123
  v_pk_mul_f32 v[124:125], v[124:125], v[8:9] op_sel_hi:[1,0]
  v_cvt_pk_bf16_f32 v162, v124, v125
  v_pk_mul_f32 v[126:127], v[126:127], v[8:9] op_sel_hi:[1,0]
  v_cvt_pk_bf16_f32 v163, v126, v127
  v_mov_b32 v8, v12
  v_mov_b32 v9, v13
  s_waitcnt vmcnt(0) lgkmcnt(0)
  s_barrier
  ds_read_b64_tr_b16 a[0:1], v8 offset:0
  ds_read_b64_tr_b16 a[2:3], v8 offset:2048
  ds_read_b64_tr_b16 a[144:145], v9 offset:0
  ds_read_b64_tr_b16 a[146:147], v9 offset:2048
  ds_read_b64_tr_b16 a[4:5], v8 offset:8192
  ds_read_b64_tr_b16 a[6:7], v8 offset:10240
  ds_read_b64_tr_b16 a[148:149], v9 offset:8192
  ds_read_b64_tr_b16 a[150:151], v9 offset:10240
  ds_read_b64_tr_b16 a[8:9], v8 offset:16384
  ds_read_b64_tr_b16 a[10:11], v8 offset:18432
  ds_read_b64_tr_b16 a[152:153], v9 offset:16384
  ds_read_b64_tr_b16 a[154:155], v9 offset:18432
  ds_read_b64_tr_b16 a[12:13], v8 offset:24576
  ds_read_b64_tr_b16 a[14:15], v8 offset:26624
  ds_read_b64_tr_b16 a[156:157], v9 offset:24576
  ds_read_b64_tr_b16 a[158:159], v9 offset:26624
  ds_read_b64_tr_b16 a[16:17], v8 offset:32768
  ds_read_b64_tr_b16 a[18:19], v8 offset:34816
  ds_read_b64_tr_b16 a[160:161], v9 offset:32768
  ds_read_b64_tr_b16 a[162:163], v9 offset:34816
  ds_read_b64_tr_b16 a[20:21], v8 offset:40960
  ds_read_b64_tr_b16 a[22:23], v8 offset:43008
  ds_read_b64_tr_b16 a[164:165], v9 offset:40960
  ds_read_b64_tr_b16 a[166:167], v9 offset:43008
  ds_read_b64_tr_b16 a[24:25], v8 offset:49152
  ds_read_b64_tr_b16 a[26:27], v8 offset:51200
  ds_read_b64_tr_b16 a[168:169], v9 offset:49152
  ds_read_b64_tr_b16 a[170:171], v9 offset:51200
  ds_read_b64_tr_b16 a[28:29], v8 offset:57344
  ds_read_b64_tr_b16 a[30:31], v8 offset:59392
  ds_read_b64_tr_b16 a[172:173], v9 offset:57344
  ds_read_b64_tr_b16 a[174:175], v9 offset:59392
  v_add_u32 v8, 0x10000, v8
  v_add_u32 v9, 0x10000, v9
  ds_read_b64_tr_b16 a[32:33], v8 offset:0
  ds_read_b64_tr_b16 a[34:35], v8 offset:2048
  ds_read_b64_tr_b16 a[176:177], v9 offset:0
  ds_read_b64_tr_b16 a[178:179], v9 offset:2048
  ds_read_b64_tr_b16 a[36:37], v8 offset:8192
  ds_read_b64_tr_b16 a[38:39], v8 offset:10240
  ds_read_b64_tr_b16 a[180:181], v9 offset:8192
  ds_read_b64_tr_b16 a[182:183], v9 offset:10240
  ds_read_b64_tr_b16 a[40:41], v8 offset:16384
  ds_read_b64_tr_b16 a[42:43], v8 offset:18432
  ds_read_b64_tr_b16 a[184:185], v9 offset:16384
  ds_read_b64_tr_b16 a[186:187], v9 offset:18432
  ds_read_b64_tr_b16 a[44:45], v8 offset:24576
  ds_read_b64_tr_b16 a[46:47], v8 offset:26624
  ds_read_b64_tr_b16 a[188:189], v9 offset:24576
  ds_read_b64_tr_b16 a[190:191], v9 offset:26624
  ds_read_b64_tr_b16 a[48:49], v8 offset:32768
  ds_read_b64_tr_b16 a[50:51], v8 offset:34816
  ds_read_b64_tr_b16 a[192:193], v9 offset:32768
  ds_read_b64_tr_b16 a[194:195], v9 offset:34816
  ds_read_b64_tr_b16 a[52:53], v8 offset:40960
  ds_read_b64_tr_b16 a[54:55], v8 offset:43008
  ds_read_b64_tr_b16 a[196:197], v9 offset:40960
  ds_read_b64_tr_b16 a[198:199], v9 offset:43008
  ds_read_b64_tr_b16 a[56:57], v8 offset:49152
  ds_read_b64_tr_b16 a[58:59], v8 offset:51200
  ds_read_b64_tr_b16 a[200:201], v9 offset:49152
  ds_read_b64_tr_b16 a[202:203], v9 offset:51200
  ds_read_b64_tr_b16 a[60:61], v8 offset:57344
  ds_read_b64_tr_b16 a[62:63], v8 offset:59392
  ds_read_b64_tr_b16 a[204:205], v9 offset:57344
  ds_read_b64_tr_b16 a[206:207], v9 offset:59392
  v_add_u32 v8, 0x10000, v8
  v_add_u32 v9, 0x10000, v9
  ds_read_b64_tr_b16 a[64:65], v8 offset:0
  ds_read_b64_tr_b16 a[66:67], v8 offset:2048
  ds_read_b64_tr_b16 a[208:209], v9 offset:0
  ds_read_b64_tr_b16 a[210:211], v9 offset:2048
  ds_read_b64_tr_b16 a[68:69], v8 offset:8192
  ds_read_b64_tr_b16 a[70:71], v8 offset:10240
  ds_read_b64_tr_b16 a[212:213], v9 offset:8192
  ds_read_b64_tr_b16 a[214:215], v9 offset:10240
  s_waitcnt lgkmcnt(0)
  s_barrier
  s_lshl_b32 s61, s51, 10
  s_mov_b32 m0, s61
  s_add_u32 s61, s61, 4096
  buffer_load_dwordx4 v18, s[12:15], s74 offen  lds
  s_add_u32 s74, s74, 27648
  s_mov_b32 m0, s61
  s_add_u32 s61, s61, 4096
  buffer_load_dwordx4 v18, s[12:15], s74 offen  lds
  s_add_u32 s74, s74, 27648
  s_mov_b32 m0, s61
  s_add_u32 s61, s61, 4096
  buffer_load_dwordx4 v18, s[12:15], s74 offen  lds
  s_add_u32 s74, s74, 27648
  s_mov_b32 m0, s61
  s_add_u32 s61, s61, 4096
  buffer_load_dwordx4 v18, s[12:15], s74 offen  lds
  s_add_u32 s74, s74, 27648
  s_mov_b32 m0, s61
  s_add_u32 s61, s61, 4096
  buffer_load_dwordx4 v18, s[12:15], s74 offen  lds
  s_add_u32 s74, s74, 27648
  s_mov_b32 m0, s61
  s_add_u32 s61, s61, 4096
  buffer_load_dwordx4 v18, s[12:15], s74 offen  lds
  s_add_u32 s74, s74, 27648
  s_mov_b32 m0, s61
  s_add_u32 s61, s61, 4096
  buffer_load_dwordx4 v18, s[12:15], s74 offen  lds
  s_add_u32 s74, s74, 27648
  s_mov_b32 m0, s61
  s_add_u32 s61, s61, 4096
  buffer_load_dwordx4 v18, s[12:15], s74 offen  lds
  s_add_u32 s74, s74, 27648
  s_mov_b32 m0, s61
  s_add_u32 s61, s61, 4096
  buffer_load_dwordx4 v18, s[12:15], s74 offen  lds
  s_add_u32 s74, s74, 27648
  s_mov_b32 m0, s61
  s_add_u32 s61, s61, 4096
  buffer_load_dwordx4 v18, s[12:15], s74 offen  lds
  s_add_u32 s74, s74, 27648
  s_mov_b32 m0, s61
  s_add_u32 s61, s61, 4096
  buffer_load_dwordx4 v18, s[12:15], s74 offen  lds
  s_add_u32 s74, s74, 27648
  s_mov_b32 m0, s61
  s_add_u32 s61, s61, 4096
  buffer_load_dwordx4 v18, s[12:15], s74 offen  lds
  s_add_u32 s74, s74, 27648
  s_mov_b32 m0, s61
  s_add_u32 s61, s61, 4096
  buffer_load_dwordx4 v18, s[12:15], s74 offen  lds
  s_add_u32 s74, s74, 27648
  s_mov_b32 m0, s61
  s_add_u32 s61, s61, 4096
  buffer_load_dwordx4 v18, s[12:15], s74 offen  lds
  s_add_u32 s74, s74, 27648
  s_mov_b32 m0, s61
  s_add_u32 s61, s61, 4096
  buffer_load_dwordx4 v18, s[12:15], s74 offen  lds
  s_add_u32 s74, s74, 27648
  s_mov_b32 m0, s61
  s_add_u32 s61, s61, 4096
  buffer_load_dwordx4 v18, s[12:15], s74 offen  lds
  s_add_u32 s74, s74, 27648
  s_mov_b32 m0, s61
  s_add_u32 s61, s61, 4096
  buffer_load_dwordx4 v18, s[12:15], s74 offen  lds
  s_add_u32 s74, s74, 27648
  s_mov_b32 m0, s61
  s_add_u32 s61, s61, 4096
  buffer_load_dwordx4 v18, s[12:15], s74 offen  lds
  s_add_u32 s74, s74, 27648
  s_mov_b32 m0, s61
  s_add_u32 s61, s61, 4096
  buffer_load_dwordx4 v18, s[12:15], s74 offen  lds
  s_add_u32 s74, s74, 27648
  s_mov_b32 m0, s61
  s_add_u32 s61, s61, 4096
  buffer_load_dwordx4 v18, s[12:15], s74 offen  lds
  s_add_u32 s74, s74, 27648
  s_mov_b32 m0, s61
  s_add_u32 s61, s61, 4096
  buffer_load_dwordx4 v18, s[12:15], s74 offen  lds
  s_add_u32 s74, s74, 27648
  s_mov_b32 m0, s61
  s_add_u32 s61, s61, 4096
  buffer_load_dwordx4 v18, s[12:15], s74 offen  lds
  s_add_u32 s74, s74, 27648
  s_mov_b32 m0, s61
  s_add_u32 s61, s61, 4096
  buffer_load_dwordx4 v18, s[12:15], s74 offen  lds
  s_add_u32 s74, s74, 27648
  s_mov_b32 m0, s61
  s_add_u32 s61, s61, 4096
  buffer_load_dwordx4 v18, s[12:15], s74 offen  lds
  s_add_u32 s74, s74, 27648
  s_mov_b32 m0, s61
  s_add_u32 s61, s61, 4096
  buffer_load_dwordx4 v18, s[12:15], s74 offen  lds
  s_add_u32 s74, s74, 27648
  s_mov_b32 m0, s61
  s_add_u32 s61, s61, 4096
  buffer_load_dwordx4 v18, s[12:15], s74 offen  lds
  s_add_u32 s74, s74, 27648
  s_mov_b32 m0, s61
  s_add_u32 s61, s61, 4096
  buffer_load_dwordx4 v18, s[12:15], s74 offen  lds
  s_add_u32 s74, s74, 27648
  s_mov_b32 m0, s61
  s_add_u32 s61, s61, 4096
  buffer_load_dwordx4 v18, s[12:15], s74 offen  lds
  s_add_u32 s74, s74, 27648
  s_mov_b32 m0, s61
  s_add_u32 s61, s61, 4096
  buffer_load_dwordx4 v18, s[12:15], s74 offen  lds
  s_add_u32 s74, s74, 27648
  s_mov_b32 m0, s61
  s_add_u32 s61, s61, 4096
  buffer_load_dwordx4 v18, s[12:15], s74 offen  lds
  s_add_u32 s74, s74, 27648
  s_mov_b32 m0, s61
  s_add_u32 s61, s61, 4096
  buffer_load_dwordx4 v18, s[12:15], s74 offen  lds
  s_add_u32 s74, s74, 27648
  s_mov_b32 m0, s61
  s_add_u32 s61, s61, 4096
  buffer_load_dwordx4 v18, s[12:15], s74 offen  lds
  s_add_u32 s74, s74, 27648
  s_mov_b32 m0, s61
  s_add_u32 s61, s61, 4096
  buffer_load_dwordx4 v18, s[12:15], s74 offen  lds
  s_add_u32 s74, s74, 27648
  s_mov_b32 m0, s61
  s_add_u32 s61, s61, 4096
  buffer_load_dwordx4 v18, s[12:15], s74 offen  lds
  s_add_u32 s74, s74, 27648
  s_mov_b32 m0, s61
  s_add_u32 s61, s61, 4096
  buffer_load_dwordx4 v18, s[12:15], s74 offen  lds
  s_add_u32 s74, s74, 27648
  s_mov_b32 m0, s61
  s_add_u32 s61, s61, 4096
  buffer_load_dwordx4 v18, s[12:15], s74 offen  lds
  s_add_u32 s74, s74, 27648
  v_mov_b32 v8, v12
  v_mov_b32 v9, v13
  s_waitcnt vmcnt(0) lgkmcnt(0)
  s_barrier
  ds_read_b64_tr_b16 a[72:73], v8 offset:0
  ds_read_b64_tr_b16 a[74:75], v8 offset:2048
  ds_read_b64_tr_b16 a[216:217], v9 offset:0
  ds_read_b64_tr_b16 a[218:219], v9 offset:2048
  ds_read_b64_tr_b16 a[76:77], v8 offset:8192
  ds_read_b64_tr_b16 a[78:79], v8 offset:10240
  ds_read_b64_tr_b16 a[220:221], v9 offset:8192
  ds_read_b64_tr_b16 a[222:223], v9 offset:10240
  ds_read_b64_tr_b16 a[80:81], v8 offset:16384
  ds_read_b64_tr_b16 a[82:83], v8 offset:18432
  ds_read_b64_tr_b16 a[224:225], v9 offset:16384
  ds_read_b64_tr_b16 a[226:227], v9 offset:18432
  ds_read_b64_tr_b16 a[84:85], v8 offset:24576
  ds_read_b64_tr_b16 a[86:87], v8 offset:26624
  ds_read_b64_tr_b16 a[228:229], v9 offset:24576
  ds_read_b64_tr_b16 a[230:231], v9 offset:26624
  ds_read_b64_tr_b16 a[88:89], v8 offset:32768
  ds_read_b64_tr_b16 a[90:91], v8 offset:34816
  ds_read_b64_tr_b16 a[232:233], v9 offset:32768
  ds_read_b64_tr_b16 a[234:235], v9 offset:34816
  ds_read_b64_tr_b16 a[92:93], v8 offset:40960
  ds_read_b64_tr_b16 a[94:95], v8 offset:43008
  ds_read_b64_tr_b16 a[236:237], v9 offset:40960
  ds_read_b64_tr_b16 a[238:239], v9 offset:43008
  ds_read_b64_tr_b16 a[96:97], v8 offset:49152
  ds_read_b64_tr_b16 a[98:99], v8 offset:51200
  ds_read_b64_tr_b16 a[240:241], v9 offset:49152
  ds_read_b64_tr_b16 a[242:243], v9 offset:51200
  ds_read_b64_tr_b16 a[100:101], v8 offset:57344
  ds_read_b64_tr_b16 a[102:103], v8 offset:59392
  ds_read_b64_tr_b16 a[244:245], v9 offset:57344
  ds_read_b64_tr_b16 a[246:247], v9 offset:59392
  v_add_u32 v8, 0x10000, v8
  v_add_u32 v9, 0x10000, v9
  ds_read_b64_tr_b16 a[104:105], v8 offset:0
  ds_read_b64_tr_b16 a[106:107], v8 offset:2048
  ds_read_b64_tr_b16 a[248:249], v9 offset:0
  ds_read_b64_tr_b16 a[250:251], v9 offset:2048
  ds_read_b64_tr_b16 a[108:109], v8 offset:8192
  ds_read_b64_tr_b16 a[110:111], v8 offset:10240
  ds_read_b64_tr_b16 a[252:253], v9 offset:8192
  ds_read_b64_tr_b16 a[254:255], v9 offset:10240
  ds_read_b64_tr_b16 a[112:113], v8 offset:16384
  ds_read_b64_tr_b16 a[114:115], v8 offset:18432
  ds_read_b64_tr_b16 v[224:225], v9 offset:16384
  ds_read_b64_tr_b16 v[226:227], v9 offset:18432
  ds_read_b64_tr_b16 a[116:117], v8 offset:24576
  ds_read_b64_tr_b16 a[118:119], v8 offset:26624
  ds_read_b64_tr_b16 v[228:229], v9 offset:24576
  ds_read_b64_tr_b16 v[230:231], v9 offset:26624
  ds_read_b64_tr_b16 a[120:121], v8 offset:32768
  ds_read_b64_tr_b16 a[122:123], v8 offset:34816
  ds_read_b64_tr_b16 v[232:233], v9 offset:32768
  ds_read_b64_tr_b16 v[234:235], v9 offset:34816
  ds_read_b64_tr_b16 a[124:125], v8 offset:40960
  ds_read_b64_tr_b16 a[126:127], v8 offset:43008
  ds_read_b64_tr_b16 v[236:237], v9 offset:40960
  ds_read_b64_tr_b16 v[238:239], v9 offset:43008
  ds_read_b64_tr_b16 a[128:129], v8 offset:49152
  ds_read_b64_tr_b16 a[130:131], v8 offset:51200
  ds_read_b64_tr_b16 v[240:241], v9 offset:49152
  ds_read_b64_tr_b16 v[242:243], v9 offset:51200
  ds_read_b64_tr_b16 a[132:133], v8 offset:57344
  ds_read_b64_tr_b16 a[134:135], v8 offset:59392
  ds_read_b64_tr_b16 v[244:245], v9 offset:57344
  ds_read_b64_tr_b16 v[246:247], v9 offset:59392
  v_add_u32 v8, 0x10000, v8
  v_add_u32 v9, 0x10000, v9
  ds_read_b64_tr_b16 a[136:137], v8 offset:0
  ds_read_b64_tr_b16 a[138:139], v8 offset:2048
  ds_read_b64_tr_b16 v[248:249], v9 offset:0
  ds_read_b64_tr_b16 v[250:251], v9 offset:2048
  ds_read_b64_tr_b16 a[140:141], v8 offset:8192
  ds_read_b64_tr_b16 a[142:143], v8 offset:10240
  ds_read_b64_tr_b16 v[252:253], v9 offset:8192
  ds_read_b64_tr_b16 v[254:255], v9 offset:10240
  s_waitcnt lgkmcnt(0)
  s_barrier
  v_mov_b32 v8, 4
  s_mov_b32 s55, 150000
poll_12:
  buffer_load_dword v9, v8, s[20:23], 0 offen sc1
  s_waitcnt vmcnt(0)
  v_cmp_gt_u32 vcc, 56, v9
  s_nop 0
  s_cbranch_vccz pdone_13
  s_sleep 2
  s_mov_b32 s58, 11
  s_sub_u32 s55, s55, 1
  s_cbranch_scc0 poll_12
  s_branch ABORT
pdone_13:
  s_mul_i32 s60, s72, 72
  s_add_u32 s75, s75, s60
  v_mov_b32 v11, 1073741824
  v_subrev_u32 v8, s73, v7
  v_add_u32 v9, s75, v8
  v_lshlrev_b32 v9, 6, v9
  v_lshl_add_u32 v9, v6, 5, v9
  v_add_u32 v12, -1280, v9
  v_cmp_le_i32 vcc, 20, v8
  s_nop 1
  v_cndmask_b32 v12, v11, v12, vcc
  v_add_u32 v13, -512, v9
  v_cmp_gt_i32 vcc, 26, v8
  s_nop 1
  v_cndmask_b32 v13, v11, v13, vcc
  v_cmp_le_u32 vcc, 20, v7
  s_nop 1
  v_cndmask_b32 v13, v11, v13, vcc
  v_mov_b32 v10, 0xff800000
  v_cndmask_b32 v14, v10, 0, vcc
  v_cndmask_b32 v16, 0, 1.0, vcc
  v_mov_b32 v10, 0x358637bd
  v_cndmask_b32 v17, 0, v10, vcc
  v_cmp_le_u32 vcc, 28, v7
  s_nop 1
  v_cndmask_b32 v15, 1.0, 0, vcc
  v_cndmask_b32 v16, v16, 0, vcc
  v_cndmask_b32 v17, v17, 1.0, vcc
  v_min_u32 v4, 17, v0
  v_lshlrev_b32 v4, 6, v4
  s_mov_b32 s78, 0x3fb8aa3b
  s_mov_b32 s79, 0x358637bd
A1_LAYER:
  v_mov_b64 v[196:197], 0
  v_mov_b64 v[198:199], 0
  v_mov_b64 v[200:201], 0
  v_mov_b64 v[202:203], 0
  v_mov_b64 v[204:205], 0
  v_mov_b64 v[206:207], 0
  v_mov_b64 v[208:209], 0
  v_mov_b64 v[210:211], 0
  s_branch A1_TW
A1_LOOP:
  s_waitcnt vmcnt(4)
  v_lshlrev_b32 v56, 16, v20
  v_and_b32 v57, 0xffff0000, v20
  v_lshlrev_b32 v58, 16, v21
  v_and_b32 v59, 0xffff0000, v21
  v_lshlrev_b32 v60, 16, v22
  v_and_b32 v61, 0xffff0000, v22
  v_lshlrev_b32 v62, 16, v23
  v_and_b32 v63, 0xffff0000, v23
  v_lshlrev_b32 v64, 16, v24
  v_and_b32 v65, 0xffff0000, v24
  v_lshlrev_b32 v66, 16, v25
  v_and_b32 v67, 0xffff0000, v25
  v_lshlrev_b32 v68, 16, v26
  v_and_b32 v69, 0xffff0000, v26
  v_lshlrev_b32 v70, 16, v27
  v_and_b32 v71, 0xffff0000, v27
  v_lshlrev_b32 v72, 16, v28
  v_and_b32 v73, 0xffff0000, v28
  v_lshlrev_b32 v74, 16, v29
  v_and_b32 v75, 0xffff0000, v29
  v_lshlrev_b32 v76, 16, v30
  v_and_b32 v77, 0xffff0000, v30
  v_lshlrev_b32 v78, 16, v31
  v_and_b32 v79, 0xffff0000, v31
  v_lshlrev_b32 v80, 16, v32
  v_and_b32 v81, 0xffff0000, v32
  v_lshlrev_b32 v82, 16, v33
  v_and_b32 v83, 0xffff0000, v33
  v_lshlrev_b32 v84, 16, v34
  v_and_b32 v85, 0xffff0000, v34
  v_lshlrev_b32 v86, 16, v35
  v_and_b32 v87, 0xffff0000, v35
  v_lshlrev_b32 v88, 16, v36
  v_and_b32 v89, 0xffff0000, v36
  v_lshlrev_b32 v90, 16, v37
  v_and_b32 v91, 0xffff0000, v37
  v_lshlrev_b32 v92, 16, v38
  v_and_b32 v93, 0xffff0000, v38
  v_lshlrev_b32 v94, 16, v39
  v_and_b32 v95, 0xffff0000, v39
  v_lshlrev_b32 v96, 16, v40
  v_and_b32 v97, 0xffff0000, v40
  v_lshlrev_b32 v98, 16, v41
  v_and_b32 v99, 0xffff0000, v41
  v_lshlrev_b32 v100, 16, v42
  v_and_b32 v101, 0xffff0000, v42
  v_lshlrev_b32 v102, 16, v43
  v_and_b32 v103, 0xffff0000, v43
  v_lshlrev_b32 v104, 16, v44
  v_and_b32 v105, 0xffff0000, v44
  v_lshlrev_b32 v106, 16, v45
  v_and_b32 v107, 0xffff0000, v45
  v_lshlrev_b32 v108, 16, v46
  v_and_b32 v109, 0xffff0000, v46
  v_lshlrev_b32 v110, 16, v47
  v_and_b32 v111, 0xffff0000, v47
  v_lshlrev_b32 v112, 16, v48
  v_and_b32 v113, 0xffff0000, v48
  v_lshlrev_b32 v114, 16, v49
  v_and_b32 v115, 0xffff0000, v49
  v_lshlrev_b32 v116, 16, v50
  v_and_b32 v117, 0xffff0000, v50
  v_lshlrev_b32 v118, 16, v51
  v_and_b32 v119, 0xffff0000, v51
  v_lshlrev_b32 v120, 16, v52
  v_and_b32 v121, 0xffff0000, v52
  v_lshlrev_b32 v122, 16, v53
  v_and_b32 v123, 0xffff0000, v53
  v_lshlrev_b32 v124, 16, v54
  v_and_b32 v125, 0xffff0000, v54
  v_lshlrev_b32 v126, 16, v55
  v_and_b32 v127, 0xffff0000, v55
  v_pk_add_f32 v[8:9], v[56:57], v[58:59]
  v_pk_add_f32 v[10:11], v[60:61], v[62:63]
  v_pk_add_f32 v[8:9], v[8:9], v[64:65]
  v_pk_add_f32 v[10:11], v[10:11], v[66:67]
  v_pk_add_f32 v[8:9], v[8:9], v[68:69]
  v_pk_add_f32 v[10:11], v[10:11], v[70:71]
  v_pk_add_f32 v[8:9], v[8:9], v[72:73]
  v_pk_add_f32 v[10:11], v[10:11], v[74:75]
  v_pk_add_f32 v[8:9], v[8:9], v[76:77]
  v_pk_add_f32 v[10:11], v[10:11], v[78:79]
  v_pk_add_f32 v[8:9], v[8:9], v[80:81]
  v_pk_add_f32 v[10:11], v[10:11], v[82:83]
  v_pk_add_f32 v[8:9], v[8:9], v[84:85]
  v_pk_add_f32 v[10:11], v[10:11], v[86:87]
  v_pk_add_f32 v[8:9], v[8:9], v[88:89]
  v_pk_add_f32 v[10:11], v[10:11], v[90:91]
  v_pk_add_f32 v[8:9], v[8:9], v[92:93]
  v_pk_add_f32 v[10:11], v[10:11], v[94:95]
  v_pk_add_f32 v[8:9], v[8:9], v[96:97]
  v_pk_add_f32 v[10:11], v[10:11], v[98:99]
  v_pk_add_f32 v[8:9], v[8:9], v[100:101]
  v_pk_add_f32 v[10:11], v[10:11], v[102:103]
  v_pk_add_f32 v[8:9], v[8:9], v[104:105]
  v_pk_add_f32 v[10:11], v[10:11], v[106:107]
  v_pk_add_f32 v[8:9], v[8:9], v[108:109]
  v_pk_add_f32 v[10:11], v[10:11], v[110:111]
  v_pk_add_f32 v[8:9], v[8:9], v[112:113]
  v_pk_add_f32 v[10:11], v[10:11], v[114:115]
  v_pk_add_f32 v[8:9], v[8:9], v[116:117]
  v_pk_add_f32 v[10:11], v[10:11], v[118:119]
  v_pk_add_f32 v[8:9], v[8:9], v[120:121]
  v_pk_add_f32 v[10:11], v[10:11], v[122:123]
  v_pk_add_f32 v[8:9], v[8:9], v[124:125]
  v_pk_add_f32 v[10:11], v[10:11], v[126:127]
  v_pk_add_f32 v[8:9], v[8:9], v[10:11]
  v_add_f32 v8, v8, v9
  s_nop 1
  v_add_f32_dpp v8, v8, v8 quad_perm:[1,0,3,2] row_mask:0xf bank_mask:0xf
  s_nop 1
  v_add_f32_dpp v8, v8, v8 quad_perm:[2,3,0,1] row_mask:0xf bank_mask:0xf
  s_nop 1
  v_add_f32_dpp v8, v8, v8 row_half_mirror row_mask:0xf bank_mask:0xf
  v_mul_f32 v8, 0xbae38e39, v8
  v_pk_add_f32 v[56:57], v[56:57], v[8:9] op_sel_hi:[1,0]
  v_pk_add_f32 v[58:59], v[58:59], v[8:9] op_sel_hi:[1,0]
  v_pk_add_f32 v[60:61], v[60:61], v[8:9] op_sel_hi:[1,0]
  v_pk_add_f32 v[62:63], v[62:63], v[8:9] op_sel_hi:[1,0]
  v_pk_add_f32 v[64:65], v[64:65], v[8:9] op_sel_hi:[1,0]
  v_pk_add_f32 v[66:67], v[66:67], v[8:9] op_sel_hi:[1,0]
  v_pk_add_f32 v[68:69], v[68:69], v[8:9] op_sel_hi:[1,0]
  v_pk_add_f32 v[70:71], v[70:71], v[8:9] op_sel_hi:[1,0]
  v_pk_add_f32 v[72:73], v[72:73], v[8:9] op_sel_hi:[1,0]
  v_pk_add_f32 v[74:75], v[74:75], v[8:9] op_sel_hi:[1,0]
  v_pk_add_f32 v[76:77], v[76:77], v[8:9] op_sel_hi:[1,0]
  v_pk_add_f32 v[78:79], v[78:79], v[8:9] op_sel_hi:[1,0]
  v_pk_add_f32 v[80:81], v[80:81], v[8:9] op_sel_hi:[1,0]
  v_pk_add_f32 v[82:83], v[82:83], v[8:9] op_sel_hi:[1,0]
  v_pk_add_f32 v[84:85], v[84:85], v[8:9] op_sel_hi:[1,0]
  v_pk_add_f32 v[86:87], v[86:87], v[8:9] op_sel_hi:[1,0]
  v_pk_add_f32 v[88:89], v[88:89], v[8:9] op_sel_hi:[1,0]
  v_pk_add_f32 v[90:91], v[90:91], v[8:9] op_sel_hi:[1,0]
  v_pk_add_f32 v[92:93], v[92:93], v[8:9] op_sel_hi:[1,0]
  v_pk_add_f32 v[94:95], v[94:95], v[8:9] op_sel_hi:[1,0]
  v_pk_add_f32 v[96:97], v[96:97], v[8:9] op_sel_hi:[1,0]
  v_pk_add_f32 v[98:99], v[98:99], v[8:9] op_sel_hi:[1,0]
  v_pk_add_f32 v[100:101], v[100:101], v[8:9] op_sel_hi:[1,0]
  v_pk_add_f32 v[102:103], v[102:103], v[8:9] op_sel_hi:[1,0]
  v_pk_add_f32 v[104:105], v[104:105], v[8:9] op_sel_hi:[1,0]
  v_pk_add_f32 v[106:107], v[106:107], v[8:9] op_sel_hi:[1,0]
  v_pk_add_f32 v[108:109], v[108:109], v[8:9] op_sel_hi:[1,0]
  v_pk_add_f32 v[110:111], v[110:111], v[8:9] op_sel_hi:[1,0]
  v_pk_add_f32 v[112:113], v[112:113], v[8:9] op_sel_hi:[1,0]
  v_pk_add_f32 v[114:115], v[114:115], v[8:9] op_sel_hi:[1,0]
  v_pk_add_f32 v[116:117], v[116:117], v[8:9] op_sel_hi:[1,0]
  v_pk_add_f32 v[118:119], v[118:119], v[8:9] op_sel_hi:[1,0]
  v_pk_add_f32 v[120:121], v[120:121], v[8:9] op_sel_hi:[1,0]
  v_pk_add_f32 v[122:123], v[122:123], v[8:9] op_sel_hi:[1,0]
  v_pk_add_f32 v[124:125], v[124:125], v[8:9] op_sel_hi:[1,0]
  v_pk_add_f32 v[126:127], v[126:127], v[8:9] op_sel_hi:[1,0]
  v_pk_mul_f32 v[8:9], v[56:57], v[56:57]
  v_pk_mul_f32 v[10:11], v[58:59], v[58:59]
  v_pk_fma_f32 v[8:9], v[60:61], v[60:61], v[8:9]
  v_pk_fma_f32 v[10:11], v[62:63], v[62:63], v[10:11]
  v_pk_fma_f32 v[8:9], v[64:65], v[64:65], v[8:9]
  v_pk_fma_f32 v[10:11], v[66:67], v[66:67], v[10:11]
  v_pk_fma_f32 v[8:9], v[68:69], v[68:69], v[8:9]
  v_pk_fma_f32 v[10:11], v[70:71], v[70:71], v[10:11]
  v_pk_fma_f32 v[8:9], v[72:73], v[72:73], v[8:9]
  v_pk_fma_f32 v[10:11], v[74:75], v[74:75], v[10:11]
  v_pk_fma_f32 v[8:9], v[76:77], v[76:77], v[8:9]
  v_pk_fma_f32 v[10:11], v[78:79], v[78:79], v[10:11]
  v_pk_fma_f32 v[8:9], v[80:81], v[80:81], v[8:9]
  v_pk_fma_f32 v[10:11], v[82:83], v[82:83], v[10:11]
  v_pk_fma_f32 v[8:9], v[84:85], v[84:85], v[8:9]
  v_pk_fma_f32 v[10:11], v[86:87], v[86:87], v[10:11]
  v_pk_fma_f32 v[8:9], v[88:89], v[88:89], v[8:9]
  v_pk_fma_f32 v[10:11], v[90:91], v[90:91], v[10:11]
  v_pk_fma_f32 v[8:9], v[92:93], v[92:93], v[8:9]
  v_pk_fma_f32 v[10:11], v[94:95], v[94:95], v[10:11]
  v_pk_fma_f32 v[8:9], v[96:97], v[96:97], v[8:9]
  v_pk_fma_f32 v[10:11], v[98:99], v[98:99], v[10:11]
  v_pk_fma_f32 v[8:9], v[100:101], v[100:101], v[8:9]
  v_pk_fma_f32 v[10:11], v[102:103], v[102:103], v[10:11]
  v_pk_fma_f32 v[8:9], v[104:105], v[104:105], v[8:9]
  v_pk_fma_f32 v[10:11], v[106:107], v[106:107], v[10:11]
  v_pk_fma_f32 v[8:9], v[108:109], v[108:109], v[8:9]
  v_pk_fma_f32 v[10:11], v[110:111], v[110:111], v[10:11]
  v_pk_fma_f32 v[8:9], v[112:113], v[112:113], v[8:9]
  v_pk_fma_f32 v[10:11], v[114:115], v[114:115], v[10:11]
  v_pk_fma_f32 v[8:9], v[116:117], v[116:117], v[8:9]
  v_pk_fma_f32 v[10:11], v[118:119], v[118:119], v[10:11]
  v_pk_fma_f32 v[8:9], v[120:121], v[120:121], v[8:9]
  v_pk_fma_f32 v[10:11], v[122:123], v[122:123], v[10:11]
  v_pk_fma_f32 v[8:9], v[124:125], v[124:125], v[8:9]
  v_pk_fma_f32 v[10:11], v[126:127], v[126:127], v[10:11]
  v_pk_add_f32 v[8:9], v[8:9], v[10:11]
  v_add_f32 v8, v8, v9
  s_nop 1
  v_add_f32_dpp v8, v8, v8 quad_perm:[1,0,3,2] row_mask:0xf bank_mask:0xf
  s_nop 1
  v_add_f32_dpp v8, v8, v8 quad_perm:[2,3,0,1] row_mask:0xf bank_mask:0xf
  s_nop 1
  v_add_f32_dpp v8, v8, v8 row_half_mirror row_mask:0xf bank_mask:0xf
  v_mov_b32 v9, 0x3727c5ac
  v_fmac_f32 v9, 0x3ae38e39, v8
  v_rsq_f32 v8, v9
  s_nop 0
  v_pk_mul_f32 v[56:57], v[56:57], v[8:9] op_sel_hi:[1,0]
  v_cvt_pk_bf16_f32 v128, v56, v57
  v_pk_mul_f32 v[58:59], v[58:59], v[8:9] op_sel_hi:[1,0]
  v_cvt_pk_bf16_f32 v129, v58, v59
  v_pk_mul_f32 v[60:61], v[60:61], v[8:9] op_sel_hi:[1,0]
  v_cvt_pk_bf16_f32 v130, v60, v61
  v_pk_mul_f32 v[62:63], v[62:63], v[8:9] op_sel_hi:[1,0]
  v_cvt_pk_bf16_f32 v131, v62, v63
  v_pk_mul_f32 v[64:65], v[64:65], v[8:9] op_sel_hi:[1,0]
  v_cvt_pk_bf16_f32 v132, v64, v65
  v_pk_mul_f32 v[66:67], v[66:67], v[8:9] op_sel_hi:[1,0]
  v_cvt_pk_bf16_f32 v133, v66, v67
  v_pk_mul_f32 v[68:69], v[68:69], v[8:9] op_sel_hi:[1,0]
  v_cvt_pk_bf16_f32 v134, v68, v69
  v_pk_mul_f32 v[70:71], v[70:71], v[8:9] op_sel_hi:[1,0]
  v_cvt_pk_bf16_f32 v135, v70, v71
  v_pk_mul_f32 v[72:73], v[72:73], v[8:9] op_sel_hi:[1,0]
  v_cvt_pk_bf16_f32 v136, v72, v73
  v_pk_mul_f32 v[74:75], v[74:75], v[8:9] op_sel_hi:[1,0]
  v_cvt_pk_bf16_f32 v137, v74, v75
  v_pk_mul_f32 v[76:77], v[76:77], v[8:9] op_sel_hi:[1,0]
  v_cvt_pk_bf16_f32 v138, v76, v77
  v_pk_mul_f32 v[78:79], v[78:79], v[8:9] op_sel_hi:[1,0]
  v_cvt_pk_bf16_f32 v139, v78, v79
  v_pk_mul_f32 v[80:81], v[80:81], v[8:9] op_sel_hi:[1,0]
  v_cvt_pk_bf16_f32 v140, v80, v81
  v_pk_mul_f32 v[82:83], v[82:83], v[8:9] op_sel_hi:[1,0]
  v_cvt_pk_bf16_f32 v141, v82, v83
  v_pk_mul_f32 v[84:85], v[84:85], v[8:9] op_sel_hi:[1,0]
  v_cvt_pk_bf16_f32 v142, v84, v85
  v_pk_mul_f32 v[86:87], v[86:87], v[8:9] op_sel_hi:[1,0]
  v_cvt_pk_bf16_f32 v143, v86, v87
  v_pk_mul_f32 v[88:89], v[88:89], v[8:9] op_sel_hi:[1,0]
  v_cvt_pk_bf16_f32 v144, v88, v89
  v_pk_mul_f32 v[90:91], v[90:91], v[8:9] op_sel_hi:[1,0]
  v_cvt_pk_bf16_f32 v145, v90, v91
  v_pk_mul_f32 v[92:93], v[92:93], v[8:9] op_sel_hi:[1,0]
  v_cvt_pk_bf16_f32 v146, v92, v93
  v_pk_mul_f32 v[94:95], v[94:95], v[8:9] op_sel_hi:[1,0]
  v_cvt_pk_bf16_f32 v147, v94, v95
  v_pk_mul_f32 v[96:97], v[96:97], v[8:9] op_sel_hi:[1,0]
  v_cvt_pk_bf16_f32 v148, v96, v97
  v_pk_mul_f32 v[98:99], v[98:99], v[8:9] op_sel_hi:[1,0]
  v_cvt_pk_bf16_f32 v149, v98, v99
  v_pk_mul_f32 v[100:101], v[100:101], v[8:9] op_sel_hi:[1,0]
  v_cvt_pk_bf16_f32 v150, v100, v101
  v_pk_mul_f32 v[102:103], v[102:103], v[8:9] op_sel_hi:[1,0]
  v_cvt_pk_bf16_f32 v151, v102, v103
  v_pk_mul_f32 v[104:105], v[104:105], v[8:9] op_sel_hi:[1,0]
  v_cvt_pk_bf16_f32 v152, v104, v105
  v_pk_mul_f32 v[106:107], v[106:107], v[8:9] op_sel_hi:[1,0]
  v_cvt_pk_bf16_f32 v153, v106, v107
  v_pk_mul_f32 v[108:109], v[108:109], v[8:9] op_sel_hi:[1,0]
  v_cvt_pk_bf16_f32 v154, v108, v109
  v_pk_mul_f32 v[110:111], v[110:111], v[8:9] op_sel_hi:[1,0]
  v_cvt_pk_bf16_f32 v155, v110, v111
  v_pk_mul_f32 v[112:113], v[112:113], v[8:9] op_sel_hi:[1,0]
  v_cvt_pk_bf16_f32 v156, v112, v113
  v_pk_mul_f32 v[114:115], v[114:115], v[8:9] op_sel_hi:[1,0]
  v_cvt_pk_bf16_f32 v157, v114, v115
  v_pk_mul_f32 v[116:117], v[116:117], v[8:9] op_sel_hi:[1,0]
  v_cvt_pk_bf16_f32 v158, v116, v117
  v_pk_mul_f32 v[118:119], v[118:119], v[8:9] op_sel_hi:[1,0]
  v_cvt_pk_bf16_f32 v159, v118, v119
  v_pk_mul_f32 v[120:121], v[120:121], v[8:9] op_sel_hi:[1,0]
  v_cvt_pk_bf16_f32 v160, v120, v121
  v_pk_mul_f32 v[122:123], v[122:123], v[8:9] op_sel_hi:[1,0]
  v_cvt_pk_bf16_f32 v161, v122, v123
  v_pk_mul_f32 v[124:125], v[124:125], v[8:9] op_sel_hi:[1,0]
  v_cvt_pk_bf16_f32 v162, v124, v125
  v_pk_mul_f32 v[126:127], v[126:127], v[8:9] op_sel_hi:[1,0]
  v_cvt_pk_bf16_f32 v163, v126, v127
A1_TW:
  s_xor_b32 s76, s76, 38016
  v_add_u32 v8, s76, v2
  ds_write_b128 v8, v[128:131] offset:0
  ds_write_b128 v8, v[132:135] offset:4224
  ds_write_b128 v8, v[136:139] offset:8448
  ds_write_b128 v8, v[140:143] offset:12672
  ds_write_b128 v8, v[144:147] offset:16896
  ds_write_b128 v8, v[148:151] offset:21120
  ds_write_b128 v8, v[152:155] offset:25344
  ds_write_b128 v8, v[156:159] offset:29568
  ds_write_b128 v8, v[160:163] offset:33792
  s_waitcnt lgkmcnt(0)
  s_barrier
  s_add_u32 s74, s53, s69
  s_cmp_lt_u32 s74, 64
  s_cselect_b32 s61, s52, 1
  s_cmp_lg_u32 s61, 0
  s_cbranch_scc1 A1_NP
  s_mul_i32 s60, s74, 36864
  buffer_load_dwordx4 v[20:23], v1, s[8:11], s60 offen offset:0 sc1
  buffer_load_dwordx4 v[24:27], v1, s[8:11], s60 offen offset:128 sc1
  buffer_load_dwordx4 v[28:31], v1, s[8:11], s60 offen offset:256 sc1
  buffer_load_dwordx4 v[32:35], v1, s[8:11], s60 offen offset:384 sc1
  buffer_load_dwordx4 v[36:39], v1, s[8:11], s60 offen offset:512 sc1
  buffer_load_dwordx4 v[40:43], v1, s[8:11], s60 offen offset:640 sc1
  buffer_load_dwordx4 v[44:47], v1, s[8:11], s60 offen offset:768 sc1
  buffer_load_dwordx4 v[48:51], v1, s[8:11], s60 offen offset:896 sc1
  buffer_load_dwordx4 v[52:55], v1, s[8:11], s60 offen offset:1024 sc1
A1_NP:
  v_add_u32 v8, s76, v3
  ds_read_b128 v[128:131], v8 offset:0
  ds_read_b128 v[132:135], v8 offset:1056
  ds_read_b128 v[136:139], v8 offset:2112
  ds_read_b128 v[140:143], v8 offset:3168
  ds_read_b128 v[144:147], v8 offset:4224
  ds_read_b128 v[148:151], v8 offset:5280
  s_waitcnt lgkmcnt(5)
  v_mfma_f32_32x32x16_bf16 v[164:179], v[128:131], a[0:3], 0
  v_mfma_f32_32x32x16_bf16 v[180:195], v[128:131], a[144:147], 0
  ds_read_b128 v[128:131], v8 offset:6336
  s_waitcnt lgkmcnt(5)
  v_mfma_f32_32x32x16_bf16 v[164:179], v[132:135], a[4:7], v[164:179]
  v_mfma_f32_32x32x16_bf16 v[180:195], v[132:135], a[148:151], v[180:195]
  ds_read_b128 v[132:135], v8 offset:7392
  s_waitcnt lgkmcnt(5)
  v_mfma_f32_32x32x16_bf16 v[164:179], v[136:139], a[8:11], v[164:179]
  v_mfma_f32_32x32x16_bf16 v[180:195], v[136:139], a[152:155], v[180:195]
  ds_read_b128 v[136:139], v8 offset:8448
  s_waitcnt lgkmcnt(5)
  v_mfma_f32_32x32x16_bf16 v[164:179], v[140:143], a[12:15], v[164:179]
  v_mfma_f32_32x32x16_bf16 v[180:195], v[140:143], a[156:159], v[180:195]
  ds_read_b128 v[140:143], v8 offset:9504
  s_waitcnt lgkmcnt(5)
  v_mfma_f32_32x32x16_bf16 v[164:179], v[144:147], a[16:19], v[164:179]
  v_mfma_f32_32x32x16_bf16 v[180:195], v[144:147], a[160:163], v[180:195]
  ds_read_b128 v[144:147], v8 offset:10560
  s_waitcnt lgkmcnt(5)
  v_mfma_f32_32x32x16_bf16 v[164:179], v[148:151], a[20:23], v[164:179]
  v_mfma_f32_32x32x16_bf16 v[180:195], v[148:151], a[164:167], v[180:195]
  ds_read_b128 v[148:151], v8 offset:11616
  s_waitcnt lgkmcnt(5)
  v_mfma_f32_32x32x16_bf16 v[164:179], v[128:131], a[24:27], v[164:179]
  v_mfma_f32_32x32x16_bf16 v[180:195], v[128:131], a[168:171], v[180:195]
  ds_read_b128 v[128:131], v8 offset:12672
  s_waitcnt lgkmcnt(5)
  v_mfma_f32_32x32x16_bf16 v[164:179], v[132:135], a[28:31], v[164:179]
  v_mfma_f32_32x32x16_bf16 v[180:195], v[132:135], a[172:175], v[180:195]
  ds_read_b128 v[132:135], v8 offset:13728
  s_waitcnt lgkmcnt(5)
  v_mfma_f32_32x32x16_bf16 v[164:179], v[136:139], a[32:35], v[164:179]
  v_mfma_f32_32x32x16_bf16 v[180:195], v[136:139], a[176:179], v[180:195]
  ds_read_b128 v[136:139], v8 offset:14784
  s_waitcnt lgkmcnt(5)
  v_mfma_f32_32x32x16_bf16 v[164:179], v[140:143], a[36:39], v[164:179]
  v_mfma_f32_32x32x16_bf16 v[180:195], v[140:143], a[180:183], v[180:195]
  ds_read_b128 v[140:143], v8 offset:15840
  s_waitcnt lgkmcnt(5)
  v_mfma_f32_32x32x16_bf16 v[164:179], v[144:147], a[40:43], v[164:179]
  v_mfma_f32_32x32x16_bf16 v[180:195], v[144:147], a[184:187], v[180:195]
  ds_read_b128 v[144:147], v8 offset:16896
  s_waitcnt lgkmcnt(5)
  v_mfma_f32_32x32x16_bf16 v[164:179], v[148:151], a[44:47], v[164:179]
  v_mfma_f32_32x32x16_bf16 v[180:195], v[148:151], a[188:191], v[180:195]
  ds_read_b128 v[148:151], v8 offset:17952
  s_waitcnt lgkmcnt(5)
  v_mfma_f32_32x32x16_bf16 v[164:179], v[128:131], a[48:51], v[164:179]
  v_mfma_f32_32x32x16_bf16 v[180:195], v[128:131], a[192:195], v[180:195]
  ds_read_b128 v[128:131], v8 offset:19008
  s_waitcnt lgkmcnt(5)
  v_mfma_f32_32x32x16_bf16 v[164:179], v[132:135], a[52:55], v[164:179]
  v_mfma_f32_32x32x16_bf16 v[180:195], v[132:135], a[196:199], v[180:195]
  ds_read_b128 v[132:135], v8 offset:20064
  s_waitcnt lgkmcnt(5)
  v_mfma_f32_32x32x16_bf16 v[164:179], v[136:139], a[56:59], v[164:179]
  v_mfma_f32_32x32x16_bf16 v[180:195], v[136:139], a[200:203], v[180:195]
  ds_read_b128 v[136:139], v8 offset:21120
  s_waitcnt lgkmcnt(5)
  v_mfma_f32_32x32x16_bf16 v[164:179], v[140:143], a[60:63], v[164:179]
  v_mfma_f32_32x32x16_bf16 v[180:195], v[140:143], a[204:207], v[180:195]
  ds_read_b128 v[140:143], v8 offset:22176
  s_waitcnt lgkmcnt(5)
  v_mfma_f32_32x32x16_bf16 v[164:179], v[144:147], a[64:67], v[164:179]
  v_mfma_f32_32x32x16_bf16 v[180:195], v[144:147], a[208:211], v[180:195]
  ds_read_b128 v[144:147], v8 offset:23232
  s_waitcnt lgkmcnt(5)
  v_mfma_f32_32x32x16_bf16 v[164:179], v[148:151], a[68:71], v[164:179]
  v_mfma_f32_32x32x16_bf16 v[180:195], v[148:151], a[212:215], v[180:195]
  ds_read_b128 v[148:151], v8 offset:24288
  s_waitcnt lgkmcnt(5)
  v_mfma_f32_32x32x16_bf16 v[164:179], v[128:131], a[72:75], v[164:179]
  v_mfma_f32_32x32x16_bf16 v[180:195], v[128:131], a[216:219], v[180:195]
  ds_read_b128 v[128:131], v8 offset:25344
  s_waitcnt lgkmcnt(5)
  v_mfma_f32_32x32x16_bf16 v[164:179], v[132:135], a[76:79], v[164:179]
  v_mfma_f32_32x32x16_bf16 v[180:195], v[132:135], a[220:223], v[180:195]
  ds_read_b128 v[132:135], v8 offset:26400
  s_waitcnt lgkmcnt(5)
  v_mfma_f32_32x32x16_bf16 v[164:179], v[136:139], a[80:83], v[164:179]
  v_mfma_f32_32x32x16_bf16 v[180:195], v[136:139], a[224:227], v[180:195]
  ds_read_b128 v[136:139], v8 offset:27456
  s_waitcnt lgkmcnt(5)
  v_mfma_f32_32x32x16_bf16 v[164:179], v[140:143], a[84:87], v[164:179]
  v_mfma_f32_32x32x16_bf16 v[180:195], v[140:143], a[228:231], v[180:195]
  ds_read_b128 v[140:143], v8 offset:28512
  s_waitcnt lgkmcnt(5)
  v_mfma_f32_32x32x16_bf16 v[164:179], v[144:147], a[88:91], v[164:179]
  v_mfma_f32_32x32x16_bf16 v[180:195], v[144:147], a[232:235], v[180:195]
  ds_read_b128 v[144:147], v8 offset:29568
  s_waitcnt lgkmcnt(5)
  v_mfma_f32_32x32x16_bf16 v[164:179], v[148:151], a[92:95], v[164:179]
  v_mfma_f32_32x32x16_bf16 v[180:195], v[148:151], a[236:239], v[180:195]
  ds_read_b128 v[148:151], v8 offset:30624
  s_waitcnt lgkmcnt(5)
  v_mfma_f32_32x32x16_bf16 v[164:179], v[128:131], a[96:99], v[164:179]
  v_mfma_f32_32x32x16_bf16 v[180:195], v[128:131], a[240:243], v[180:195]
  ds_read_b128 v[128:131], v8 offset:31680
  s_waitcnt lgkmcnt(5)
  v_mfma_f32_32x32x16_bf16 v[164:179], v[132:135], a[100:103], v[164:179]
  v_mfma_f32_32x32x16_bf16 v[180:195], v[132:135], a[244:247], v[180:195]
  ds_read_b128 v[132:135], v8 offset:32736
  s_waitcnt lgkmcnt(5)
  v_mfma_f32_32x32x16_bf16 v[164:179], v[136:139], a[104:107], v[164:179]
  v_mfma_f32_32x32x16_bf16 v[180:195], v[136:139], a[248:251], v[180:195]
  ds_read_b128 v[136:139], v8 offset:33792
  s_waitcnt lgkmcnt(5)
  v_mfma_f32_32x32x16_bf16 v[164:179], v[140:143], a[108:111], v[164:179]
  v_mfma_f32_32x32x16_bf16 v[180:195], v[140:143], a[252:255], v[180:195]
  ds_read_b128 v[140:143], v8 offset:34848
  s_waitcnt lgkmcnt(5)
  v_mfma_f32_32x32x16_bf16 v[164:179], v[144:147], a[112:115], v[164:179]
  v_mfma_f32_32x32x16_bf16 v[180:195], v[144:147], v[224:227], v[180:195]
  ds_read_b128 v[144:147], v8 offset:35904
  s_waitcnt lgkmcnt(5)
  v_mfma_f32_32x32x16_bf16 v[164:179], v[148:151], a[116:119], v[164:179]
  v_mfma_f32_32x32x16_bf16 v[180:195], v[148:151], v[228:231], v[180:195]
  ds_read_b128 v[148:151], v8 offset:36960
  s_waitcnt lgkmcnt(5)
  v_mfma_f32_32x32x16_bf16 v[164:179], v[128:131], a[120:123], v[164:179]
  v_mfma_f32_32x32x16_bf16 v[180:195], v[128:131], v[232:235], v[180:195]
  s_waitcnt lgkmcnt(4)
  v_mfma_f32_32x32x16_bf16 v[164:179], v[132:135], a[124:127], v[164:179]
  v_mfma_f32_32x32x16_bf16 v[180:195], v[132:135], v[236:239], v[180:195]
  s_waitcnt lgkmcnt(3)
  v_mfma_f32_32x32x16_bf16 v[164:179], v[136:139], a[128:131], v[164:179]
  v_mfma_f32_32x32x16_bf16 v[180:195], v[136:139], v[240:243], v[180:195]
  s_waitcnt lgkmcnt(2)
  v_mfma_f32_32x32x16_bf16 v[164:179], v[140:143], a[132:135], v[164:179]
  v_mfma_f32_32x32x16_bf16 v[180:195], v[140:143], v[244:247], v[180:195]
  s_waitcnt lgkmcnt(1)
  v_mfma_f32_32x32x16_bf16 v[164:179], v[144:147], a[136:139], v[164:179]
  v_mfma_f32_32x32x16_bf16 v[180:195], v[144:147], v[248:251], v[180:195]
  s_waitcnt lgkmcnt(0)
  v_mfma_f32_32x32x16_bf16 v[164:179], v[148:151], a[140:143], v[164:179]
  v_mfma_f32_32x32x16_bf16 v[180:195], v[148:151], v[252:255], v[180:195]
  s_mul_i32 s60, s53, 36864
  s_add_u32 s60, s60, s54
  s_nop 8
  v_mul_f32 v8, s78, v164
  v_min_f32 v8, 0, v8
  v_exp_f32 v8, v8
  v_mul_f32 v9, s78, v165
  v_min_f32 v9, 0, v9
  v_exp_f32 v9, v9
  v_max_f32 v164, 0, v164
  v_add_f32 v164, v164, v8
  v_add_f32 v164, s79, v164
  v_max_f32 v165, 0, v165
  v_add_f32 v165, v165, v9
  v_add_f32 v165, s79, v165
  v_cvt_pk_bf16_f32 v56, v164, v165
  v_mul_f32 v8, s78, v166
  v_min_f32 v8, 0, v8
  v_exp_f32 v8, v8
  v_mul_f32 v9, s78, v167
  v_min_f32 v9, 0, v9
  v_exp_f32 v9, v9
  v_max_f32 v166, 0, v166
  v_add_f32 v166, v166, v8
  v_add_f32 v166, s79, v166
  v_max_f32 v167, 0, v167
  v_add_f32 v167, v167, v9
  v_add_f32 v167, s79, v167
  v_cvt_pk_bf16_f32 v57, v166, v167
  v_mul_f32 v8, s78, v168
  v_min_f32 v8, 0, v8
  v_exp_f32 v8, v8
  v_mul_f32 v9, s78, v169
  v_min_f32 v9, 0, v9
  v_exp_f32 v9, v9
  v_max_f32 v168, 0, v168
  v_add_f32 v168, v168, v8
  v_add_f32 v168, s79, v168
  v_max_f32 v169, 0, v169
  v_add_f32 v169, v169, v9
  v_add_f32 v169, s79, v169
  v_cvt_pk_bf16_f32 v58, v168, v169
  v_mul_f32 v8, s78, v170
  v_min_f32 v8, 0, v8
  v_exp_f32 v8, v8
  v_mul_f32 v9, s78, v171
  v_min_f32 v9, 0, v9
  v_exp_f32 v9, v9
  v_max_f32 v170, 0, v170
  v_add_f32 v170, v170, v8
  v_add_f32 v170, s79, v170
  v_max_f32 v171, 0, v171
  v_add_f32 v171, v171, v9
  v_add_f32 v171, s79, v171
  v_cvt_pk_bf16_f32 v59, v170, v171
  v_mul_f32 v8, s78, v172
  v_min_f32 v8, 0, v8
  v_exp_f32 v8, v8
  v_mul_f32 v9, s78, v173
  v_min_f32 v9, 0, v9
  v_exp_f32 v9, v9
  v_max_f32 v172, 0, v172
  v_add_f32 v172, v172, v8
  v_add_f32 v172, s79, v172
  v_max_f32 v173, 0, v173
  v_add_f32 v173, v173, v9
  v_add_f32 v173, s79, v173
  v_cvt_pk_bf16_f32 v60, v172, v173
  v_mul_f32 v8, s78, v174
  v_min_f32 v8, 0, v8
  v_exp_f32 v8, v8
  v_mul_f32 v9, s78, v175
  v_min_f32 v9, 0, v9
  v_exp_f32 v9, v9
  v_max_f32 v174, 0, v174
  v_add_f32 v174, v174, v8
  v_add_f32 v174, s79, v174
  v_max_f32 v175, 0, v175
  v_add_f32 v175, v175, v9
  v_add_f32 v175, s79, v175
  v_cvt_pk_bf16_f32 v61, v174, v175
  v_mul_f32 v8, s78, v176
  v_min_f32 v8, 0, v8
  v_exp_f32 v8, v8
  v_mul_f32 v9, s78, v177
  v_min_f32 v9, 0, v9
  v_exp_f32 v9, v9
  v_max_f32 v176, 0, v176
  v_add_f32 v176, v176, v8
  v_add_f32 v176, s79, v176
  v_max_f32 v177, 0, v177
  v_add_f32 v177, v177, v9
  v_add_f32 v177, s79, v177
  v_cvt_pk_bf16_f32 v62, v176, v177
  v_mul_f32 v8, s78, v178
  v_min_f32 v8, 0, v8
  v_exp_f32 v8, v8
  v_mul_f32 v9, s78, v179
  v_min_f32 v9, 0, v9
  v_exp_f32 v9, v9
  v_max_f32 v178, 0, v178
  v_add_f32 v178, v178, v8
  v_add_f32 v178, s79, v178
  v_max_f32 v179, 0, v179
  v_add_f32 v179, v179, v9
  v_add_f32 v179, s79, v179
  v_cvt_pk_bf16_f32 v63, v178, v179
  buffer_store_dwordx4 v[56:59], v12, s[4:7], s60 offen offset:0 sc1
  buffer_store_dwordx4 v[60:63], v12, s[4:7], s60 offen offset:16 sc1
  v_mul_f32 v8, s78, v180
  v_min_f32 v8, 0, v8
  v_exp_f32 v8, v8
  v_mul_f32 v9, s78, v181
  v_min_f32 v9, 0, v9
  v_exp_f32 v9, v9
  v_max_f32 v180, v14, v180
  v_fma_f32 v8, v8, v16, v17
  v_fma_f32 v180, v180, v15, v8
  v_max_f32 v181, v14, v181
  v_fma_f32 v9, v9, v16, v17
  v_fma_f32 v181, v181, v15, v9
  v_cvt_pk_bf16_f32 v64, v180, v181
  v_mul_f32 v8, s78, v182
  v_min_f32 v8, 0, v8
  v_exp_f32 v8, v8
  v_mul_f32 v9, s78, v183
  v_min_f32 v9, 0, v9
  v_exp_f32 v9, v9
  v_max_f32 v182, v14, v182
  v_fma_f32 v8, v8, v16, v17
  v_fma_f32 v182, v182, v15, v8
  v_max_f32 v183, v14, v183
  v_fma_f32 v9, v9, v16, v17
  v_fma_f32 v183, v183, v15, v9
  v_cvt_pk_bf16_f32 v65, v182, v183
  v_mul_f32 v8, s78, v184
  v_min_f32 v8, 0, v8
  v_exp_f32 v8, v8
  v_mul_f32 v9, s78, v185
  v_min_f32 v9, 0, v9
  v_exp_f32 v9, v9
  v_max_f32 v184, v14, v184
  v_fma_f32 v8, v8, v16, v17
  v_fma_f32 v184, v184, v15, v8
  v_max_f32 v185, v14, v185
  v_fma_f32 v9, v9, v16, v17
  v_fma_f32 v185, v185, v15, v9
  v_cvt_pk_bf16_f32 v66, v184, v185
  v_mul_f32 v8, s78, v186
  v_min_f32 v8, 0, v8
  v_exp_f32 v8, v8
  v_mul_f32 v9, s78, v187
  v_min_f32 v9, 0, v9
  v_exp_f32 v9, v9
  v_max_f32 v186, v14, v186
  v_fma_f32 v8, v8, v16, v17
  v_fma_f32 v186, v186, v15, v8
  v_max_f32 v187, v14, v187
  v_fma_f32 v9, v9, v16, v17
  v_fma_f32 v187, v187, v15, v9
  v_cvt_pk_bf16_f32 v67, v186, v187
  v_mul_f32 v8, s78, v188
  v_min_f32 v8, 0, v8
  v_exp_f32 v8, v8
  v_mul_f32 v9, s78, v189
  v_min_f32 v9, 0, v9
  v_exp_f32 v9, v9
  v_max_f32 v188, v14, v188
  v_fma_f32 v8, v8, v16, v17
  v_fma_f32 v188, v188, v15, v8
  v_max_f32 v189, v14, v189
  v_fma_f32 v9, v9, v16, v17
  v_fma_f32 v189, v189, v15, v9
  v_cvt_pk_bf16_f32 v68, v188, v189
  v_mul_f32 v8, s78, v190
  v_min_f32 v8, 0, v8
  v_exp_f32 v8, v8
  v_mul_f32 v9, s78, v191
  v_min_f32 v9, 0, v9
  v_exp_f32 v9, v9
  v_max_f32 v190, v14, v190
  v_fma_f32 v8, v8, v16, v17
  v_fma_f32 v190, v190, v15, v8
  v_max_f32 v191, v14, v191
  v_fma_f32 v9, v9, v16, v17
  v_fma_f32 v191, v191, v15, v9
  v_cvt_pk_bf16_f32 v69, v190, v191
  v_mul_f32 v8, s78, v192
  v_min_f32 v8, 0, v8
  v_exp_f32 v8, v8
  v_mul_f32 v9, s78, v193
  v_min_f32 v9, 0, v9
  v_exp_f32 v9, v9
  v_max_f32 v192, v14, v192
  v_fma_f32 v8, v8, v16, v17
  v_fma_f32 v192, v192, v15, v8
  v_max_f32 v193, v14, v193
  v_fma_f32 v9, v9, v16, v17
  v_fma_f32 v193, v193, v15, v9
  v_cvt_pk_bf16_f32 v70, v192, v193
  v_mul_f32 v8, s78, v194
  v_min_f32 v8, 0, v8
  v_exp_f32 v8, v8
  v_mul_f32 v9, s78, v195
  v_min_f32 v9, 0, v9
  v_exp_f32 v9, v9
  v_max_f32 v194, v14, v194
  v_fma_f32 v8, v8, v16, v17
  v_fma_f32 v194, v194, v15, v8
  v_max_f32 v195, v14, v195
  v_fma_f32 v9, v9, v16, v17
  v_fma_f32 v195, v195, v15, v9
  v_cvt_pk_bf16_f32 v71, v194, v195
  buffer_store_dwordx4 v[64:67], v13, s[4:7], s60 offen offset:0 sc1
  buffer_store_dwordx4 v[68:71], v13, s[4:7], s60 offen offset:16 sc1
  v_mfma_f32_32x32x16_bf16 v[196:211], v[64:67], v[56:59], v[196:211]
  v_mfma_f32_32x32x16_bf16 v[196:211], v[68:71], v[60:63], v[196:211]
  s_mov_b32 s53, s74
  s_cmp_ge_u32 s53, 64
  s_cbranch_scc1 A1_DONE
  s_cmp_eq_u32 s52, 0
  s_cbranch_scc1 A1_LOOP
A1_FETCH:
  s_and_b32 s61, s53, 3
  s_mul_i32 s61, s61, 1152
  s_add_u32 s61, s61, 16384
  s_add_u32 s77, s53, 1
  s_cmp_lg_u32 s51, 0
  s_cbranch_scc1 w0_14
  s_mov_b32 s55, 150000
poll_15:
  buffer_load_dword v8, v4, s[4:7], s61 offen sc1
  s_waitcnt vmcnt(0)
  v_cmp_gt_u32 vcc, s77, v8
  s_nop 0
  s_cbranch_vccz pdone_16
  s_sleep 1
  s_mov_b32 s58, 10
  s_sub_u32 s55, s55, 1
  s_cbranch_scc0 poll_15
  s_branch ABORT
pdone_16:
w0_14:
  s_waitcnt lgkmcnt(0)
  s_barrier
  s_mul_i32 s60, s53, 36864
  buffer_load_dwordx4 v[20:23], v1, s[8:11], s60 offen offset:0 sc1
  buffer_load_dwordx4 v[24:27], v1, s[8:11], s60 offen offset:128 sc1
  buffer_load_dwordx4 v[28:31], v1, s[8:11], s60 offen offset:256 sc1
  buffer_load_dwordx4 v[32:35], v1, s[8:11], s60 offen offset:384 sc1
  buffer_load_dwordx4 v[36:39], v1, s[8:11], s60 offen offset:512 sc1
  buffer_load_dwordx4 v[40:43], v1, s[8:11], s60 offen offset:640 sc1
  buffer_load_dwordx4 v[44:47], v1, s[8:11], s60 offen offset:768 sc1
  buffer_load_dwordx4 v[48:51], v1, s[8:11], s60 offen offset:896 sc1
  buffer_load_dwordx4 v[52:55], v1, s[8:11], s60 offen offset:1024 sc1
  s_waitcnt vmcnt(0)
  s_branch A1_LOOP
A1_DONE:
  v_mov_b32 v11, 1073741824
  v_subrev_u32 v8, s73, v7
  v_lshlrev_b32 v76, 2, v8
  v_lshl_add_u32 v76, v6, 9, v76
  v_cmp_gt_u32 vcc, 18, v8
  s_nop 1
  v_cndmask_b32 v76, v11, v76, vcc
  v_cndmask_b32 v78, v76, v11, s[96:97]
  v_cndmask_b32 v77, v11, v76, s[96:97]
  v_mov_b32 v10, v77
  s_cmp_eq_u32 s73, 0
  s_cselect_b64 vcc, -1, 0
  v_cndmask_b32 v77, v77, v76, vcc
  v_cndmask_b32 v79, v78, v11, vcc
  s_lshl_b32 s60, s72, 2
  s_add_u32 s60, s60, s51
  s_mul_i32 s60, s60, 2560
  s_mul_i32 s61, s52, 81920
  s_add_u32 s60, s60, s61
  s_add_u32 s62, s60, 524288
  s_lshl_b32 s61, s73, 7
  s_sub_u32 s60, s62, s61
  buffer_atomic_add_f32 v208, v10, s[4:7], s62 offen offset:1792 sc1
  buffer_atomic_add_f32 v196, v77, s[4:7], s60 offen offset:0 sc1
  buffer_atomic_add_f32 v197, v77, s[4:7], s60 offen offset:128 sc1
  buffer_atomic_add_f32 v198, v76, s[4:7], s60 offen offset:256 sc1
  buffer_atomic_add_f32 v199, v76, s[4:7], s60 offen offset:384 sc1
  buffer_atomic_add_f32 v200, v76, s[4:7], s60 offen offset:1024 sc1
  buffer_atomic_add_f32 v201, v76, s[4:7], s60 offen offset:1152 sc1
  buffer_atomic_add_f32 v202, v76, s[4:7], s60 offen offset:1280 sc1
  buffer_atomic_add_f32 v203, v76, s[4:7], s60 offen offset:1408 sc1
  buffer_atomic_add_f32 v204, v78, s[4:7], s60 offen offset:2048 sc1
  buffer_atomic_add_f32 v205, v78, s[4:7], s60 offen offset:2176 sc1
  buffer_atomic_add_f32 v206, v79, s[4:7], s60 offen offset:2304 sc1
  buffer_atomic_add_f32 v207, v79, s[4:7], s60 offen offset:2432 sc1
  s_waitcnt vmcnt(0) lgkmcnt(0)
  s_barrier
  s_lshl_b32 s60, s52, 3
  s_add_u32 s60, s60, s72
  s_lshl_b32 s60, s60, 7
  s_add_u32 s60, s60, 22528
  s_cmp_lg_u32 s51, 0
  s_cbranch_scc1 w0_17
  s_mov_b64 exec, 1
  v_mov_b32 v8, s60
  v_mov_b32 v9, 1
  buffer_atomic_add v9, v8, s[4:7], 0 offen sc1
  s_mov_b64 exec, -1
w0_17:
  s_cmp_lt_u32 s68, 96
  s_cbranch_scc1 R_QKV
  s_cmp_lt_u32 s68, 168
  s_cbranch_scc1 R_OUT
  s_cmp_eq_u32 s52, 1
  s_cbranch_scc1 W_END
  s_mov_b32 s52, 1
  s_mov_b32 s54, 104857600
  s_sub_u32 s53, s68, 168
  s_lshr_b32 s53, s53, 3
  s_mov_b32 s69, 3
  s_add_u32 s8, s48, 1048576
  s_addc_u32 s9, s49, 0
  s_mov_b32 s10, 2359296
  s_mov_b32 s11, 0x00020000
  v_mov_b64 v[196:197], 0
  v_mov_b64 v[198:199], 0
  v_mov_b64 v[200:201], 0
  v_mov_b64 v[202:203], 0
  v_mov_b64 v[204:205], 0
  v_mov_b64 v[206:207], 0
  v_mov_b64 v[208:209], 0
  v_mov_b64 v[210:211], 0
  s_branch A1_FETCH
R_QKV:
  s_lshr_b32 s73, s68, 5
  s_and_b32 s74, s68, 31
  s_lshl_b32 s72, s74, 8
  s_cmp_eq_u32 s73, 0
  s_cselect_b32 s12, s34, s36
  s_cselect_b32 s13, s35, s37
  s_cselect_b32 s69, 1, 2
  s_mov_b32 s14, 4718592
  s_add_u32 s70, s68, 32
  s_lshl_b32 s70, s70, 6
  v_and_b32 v13, 1, v0
  v_lshlrev_b32 v13, 8, v13
  v_lshl_add_u32 v13, v6, 9, v13
  v_bfe_u32 v8, v0, 1, 4
  v_lshl_add_u32 v13, v8, 4, v13
  v_min_u32 v4, 4, v0
  v_lshlrev_b32 v4, 6, v4
  s_waitcnt lgkmcnt(0)
  s_barrier
  v_lshrrev_b32 v8, 4, v0
  v_and_b32 v9, 15, v0
  v_lshlrev_b32 v10, 2, v8
  v_xor_b32 v9, v9, v10
  v_lshlrev_b32 v9, 4, v9
  v_mul_u32_u24 v10, 8192, v8
  v_add_u32 v10, v10, v9
  s_mul_i32 s60, s51, 32768
  s_add_u32 s60, s60, s72
  s_lshl_b32 s61, s51, 10
  s_mov_b32 m0, s61
  s_add_u32 s61, s61, 4096
  buffer_load_dwordx4 v10, s[12:15], s60 offen  lds
  s_add_u32 s60, s60, 131072
  s_mov_b32 m0, s61
  s_add_u32 s61, s61, 4096
  buffer_load_dwordx4 v10, s[12:15], s60 offen  lds
  s_add_u32 s60, s60, 131072
  s_mov_b32 m0, s61
  s_add_u32 s61, s61, 4096
  buffer_load_dwordx4 v10, s[12:15], s60 offen  lds
  s_add_u32 s60, s60, 131072
  s_mov_b32 m0, s61
  s_add_u32 s61, s61, 4096
  buffer_load_dwordx4 v10, s[12:15], s60 offen  lds
  s_add_u32 s60, s60, 131072
  s_mov_b32 m0, s61
  s_add_u32 s61, s61, 4096
  buffer_load_dwordx4 v10, s[12:15], s60 offen  lds
  s_add_u32 s60, s60, 131072
  s_mov_b32 m0, s61
  s_add_u32 s61, s61, 4096
  buffer_load_dwordx4 v10, s[12:15], s60 offen  lds
  s_add_u32 s60, s60, 131072
  s_mov_b32 m0, s61
  s_add_u32 s61, s61, 4096
  buffer_load_dwordx4 v10, s[12:15], s60 offen  lds
  s_add_u32 s60, s60, 131072
  s_mov_b32 m0, s61
  s_add_u32 s61, s61, 4096
  buffer_load_dwordx4 v10, s[12:15], s60 offen  lds
  s_add_u32 s60, s60, 131072
  s_mov_b32 m0, s61
  s_add_u32 s61, s61, 4096
  buffer_load_dwordx4 v10, s[12:15], s60 offen  lds
  s_add_u32 s60, s60, 131072
  s_mov_b32 m0, s61
  s_add_u32 s61, s61, 4096
  buffer_load_dwordx4 v10, s[12:15], s60 offen  lds
  s_add_u32 s60, s60, 131072
  s_mov_b32 m0, s61
  s_add_u32 s61, s61, 4096
  buffer_load_dwordx4 v10, s[12:15], s60 offen  lds
  s_add_u32 s60, s60, 131072
  s_mov_b32 m0, s61
  s_add_u32 s61, s61, 4096
  buffer_load_dwordx4 v10, s[12:15], s60 offen  lds
  s_add_u32 s60, s60, 131072
  s_mov_b32 m0, s61
  s_add_u32 s61, s61, 4096
  buffer_load_dwordx4 v10, s[12:15], s60 offen  lds
  s_add_u32 s60, s60, 131072
  s_mov_b32 m0, s61
  s_add_u32 s61, s61, 4096
  buffer_load_dwordx4 v10, s[12:15], s60 offen  lds
  s_add_u32 s60, s60, 131072
  s_mov_b32 m0, s61
  s_add_u32 s61, s61, 4096
  buffer_load_dwordx4 v10, s[12:15], s60 offen  lds
  s_add_u32 s60, s60, 131072
  s_mov_b32 m0, s61
  s_add_u32 s61, s61, 4096
  buffer_load_dwordx4 v10, s[12:15], s60 offen  lds
  s_add_u32 s60, s60, 131072
  s_mov_b32 m0, s61
  s_add_u32 s61, s61, 4096
  buffer_load_dwordx4 v10, s[12:15], s60 offen  lds
  s_add_u32 s60, s60, 131072
  s_mov_b32 m0, s61
  s_add_u32 s61, s61, 4096
  buffer_load_dwordx4 v10, s[12:15], s60 offen  lds
  s_add_u32 s60, s60, 131072
  s_mov_b32 m0, s61
  s_add_u32 s61, s61, 4096
  buffer_load_dwordx4 v10, s[12:15], s60 offen  lds
  s_add_u32 s60, s60, 131072
  s_mov_b32 m0, s61
  s_add_u32 s61, s61, 4096
  buffer_load_dwordx4 v10, s[12:15], s60 offen  lds
  s_add_u32 s60, s60, 131072
  s_mov_b32 m0, s61
  s_add_u32 s61, s61, 4096
  buffer_load_dwordx4 v10, s[12:15], s60 offen  lds
  s_add_u32 s60, s60, 131072
  s_mov_b32 m0, s61
  s_add_u32 s61, s61, 4096
  buffer_load_dwordx4 v10, s[12:15], s60 offen  lds
  s_add_u32 s60, s60, 131072
  s_mov_b32 m0, s61
  s_add_u32 s61, s61, 4096
  buffer_load_dwordx4 v10, s[12:15], s60 offen  lds
  s_add_u32 s60, s60, 131072
  s_mov_b32 m0, s61
  s_add_u32 s61, s61, 4096
  buffer_load_dwordx4 v10, s[12:15], s60 offen  lds
  s_add_u32 s60, s60, 131072
  s_mov_b32 m0, s61
  s_add_u32 s61, s61, 4096
  buffer_load_dwordx4 v10, s[12:15], s60 offen  lds
  s_add_u32 s60, s60, 131072
  s_mov_b32 m0, s61
  s_add_u32 s61, s61, 4096
  buffer_load_dwordx4 v10, s[12:15], s60 offen  lds
  s_add_u32 s60, s60, 131072
  s_mov_b32 m0, s61
  s_add_u32 s61, s61, 4096
  buffer_load_dwordx4 v10, s[12:15], s60 offen  lds
  s_add_u32 s60, s60, 131072
  s_mov_b32 m0, s61
  s_add_u32 s61, s61, 4096
  buffer_load_dwordx4 v10, s[12:15], s60 offen  lds
  s_add_u32 s60, s60, 131072
  s_mov_b32 m0, s61
  s_add_u32 s61, s61, 4096
  buffer_load_dwordx4 v10, s[12:15], s60 offen  lds
  s_add_u32 s60, s60, 131072
  s_mov_b32 m0, s61
  s_add_u32 s61, s61, 4096
  buffer_load_dwordx4 v10, s[12:15], s60 offen  lds
  s_add_u32 s60, s60, 131072
  s_mov_b32 m0, s61
  s_add_u32 s61, s61, 4096
  buffer_load_dwordx4 v10, s[12:15], s60 offen  lds
  s_add_u32 s60, s60, 131072
  s_mov_b32 m0, s61
  s_add_u32 s61, s61, 4096
  buffer_load_dwordx4 v10, s[12:15], s60 offen  lds
  s_add_u32 s60, s60, 131072
  s_mov_b32 m0, s61
  s_add_u32 s61, s61, 4096
  buffer_load_dwordx4 v10, s[12:15], s60 offen  lds
  s_add_u32 s60, s60, 131072
  s_mov_b32 m0, s61
  s_add_u32 s61, s61, 4096
  buffer_load_dwordx4 v10, s[12:15], s60 offen  lds
  s_add_u32 s60, s60, 131072
  s_mov_b32 m0, s61
  s_add_u32 s61, s61, 4096
  buffer_load_dwordx4 v10, s[12:15], s60 offen  lds
  s_add_u32 s60, s60, 131072
  s_mov_b32 m0, s61
  s_add_u32 s61, s61, 4096
  buffer_load_dwordx4 v10, s[12:15], s60 offen  lds
  s_add_u32 s60, s60, 131072
  v_bfe_u32 v8, v0, 4, 1
  v_bfe_u32 v9, v0, 2, 2
  v_and_b32 v10, 3, v0
  v_xor_b32 v11, s51, v9
  v_lshlrev_b32 v11, 6, v11
  v_lshl_add_u32 v11, v8, 5, v11
  v_lshl_add_u32 v11, v10, 3, v11
  v_lshl_add_u32 v11, v9, 8, v11
  v_lshl_add_u32 v11, v6, 11, v11
  s_waitcnt vmcnt(0) lgkmcnt(0)
  s_barrier
  ds_read_b64_tr_b16 a[0:1], v11 offset:0
  ds_read_b64_tr_b16 a[2:3], v11 offset:1024
  ds_read_b64_tr_b16 a[4:5], v11 offset:4096
  ds_read_b64_tr_b16 a[6:7], v11 offset:5120
  ds_read_b64_tr_b16 a[8:9], v11 offset:8192
  ds_read_b64_tr_b16 a[10:11], v11 offset:9216
  ds_read_b64_tr_b16 a[12:13], v11 offset:12288
  ds_read_b64_tr_b16 a[14:15], v11 offset:13312
  ds_read_b64_tr_b16 a[16:17], v11 offset:16384
  ds_read_b64_tr_b16 a[18:19], v11 offset:17408
  ds_read_b64_tr_b16 a[20:21], v11 offset:20480
  ds_read_b64_tr_b16 a[22:23], v11 offset:21504
  ds_read_b64_tr_b16 a[24:25], v11 offset:24576
  ds_read_b64_tr_b16 a[26:27], v11 offset:25600
  ds_read_b64_tr_b16 a[28:29], v11 offset:28672
  ds_read_b64_tr_b16 a[30:31], v11 offset:29696
  ds_read_b64_tr_b16 a[32:33], v11 offset:32768
  ds_read_b64_tr_b16 a[34:35], v11 offset:33792
  ds_read_b64_tr_b16 a[36:37], v11 offset:36864
  ds_read_b64_tr_b16 a[38:39], v11 offset:37888
  ds_read_b64_tr_b16 a[40:41], v11 offset:40960
  ds_read_b64_tr_b16 a[42:43], v11 offset:41984
  ds_read_b64_tr_b16 a[44:45], v11 offset:45056
  ds_read_b64_tr_b16 a[46:47], v11 offset:46080
  ds_read_b64_tr_b16 a[48:49], v11 offset:49152
  ds_read_b64_tr_b16 a[50:51], v11 offset:50176
  ds_read_b64_tr_b16 a[52:53], v11 offset:53248
  ds_read_b64_tr_b16 a[54:55], v11 offset:54272
  ds_read_b64_tr_b16 a[56:57], v11 offset:57344
  ds_read_b64_tr_b16 a[58:59], v11 offset:58368
  ds_read_b64_tr_b16 a[60:61], v11 offset:61440
  ds_read_b64_tr_b16 a[62:63], v11 offset:62464
  v_add_u32 v11, 0x10000, v11
  ds_read_b64_tr_b16 a[64:65], v11 offset:0
  ds_read_b64_tr_b16 a[66:67], v11 offset:1024
  ds_read_b64_tr_b16 a[68:69], v11 offset:4096
  ds_read_b64_tr_b16 a[70:71], v11 offset:5120
  ds_read_b64_tr_b16 a[72:73], v11 offset:8192
  ds_read_b64_tr_b16 a[74:75], v11 offset:9216
  ds_read_b64_tr_b16 a[76:77], v11 offset:12288
  ds_read_b64_tr_b16 a[78:79], v11 offset:13312
  ds_read_b64_tr_b16 a[80:81], v11 offset:16384
  ds_read_b64_tr_b16 a[82:83], v11 offset:17408
  ds_read_b64_tr_b16 a[84:85], v11 offset:20480
  ds_read_b64_tr_b16 a[86:87], v11 offset:21504
  ds_read_b64_tr_b16 a[88:89], v11 offset:24576
  ds_read_b64_tr_b16 a[90:91], v11 offset:25600
  ds_read_b64_tr_b16 a[92:93], v11 offset:28672
  ds_read_b64_tr_b16 a[94:95], v11 offset:29696
  ds_read_b64_tr_b16 a[96:97], v11 offset:32768
  ds_read_b64_tr_b16 a[98:99], v11 offset:33792
  ds_read_b64_tr_b16 a[100:101], v11 offset:36864
  ds_read_b64_tr_b16 a[102:103], v11 offset:37888
  ds_read_b64_tr_b16 a[104:105], v11 offset:40960
  ds_read_b64_tr_b16 a[106:107], v11 offset:41984
  ds_read_b64_tr_b16 a[108:109], v11 offset:45056
  ds_read_b64_tr_b16 a[110:111], v11 offset:46080
  ds_read_b64_tr_b16 a[112:113], v11 offset:49152
  ds_read_b64_tr_b16 a[114:115], v11 offset:50176
  ds_read_b64_tr_b16 a[116:117], v11 offset:53248
  ds_read_b64_tr_b16 a[118:119], v11 offset:54272
  ds_read_b64_tr_b16 a[120:121], v11 offset:57344
  ds_read_b64_tr_b16 a[122:123], v11 offset:58368
  ds_read_b64_tr_b16 a[124:125], v11 offset:61440
  ds_read_b64_tr_b16 a[126:127], v11 offset:62464
  v_add_u32 v11, 0x10000, v11
  ds_read_b64_tr_b16 a[128:129], v11 offset:0
  ds_read_b64_tr_b16 a[130:131], v11 offset:1024
  ds_read_b64_tr_b16 a[132:133], v11 offset:4096
  ds_read_b64_tr_b16 a[134:135], v11 offset:5120
  ds_read_b64_tr_b16 a[136:137], v11 offset:8192
  ds_read_b64_tr_b16 a[138:139], v11 offset:9216
  ds_read_b64_tr_b16 a[140:141], v11 offset:12288
  ds_read_b64_tr_b16 a[142:143], v11 offset:13312
  s_waitcnt lgkmcnt(0)
  s_barrier
  s_cmp_eq_u32 s73, 0
  s_cbranch_scc1 Q_W
  s_mov_b32 s12, s38
  s_mov_b32 s13, s39
  s_waitcnt lgkmcnt(0)
  s_barrier
  v_lshrrev_b32 v8, 4, v0
  v_and_b32 v9, 15, v0
  v_lshlrev_b32 v10, 2, v8
  v_xor_b32 v9, v9, v10
  v_lshlrev_b32 v9, 4, v9
  v_mul_u32_u24 v10, 8192, v8
  v_add_u32 v10, v10, v9
  s_mul_i32 s60, s51, 32768
  s_add_u32 s60, s60, s72
  s_lshl_b32 s61, s51, 10
  s_mov_b32 m0, s61
  s_add_u32 s61, s61, 4096
  buffer_load_dwordx4 v10, s[12:15], s60 offen  lds
  s_add_u32 s60, s60, 131072
  s_mov_b32 m0, s61
  s_add_u32 s61, s61, 4096
  buffer_load_dwordx4 v10, s[12:15], s60 offen  lds
  s_add_u32 s60, s60, 131072
  s_mov_b32 m0, s61
  s_add_u32 s61, s61, 4096
  buffer_load_dwordx4 v10, s[12:15], s60 offen  lds
  s_add_u32 s60, s60, 131072
  s_mov_b32 m0, s61
  s_add_u32 s61, s61, 4096
  buffer_load_dwordx4 v10, s[12:15], s60 offen  lds
  s_add_u32 s60, s60, 131072
  s_mov_b32 m0, s61
  s_add_u32 s61, s61, 4096
  buffer_load_dwordx4 v10, s[12:15], s60 offen  lds
  s_add_u32 s60, s60, 131072
  s_mov_b32 m0, s61
  s_add_u32 s61, s61, 4096
  buffer_load_dwordx4 v10, s[12:15], s60 offen  lds
  s_add_u32 s60, s60, 131072
  s_mov_b32 m0, s61
  s_add_u32 s61, s61, 4096
  buffer_load_dwordx4 v10, s[12:15], s60 offen  lds
  s_add_u32 s60, s60, 131072
  s_mov_b32 m0, s61
  s_add_u32 s61, s61, 4096
  buffer_load_dwordx4 v10, s[12:15], s60 offen  lds
  s_add_u32 s60, s60, 131072
  s_mov_b32 m0, s61
  s_add_u32 s61, s61, 4096
  buffer_load_dwordx4 v10, s[12:15], s60 offen  lds
  s_add_u32 s60, s60, 131072
  s_mov_b32 m0, s61
  s_add_u32 s61, s61, 4096
  buffer_load_dwordx4 v10, s[12:15], s60 offen  lds
  s_add_u32 s60, s60, 131072
  s_mov_b32 m0, s61
  s_add_u32 s61, s61, 4096
  buffer_load_dwordx4 v10, s[12:15], s60 offen  lds
  s_add_u32 s60, s60, 131072
  s_mov_b32 m0, s61
  s_add_u32 s61, s61, 4096
  buffer_load_dwordx4 v10, s[12:15], s60 offen  lds
  s_add_u32 s60, s60, 131072
  s_mov_b32 m0, s61
  s_add_u32 s61, s61, 4096
  buffer_load_dwordx4 v10, s[12:15], s60 offen  lds
  s_add_u32 s60, s60, 131072
  s_mov_b32 m0, s61
  s_add_u32 s61, s61, 4096
  buffer_load_dwordx4 v10, s[12:15], s60 offen  lds
  s_add_u32 s60, s60, 131072
  s_mov_b32 m0, s61
  s_add_u32 s61, s61, 4096
  buffer_load_dwordx4 v10, s[12:15], s60 offen  lds
  s_add_u32 s60, s60, 131072
  s_mov_b32 m0, s61
  s_add_u32 s61, s61, 4096
  buffer_load_dwordx4 v10, s[12:15], s60 offen  lds
  s_add_u32 s60, s60, 131072
  s_mov_b32 m0, s61
  s_add_u32 s61, s61, 4096
  buffer_load_dwordx4 v10, s[12:15], s60 offen  lds
  s_add_u32 s60, s60, 131072
  s_mov_b32 m0, s61
  s_add_u32 s61, s61, 4096
  buffer_load_dwordx4 v10, s[12:15], s60 offen  lds
  s_add_u32 s60, s60, 131072
  s_mov_b32 m0, s61
  s_add_u32 s61, s61, 4096
  buffer_load_dwordx4 v10, s[12:15], s60 offen  lds
  s_add_u32 s60, s60, 131072
  s_mov_b32 m0, s61
  s_add_u32 s61, s61, 4096
  buffer_load_dwordx4 v10, s[12:15], s60 offen  lds
  s_add_u32 s60, s60, 131072
  s_mov_b32 m0, s61
  s_add_u32 s61, s61, 4096
  buffer_load_dwordx4 v10, s[12:15], s60 offen  lds
  s_add_u32 s60, s60, 131072
  s_mov_b32 m0, s61
  s_add_u32 s61, s61, 4096
  buffer_load_dwordx4 v10, s[12:15], s60 offen  lds
  s_add_u32 s60, s60, 131072
  s_mov_b32 m0, s61
  s_add_u32 s61, s61, 4096
  buffer_load_dwordx4 v10, s[12:15], s60 offen  lds
  s_add_u32 s60, s60, 131072
  s_mov_b32 m0, s61
  s_add_u32 s61, s61, 4096
  buffer_load_dwordx4 v10, s[12:15], s60 offen  lds
  s_add_u32 s60, s60, 131072
  s_mov_b32 m0, s61
  s_add_u32 s61, s61, 4096
  buffer_load_dwordx4 v10, s[12:15], s60 offen  lds
  s_add_u32 s60, s60, 131072
  s_mov_b32 m0, s61
  s_add_u32 s61, s61, 4096
  buffer_load_dwordx4 v10, s[12:15], s60 offen  lds
  s_add_u32 s60, s60, 131072
  s_mov_b32 m0, s61
  s_add_u32 s61, s61, 4096
  buffer_load_dwordx4 v10, s[12:15], s60 offen  lds
  s_add_u32 s60, s60, 131072
  s_mov_b32 m0, s61
  s_add_u32 s61, s61, 4096
  buffer_load_dwordx4 v10, s[12:15], s60 offen  lds
  s_add_u32 s60, s60, 131072
  s_mov_b32 m0, s61
  s_add_u32 s61, s61, 4096
  buffer_load_dwordx4 v10, s[12:15], s60 offen  lds
  s_add_u32 s60, s60, 131072
  s_mov_b32 m0, s61
  s_add_u32 s61, s61, 4096
  buffer_load_dwordx4 v10, s[12:15], s60 offen  lds
  s_add_u32 s60, s60, 131072
  s_mov_b32 m0, s61
  s_add_u32 s61, s61, 4096
  buffer_load_dwordx4 v10, s[12:15], s60 offen  lds
  s_add_u32 s60, s60, 131072
  s_mov_b32 m0, s61
  s_add_u32 s61, s61, 4096
  buffer_load_dwordx4 v10, s[12:15], s60 offen  lds
  s_add_u32 s60, s60, 131072
  s_mov_b32 m0, s61
  s_add_u32 s61, s61, 4096
  buffer_load_dwordx4 v10, s[12:15], s60 offen  lds
  s_add_u32 s60, s60, 131072
  s_mov_b32 m0, s61
  s_add_u32 s61, s61, 4096
  buffer_load_dwordx4 v10, s[12:15], s60 offen  lds
  s_add_u32 s60, s60, 131072
  s_mov_b32 m0, s61
  s_add_u32 s61, s61, 4096
  buffer_load_dwordx4 v10, s[12:15], s60 offen  lds
  s_add_u32 s60, s60, 131072
  s_mov_b32 m0, s61
  s_add_u32 s61, s61, 4096
  buffer_load_dwordx4 v10, s[12:15], s60 offen  lds
  s_add_u32 s60, s60, 131072
  v_bfe_u32 v8, v0, 4, 1
  v_bfe_u32 v9, v0, 2, 2
  v_and_b32 v10, 3, v0
  v_xor_b32 v11, s51, v9
  v_lshlrev_b32 v11, 6, v11
  v_lshl_add_u32 v11, v8, 5, v11
  v_lshl_add_u32 v11, v10, 3, v11
  v_lshl_add_u32 v11, v9, 8, v11
  v_lshl_add_u32 v11, v6, 11, v11
  s_waitcnt vmcnt(0) lgkmcnt(0)
  s_barrier
  ds_read_b64_tr_b16 a[144:145], v11 offset:0
  ds_read_b64_tr_b16 a[146:147], v11 offset:1024
  ds_read_b64_tr_b16 a[148:149], v11 offset:4096
  ds_read_b64_tr_b16 a[150:151], v11 offset:5120
  ds_read_b64_tr_b16 a[152:153], v11 offset:8192
  ds_read_b64_tr_b16 a[154:155], v11 offset:9216
  ds_read_b64_tr_b16 a[156:157], v11 offset:12288
  ds_read_b64_tr_b16 a[158:159], v11 offset:13312
  ds_read_b64_tr_b16 a[160:161], v11 offset:16384
  ds_read_b64_tr_b16 a[162:163], v11 offset:17408
  ds_read_b64_tr_b16 a[164:165], v11 offset:20480
  ds_read_b64_tr_b16 a[166:167], v11 offset:21504
  ds_read_b64_tr_b16 a[168:169], v11 offset:24576
  ds_read_b64_tr_b16 a[170:171], v11 offset:25600
  ds_read_b64_tr_b16 a[172:173], v11 offset:28672
  ds_read_b64_tr_b16 a[174:175], v11 offset:29696
  ds_read_b64_tr_b16 a[176:177], v11 offset:32768
  ds_read_b64_tr_b16 a[178:179], v11 offset:33792
  ds_read_b64_tr_b16 a[180:181], v11 offset:36864
  ds_read_b64_tr_b16 a[182:183], v11 offset:37888
  ds_read_b64_tr_b16 a[184:185], v11 offset:40960
  ds_read_b64_tr_b16 a[186:187], v11 offset:41984
  ds_read_b64_tr_b16 a[188:189], v11 offset:45056
  ds_read_b64_tr_b16 a[190:191], v11 offset:46080
  ds_read_b64_tr_b16 a[192:193], v11 offset:49152
  ds_read_b64_tr_b16 a[194:195], v11 offset:50176
  ds_read_b64_tr_b16 a[196:197], v11 offset:53248
  ds_read_b64_tr_b16 a[198:199], v11 offset:54272
  ds_read_b64_tr_b16 a[200:201], v11 offset:57344
  ds_read_b64_tr_b16 a[202:203], v11 offset:58368
  ds_read_b64_tr_b16 a[204:205], v11 offset:61440
  ds_read_b64_tr_b16 a[206:207], v11 offset:62464
  v_add_u32 v11, 0x10000, v11
  ds_read_b64_tr_b16 a[208:209], v11 offset:0
  ds_read_b64_tr_b16 a[210:211], v11 offset:1024
  ds_read_b64_tr_b16 a[212:213], v11 offset:4096
  ds_read_b64_tr_b16 a[214:215], v11 offset:5120
  ds_read_b64_tr_b16 a[216:217], v11 offset:8192
  ds_read_b64_tr_b16 a[218:219], v11 offset:9216
  ds_read_b64_tr_b16 a[220:221], v11 offset:12288
  ds_read_b64_tr_b16 a[222:223], v11 offset:13312
  ds_read_b64_tr_b16 a[224:225], v11 offset:16384
  ds_read_b64_tr_b16 a[226:227], v11 offset:17408
  ds_read_b64_tr_b16 a[228:229], v11 offset:20480
  ds_read_b64_tr_b16 a[230:231], v11 offset:21504
  ds_read_b64_tr_b16 a[232:233], v11 offset:24576
  ds_read_b64_tr_b16 a[234:235], v11 offset:25600
  ds_read_b64_tr_b16 a[236:237], v11 offset:28672
  ds_read_b64_tr_b16 a[238:239], v11 offset:29696
  ds_read_b64_tr_b16 a[240:241], v11 offset:32768
  ds_read_b64_tr_b16 a[242:243], v11 offset:33792
  ds_read_b64_tr_b16 a[244:245], v11 offset:36864
  ds_read_b64_tr_b16 a[246:247], v11 offset:37888
  ds_read_b64_tr_b16 a[248:249], v11 offset:40960
  ds_read_b64_tr_b16 a[250:251], v11 offset:41984
  ds_read_b64_tr_b16 a[252:253], v11 offset:45056
  ds_read_b64_tr_b16 a[254:255], v11 offset:46080
  ds_read_b64_tr_b16 v[224:225], v11 offset:49152
  ds_read_b64_tr_b16 v[226:227], v11 offset:50176
  ds_read_b64_tr_b16 v[228:229], v11 offset:53248
  ds_read_b64_tr_b16 v[230:231], v11 offset:54272
  ds_read_b64_tr_b16 v[232:233], v11 offset:57344
  ds_read_b64_tr_b16 v[234:235], v11 offset:58368
  ds_read_b64_tr_b16 v[236:237], v11 offset:61440
  ds_read_b64_tr_b16 v[238:239], v11 offset:62464
  v_add_u32 v11, 0x10000, v11
  ds_read_b64_tr_b16 v[240:241], v11 offset:0
  ds_read_b64_tr_b16 v[242:243], v11 offset:1024
  ds_read_b64_tr_b16 v[244:245], v11 offset:4096
  ds_read_b64_tr_b16 v[246:247], v11 offset:5120
  ds_read_b64_tr_b16 v[248:249], v11 offset:8192
  ds_read_b64_tr_b16 v[250:251], v11 offset:9216
  ds_read_b64_tr_b16 v[252:253], v11 offset:12288
  ds_read_b64_tr_b16 v[254:255], v11 offset:13312
  s_waitcnt lgkmcnt(0)
  s_barrier
Q_W:
Q_LAYER:
  v_mov_b32 v12, -1
  s_lshr_b32 s53, s73, 1
  s_lshl_b32 s71, s52, 6
  s_add_u32 s71, s71, s53
  s_sub_u32 s75, s69, 1
  s_lshl_b32 s75, s75, 24
  s_lshl_b32 s60, s53, 18
  s_add_u32 s75, s75, s60
  s_mul_i32 s61, s53, 320
  s_lshl_b32 s60, s74, 13
  s_add_u32 s75, s75, s60
  s_lshl_b32 s60, s51, 11
  s_add_u32 s75, s75, s60
  s_add_u32 s75, s75, s54
  s_add_u32 s75, s75, 6291456
  s_add_u32 s60, s54, 3145728
  s_add_u32 s8, s48, s60
  s_addc_u32 s9, s49, 0
  s_lshl_b32 s77, s52, 6
  s_add_u32 s77, s77, s53
  s_add_u32 s77, s77, 1
  s_cmp_lg_u32 s51, 0
  s_cbranch_scc1 w0_18
  s_mov_b32 s55, 150000
poll_19:
  buffer_load_dword v8, v4, s[4:7], s61 offen sc1
  s_waitcnt vmcnt(0)
  v_cmp_gt_u32 vcc, s77, v8
  s_nop 0
  s_cbranch_vccz pdone_20
  s_sleep 1
  s_mov_b32 s58, 21
  s_sub_u32 s55, s55, 1
  s_cbranch_scc0 poll_19
  s_branch ABORT
pdone_20:
w0_18:
  s_waitcnt lgkmcnt(0)
  s_barrier
  s_lshl_b32 s77, s52, 6
  s_add_u32 s77, s77, s53
  s_add_u32 s77, s77, 1
  v_cmp_gt_u32 vcc, s77, v12
  s_nop 0
  s_cbranch_vccz qok_21
  s_mov_b32 s61, s53
  s_and_b32 s61, s61, 3
  s_mul_i32 s61, s61, 320
  s_mov_b32 s55, 150000
poll_22:
  buffer_load_dword v8, v4, s[4:7], s61 offen sc1
  s_waitcnt vmcnt(0)
  v_cmp_gt_u32 vcc, s77, v8
  s_nop 0
  s_cbranch_vccz pdone_23
  s_sleep 1
  s_mov_b32 s58, 20
  s_sub_u32 s55, s55, 1
  s_cbranch_scc0 poll_22
  s_branch ABORT
pdone_23:
qok_21:
  s_add_u32 s61, s53, s69
  s_and_b32 s61, s61, 3
  s_mul_i32 s61, s61, 320
  s_mul_i32 s60, s53, 36864
  buffer_load_dwordx4 v[20:23], v1, s[8:11], s60 offen offset:0 sc1
  buffer_load_dwordx4 v[24:27], v1, s[8:11], s60 offen offset:128 sc1
  buffer_load_dwordx4 v[28:31], v1, s[8:11], s60 offen offset:256 sc1
  buffer_load_dwordx4 v[32:35], v1, s[8:11], s60 offen offset:384 sc1
  buffer_load_dwordx4 v[36:39], v1, s[8:11], s60 offen offset:512 sc1
  buffer_load_dwordx4 v[40:43], v1, s[8:11], s60 offen offset:640 sc1
  buffer_load_dwordx4 v[44:47], v1, s[8:11], s60 offen offset:768 sc1
  buffer_load_dwordx4 v[48:51], v1, s[8:11], s60 offen offset:896 sc1
  buffer_load_dwordx4 v[52:55], v1, s[8:11], s60 offen offset:1024 sc1
  buffer_load_dword v12, v4, s[4:7], s61 offen sc1
  s_waitcnt vmcnt(0)
Q_LOOP:
  v_lshlrev_b32 v56, 16, v20
  v_and_b32 v57, 0xffff0000, v20
  v_lshlrev_b32 v58, 16, v21
  v_and_b32 v59, 0xffff0000, v21
  v_lshlrev_b32 v60, 16, v22
  v_and_b32 v61, 0xffff0000, v22
  v_lshlrev_b32 v62, 16, v23
  v_and_b32 v63, 0xffff0000, v23
  v_lshlrev_b32 v64, 16, v24
  v_and_b32 v65, 0xffff0000, v24
  v_lshlrev_b32 v66, 16, v25
  v_and_b32 v67, 0xffff0000, v25
  v_lshlrev_b32 v68, 16, v26
  v_and_b32 v69, 0xffff0000, v26
  v_lshlrev_b32 v70, 16, v27
  v_and_b32 v71, 0xffff0000, v27
  v_lshlrev_b32 v72, 16, v28
  v_and_b32 v73, 0xffff0000, v28
  v_lshlrev_b32 v74, 16, v29
  v_and_b32 v75, 0xffff0000, v29
  v_lshlrev_b32 v76, 16, v30
  v_and_b32 v77, 0xffff0000, v30
  v_lshlrev_b32 v78, 16, v31
  v_and_b32 v79, 0xffff0000, v31
  v_lshlrev_b32 v80, 16, v32
  v_and_b32 v81, 0xffff0000, v32
  v_lshlrev_b32 v82, 16, v33
  v_and_b32 v83, 0xffff0000, v33
  v_lshlrev_b32 v84, 16, v34
  v_and_b32 v85, 0xffff0000, v34
  v_lshlrev_b32 v86, 16, v35
  v_and_b32 v87, 0xffff0000, v35
  v_lshlrev_b32 v88, 16, v36
  v_and_b32 v89, 0xffff0000, v36
  v_lshlrev_b32 v90, 16, v37
  v_and_b32 v91, 0xffff0000, v37
  v_lshlrev_b32 v92, 16, v38
  v_and_b32 v93, 0xffff0000, v38
  v_lshlrev_b32 v94, 16, v39
  v_and_b32 v95, 0xffff0000, v39
  v_lshlrev_b32 v96, 16, v40
  v_and_b32 v97, 0xffff0000, v40
  v_lshlrev_b32 v98, 16, v41
  v_and_b32 v99, 0xffff0000, v41
  v_lshlrev_b32 v100, 16, v42
  v_and_b32 v101, 0xffff0000, v42
  v_lshlrev_b32 v102, 16, v43
  v_and_b32 v103, 0xffff0000, v43
  v_lshlrev_b32 v104, 16, v44
  v_and_b32 v105, 0xffff0000, v44
  v_lshlrev_b32 v106, 16, v45
  v_and_b32 v107, 0xffff0000, v45
  v_lshlrev_b32 v108, 16, v46
  v_and_b32 v109, 0xffff0000, v46
  v_lshlrev_b32 v110, 16, v47
  v_and_b32 v111, 0xffff0000, v47
  v_lshlrev_b32 v112, 16, v48
  v_and_b32 v113, 0xffff0000, v48
  v_lshlrev_b32 v114, 16, v49
  v_and_b32 v115, 0xffff0000, v49
  v_lshlrev_b32 v116, 16, v50
  v_and_b32 v117, 0xffff0000, v50
  v_lshlrev_b32 v118, 16, v51
  v_and_b32 v119, 0xffff0000, v51
  v_lshlrev_b32 v120, 16, v52
  v_and_b32 v121, 0xffff0000, v52
  v_lshlrev_b32 v122, 16, v53
  v_and_b32 v123, 0xffff0000, v53
  v_lshlrev_b32 v124, 16, v54
  v_and_b32 v125, 0xffff0000, v54
  v_lshlrev_b32 v126, 16, v55
  v_and_b32 v127, 0xffff0000, v55
  v_pk_add_f32 v[8:9], v[56:57], v[58:59]
  v_pk_add_f32 v[10:11], v[60:61], v[62:63]
  v_pk_add_f32 v[8:9], v[8:9], v[64:65]
  v_pk_add_f32 v[10:11], v[10:11], v[66:67]
  v_pk_add_f32 v[8:9], v[8:9], v[68:69]
  v_pk_add_f32 v[10:11], v[10:11], v[70:71]
  v_pk_add_f32 v[8:9], v[8:9], v[72:73]
  v_pk_add_f32 v[10:11], v[10:11], v[74:75]
  v_pk_add_f32 v[8:9], v[8:9], v[76:77]
  v_pk_add_f32 v[10:11], v[10:11], v[78:79]
  v_pk_add_f32 v[8:9], v[8:9], v[80:81]
  v_pk_add_f32 v[10:11], v[10:11], v[82:83]
  v_pk_add_f32 v[8:9], v[8:9], v[84:85]
  v_pk_add_f32 v[10:11], v[10:11], v[86:87]
  v_pk_add_f32 v[8:9], v[8:9], v[88:89]
  v_pk_add_f32 v[10:11], v[10:11], v[90:91]
  v_pk_add_f32 v[8:9], v[8:9], v[92:93]
  v_pk_add_f32 v[10:11], v[10:11], v[94:95]
  v_pk_add_f32 v[8:9], v[8:9], v[96:97]
  v_pk_add_f32 v[10:11], v[10:11], v[98:99]
  v_pk_add_f32 v[8:9], v[8:9], v[100:101]
  v_pk_add_f32 v[10:11], v[10:11], v[102:103]
  v_pk_add_f32 v[8:9], v[8:9], v[104:105]
  v_pk_add_f32 v[10:11], v[10:11], v[106:107]
  v_pk_add_f32 v[8:9], v[8:9], v[108:109]
  v_pk_add_f32 v[10:11], v[10:11], v[110:111]
  v_pk_add_f32 v[8:9], v[8:9], v[112:113]
  v_pk_add_f32 v[10:11], v[10:11], v[114:115]
  v_pk_add_f32 v[8:9], v[8:9], v[116:117]
  v_pk_add_f32 v[10:11], v[10:11], v[118:119]
  v_pk_add_f32 v[8:9], v[8:9], v[120:121]
  v_pk_add_f32 v[10:11], v[10:11], v[122:123]
  v_pk_add_f32 v[8:9], v[8:9], v[124:125]
  v_pk_add_f32 v[10:11], v[10:11], v[126:127]
  v_pk_add_f32 v[8:9], v[8:9], v[10:11]
  v_add_f32 v8, v8, v9
  s_nop 1
  v_add_f32_dpp v8, v8, v8 quad_perm:[1,0,3,2] row_mask:0xf bank_mask:0xf
  s_nop 1
  v_add_f32_dpp v8, v8, v8 quad_perm:[2,3,0,1] row_mask:0xf bank_mask:0xf
  s_nop 1
  v_add_f32_dpp v8, v8, v8 row_half_mirror row_mask:0xf bank_mask:0xf
  v_mul_f32 v8, 0xbae38e39, v8
  v_pk_add_f32 v[56:57], v[56:57], v[8:9] op_sel_hi:[1,0]
  v_pk_add_f32 v[58:59], v[58:59], v[8:9] op_sel_hi:[1,0]
  v_pk_add_f32 v[60:61], v[60:61], v[8:9] op_sel_hi:[1,0]
  v_pk_add_f32 v[62:63], v[62:63], v[8:9] op_sel_hi:[1,0]
  v_pk_add_f32 v[64:65], v[64:65], v[8:9] op_sel_hi:[1,0]
  v_pk_add_f32 v[66:67], v[66:67], v[8:9] op_sel_hi:[1,0]
  v_pk_add_f32 v[68:69], v[68:69], v[8:9] op_sel_hi:[1,0]
  v_pk_add_f32 v[70:71], v[70:71], v[8:9] op_sel_hi:[1,0]
  v_pk_add_f32 v[72:73], v[72:73], v[8:9] op_sel_hi:[1,0]
  v_pk_add_f32 v[74:75], v[74:75], v[8:9] op_sel_hi:[1,0]
  v_pk_add_f32 v[76:77], v[76:77], v[8:9] op_sel_hi:[1,0]
  v_pk_add_f32 v[78:79], v[78:79], v[8:9] op_sel_hi:[1,0]
  v_pk_add_f32 v[80:81], v[80:81], v[8:9] op_sel_hi:[1,0]
  v_pk_add_f32 v[82:83], v[82:83], v[8:9] op_sel_hi:[1,0]
  v_pk_add_f32 v[84:85], v[84:85], v[8:9] op_sel_hi:[1,0]
  v_pk_add_f32 v[86:87], v[86:87], v[8:9] op_sel_hi:[1,0]
  v_pk_add_f32 v[88:89], v[88:89], v[8:9] op_sel_hi:[1,0]
  v_pk_add_f32 v[90:91], v[90:91], v[8:9] op_sel_hi:[1,0]
  v_pk_add_f32 v[92:93], v[92:93], v[8:9] op_sel_hi:[1,0]
  v_pk_add_f32 v[94:95], v[94:95], v[8:9] op_sel_hi:[1,0]
  v_pk_add_f32 v[96:97], v[96:97], v[8:9] op_sel_hi:[1,0]
  v_pk_add_f32 v[98:99], v[98:99], v[8:9] op_sel_hi:[1,0]
  v_pk_add_f32 v[100:101], v[100:101], v[8:9] op_sel_hi:[1,0]
  v_pk_add_f32 v[102:103], v[102:103], v[8:9] op_sel_hi:[1,0]
  v_pk_add_f32 v[104:105], v[104:105], v[8:9] op_sel_hi:[1,0]
  v_pk_add_f32 v[106:107], v[106:107], v[8:9] op_sel_hi:[1,0]
  v_pk_add_f32 v[108:109], v[108:109], v[8:9] op_sel_hi:[1,0]
  v_pk_add_f32 v[110:111], v[110:111], v[8:9] op_sel_hi:[1,0]
  v_pk_add_f32 v[112:113], v[112:113], v[8:9] op_sel_hi:[1,0]
  v_pk_add_f32 v[114:115], v[114:115], v[8:9] op_sel_hi:[1,0]
  v_pk_add_f32 v[116:117], v[116:117], v[8:9] op_sel_hi:[1,0]
  v_pk_add_f32 v[118:119], v[118:119], v[8:9] op_sel_hi:[1,0]
  v_pk_add_f32 v[120:121], v[120:121], v[8:9] op_sel_hi:[1,0]
  v_pk_add_f32 v[122:123], v[122:123], v[8:9] op_sel_hi:[1,0]
  v_pk_add_f32 v[124:125], v[124:125], v[8:9] op_sel_hi:[1,0]
  v_pk_add_f32 v[126:127], v[126:127], v[8:9] op_sel_hi:[1,0]
  v_pk_mul_f32 v[8:9], v[56:57], v[56:57]
  v_pk_mul_f32 v[10:11], v[58:59], v[58:59]
  v_pk_fma_f32 v[8:9], v[60:61], v[60:61], v[8:9]
  v_pk_fma_f32 v[10:11], v[62:63], v[62:63], v[10:11]
  v_pk_fma_f32 v[8:9], v[64:65], v[64:65], v[8:9]
  v_pk_fma_f32 v[10:11], v[66:67], v[66:67], v[10:11]
  v_pk_fma_f32 v[8:9], v[68:69], v[68:69], v[8:9]
  v_pk_fma_f32 v[10:11], v[70:71], v[70:71], v[10:11]
  v_pk_fma_f32 v[8:9], v[72:73], v[72:73], v[8:9]
  v_pk_fma_f32 v[10:11], v[74:75], v[74:75], v[10:11]
  v_pk_fma_f32 v[8:9], v[76:77], v[76:77], v[8:9]
  v_pk_fma_f32 v[10:11], v[78:79], v[78:79], v[10:11]
  v_pk_fma_f32 v[8:9], v[80:81], v[80:81], v[8:9]
  v_pk_fma_f32 v[10:11], v[82:83], v[82:83], v[10:11]
  v_pk_fma_f32 v[8:9], v[84:85], v[84:85], v[8:9]
  v_pk_fma_f32 v[10:11], v[86:87], v[86:87], v[10:11]
  v_pk_fma_f32 v[8:9], v[88:89], v[88:89], v[8:9]
  v_pk_fma_f32 v[10:11], v[90:91], v[90:91], v[10:11]
  v_pk_fma_f32 v[8:9], v[92:93], v[92:93], v[8:9]
  v_pk_fma_f32 v[10:11], v[94:95], v[94:95], v[10:11]
  v_pk_fma_f32 v[8:9], v[96:97], v[96:97], v[8:9]
  v_pk_fma_f32 v[10:11], v[98:99], v[98:99], v[10:11]
  v_pk_fma_f32 v[8:9], v[100:101], v[100:101], v[8:9]
  v_pk_fma_f32 v[10:11], v[102:103], v[102:103], v[10:11]
  v_pk_fma_f32 v[8:9], v[104:105], v[104:105], v[8:9]
  v_pk_fma_f32 v[10:11], v[106:107], v[106:107], v[10:11]
  v_pk_fma_f32 v[8:9], v[108:109], v[108:109], v[8:9]
  v_pk_fma_f32 v[10:11], v[110:111], v[110:111], v[10:11]
  v_pk_fma_f32 v[8:9], v[112:113], v[112:113], v[8:9]
  v_pk_fma_f32 v[10:11], v[114:115], v[114:115], v[10:11]
  v_pk_fma_f32 v[8:9], v[116:117], v[116:117], v[8:9]
  v_pk_fma_f32 v[10:11], v[118:119], v[118:119], v[10:11]
  v_pk_fma_f32 v[8:9], v[120:121], v[120:121], v[8:9]
  v_pk_fma_f32 v[10:11], v[122:123], v[122:123], v[10:11]
  v_pk_fma_f32 v[8:9], v[124:125], v[124:125], v[8:9]
  v_pk_fma_f32 v[10:11], v[126:127], v[126:127], v[10:11]
  v_pk_add_f32 v[8:9], v[8:9], v[10:11]
  v_add_f32 v8, v8, v9
  s_nop 1
  v_add_f32_dpp v8, v8, v8 quad_perm:[1,0,3,2] row_mask:0xf bank_mask:0xf
  s_nop 1
  v_add_f32_dpp v8, v8, v8 quad_perm:[2,3,0,1] row_mask:0xf bank_mask:0xf
  s_nop 1
  v_add_f32_dpp v8, v8, v8 row_half_mirror row_mask:0xf bank_mask:0xf
  v_mov_b32 v9, 0x3727c5ac
  v_fmac_f32 v9, 0x3ae38e39, v8
  v_rsq_f32 v8, v9
  s_nop 0
  v_pk_mul_f32 v[56:57], v[56:57], v[8:9] op_sel_hi:[1,0]
  v_cvt_pk_bf16_f32 v128, v56, v57
  v_pk_mul_f32 v[58:59], v[58:59], v[8:9] op_sel_hi:[1,0]
  v_cvt_pk_bf16_f32 v129, v58, v59
  v_pk_mul_f32 v[60:61], v[60:61], v[8:9] op_sel_hi:[1,0]
  v_cvt_pk_bf16_f32 v130, v60, v61
  v_pk_mul_f32 v[62:63], v[62:63], v[8:9] op_sel_hi:[1,0]
  v_cvt_pk_bf16_f32 v131, v62, v63
  v_pk_mul_f32 v[64:65], v[64:65], v[8:9] op_sel_hi:[1,0]
  v_cvt_pk_bf16_f32 v132, v64, v65
  v_pk_mul_f32 v[66:67], v[66:67], v[8:9] op_sel_hi:[1,0]
  v_cvt_pk_bf16_f32 v133, v66, v67
  v_pk_mul_f32 v[68:69], v[68:69], v[8:9] op_sel_hi:[1,0]
  v_cvt_pk_bf16_f32 v134, v68, v69
  v_pk_mul_f32 v[70:71], v[70:71], v[8:9] op_sel_hi:[1,0]
  v_cvt_pk_bf16_f32 v135, v70, v71
  v_pk_mul_f32 v[72:73], v[72:73], v[8:9] op_sel_hi:[1,0]
  v_cvt_pk_bf16_f32 v136, v72, v73
  v_pk_mul_f32 v[74:75], v[74:75], v[8:9] op_sel_hi:[1,0]
  v_cvt_pk_bf16_f32 v137, v74, v75
  v_pk_mul_f32 v[76:77], v[76:77], v[8:9] op_sel_hi:[1,0]
  v_cvt_pk_bf16_f32 v138, v76, v77
  v_pk_mul_f32 v[78:79], v[78:79], v[8:9] op_sel_hi:[1,0]
  v_cvt_pk_bf16_f32 v139, v78, v79
  v_pk_mul_f32 v[80:81], v[80:81], v[8:9] op_sel_hi:[1,0]
  v_cvt_pk_bf16_f32 v140, v80, v81
  v_pk_mul_f32 v[82:83], v[82:83], v[8:9] op_sel_hi:[1,0]
  v_cvt_pk_bf16_f32 v141, v82, v83
  v_pk_mul_f32 v[84:85], v[84:85], v[8:9] op_sel_hi:[1,0]
  v_cvt_pk_bf16_f32 v142, v84, v85
  v_pk_mul_f32 v[86:87], v[86:87], v[8:9] op_sel_hi:[1,0]
  v_cvt_pk_bf16_f32 v143, v86, v87
  v_pk_mul_f32 v[88:89], v[88:89], v[8:9] op_sel_hi:[1,0]
  v_cvt_pk_bf16_f32 v144, v88, v89
  v_pk_mul_f32 v[90:91], v[90:91], v[8:9] op_sel_hi:[1,0]
  v_cvt_pk_bf16_f32 v145, v90, v91
  v_pk_mul_f32 v[92:93], v[92:93], v[8:9] op_sel_hi:[1,0]
  v_cvt_pk_bf16_f32 v146, v92, v93
  v_pk_mul_f32 v[94:95], v[94:95], v[8:9] op_sel_hi:[1,0]
  v_cvt_pk_bf16_f32 v147, v94, v95
  v_pk_mul_f32 v[96:97], v[96:97], v[8:9] op_sel_hi:[1,0]
  v_cvt_pk_bf16_f32 v148, v96, v97
  v_pk_mul_f32 v[98:99], v[98:99], v[8:9] op_sel_hi:[1,0]
  v_cvt_pk_bf16_f32 v149, v98, v99
  v_pk_mul_f32 v[100:101], v[100:101], v[8:9] op_sel_hi:[1,0]
  v_cvt_pk_bf16_f32 v150, v100, v101
  v_pk_mul_f32 v[102:103], v[102:103], v[8:9] op_sel_hi:[1,0]
  v_cvt_pk_bf16_f32 v151, v102, v103
  v_pk_mul_f32 v[104:105], v[104:105], v[8:9] op_sel_hi:[1,0]
  v_cvt_pk_bf16_f32 v152, v104, v105
  v_pk_mul_f32 v[106:107], v[106:107], v[8:9] op_sel_hi:[1,0]
  v_cvt_pk_bf16_f32 v153, v106, v107
  v_pk_mul_f32 v[108:109], v[108:109], v[8:9] op_sel_hi:[1,0]
  v_cvt_pk_bf16_f32 v154, v108, v109
  v_pk_mul_f32 v[110:111], v[110:111], v[8:9] op_sel_hi:[1,0]
  v_cvt_pk_bf16_f32 v155, v110, v111
  v_pk_mul_f32 v[112:113], v[112:113], v[8:9] op_sel_hi:[1,0]
  v_cvt_pk_bf16_f32 v156, v112, v113
  v_pk_mul_f32 v[114:115], v[114:115], v[8:9] op_sel_hi:[1,0]
  v_cvt_pk_bf16_f32 v157, v114, v115
  v_pk_mul_f32 v[116:117], v[116:117], v[8:9] op_sel_hi:[1,0]
  v_cvt_pk_bf16_f32 v158, v116, v117
  v_pk_mul_f32 v[118:119], v[118:119], v[8:9] op_sel_hi:[1,0]
  v_cvt_pk_bf16_f32 v159, v118, v119
  v_pk_mul_f32 v[120:121], v[120:121], v[8:9] op_sel_hi:[1,0]
  v_cvt_pk_bf16_f32 v160, v120, v121
  v_pk_mul_f32 v[122:123], v[122:123], v[8:9] op_sel_hi:[1,0]
  v_cvt_pk_bf16_f32 v161, v122, v123
  v_pk_mul_f32 v[124:125], v[124:125], v[8:9] op_sel_hi:[1,0]
  v_cvt_pk_bf16_f32 v162, v124, v125
  v_pk_mul_f32 v[126:127], v[126:127], v[8:9] op_sel_hi:[1,0]
  v_cvt_pk_bf16_f32 v163, v126, v127
  s_xor_b32 s76, s76, 38016
  v_add_u32 v8, s76, v2
  ds_write_b128 v8, v[128:131] offset:0
  ds_write_b128 v8, v[132:135] offset:4224
  ds_write_b128 v8, v[136:139] offset:8448
  ds_write_b128 v8, v[140:143] offset:12672
  ds_write_b128 v8, v[144:147] offset:16896
  ds_write_b128 v8, v[148:151] offset:21120
  ds_write_b128 v8, v[152:155] offset:25344
  ds_write_b128 v8, v[156:159] offset:29568
  ds_write_b128 v8, v[160:163] offset:33792
  s_waitcnt vmcnt(0) lgkmcnt(0)
  s_barrier
  s_cmp_lg_u32 s51, 0
  s_cbranch_scc1 w0_24
  s_mov_b64 exec, 1
  v_mov_b32 v8, 0
  v_mov_b32 v9, s71
  buffer_store_dword v9, v8, s[4:7], s70 offen sc1
  s_mov_b64 exec, -1
w0_24:
  s_add_u32 s53, s53, s69
  s_cmp_ge_u32 s53, 64
  s_cbranch_scc1 Q_NP
  s_lshl_b32 s77, s52, 6
  s_add_u32 s77, s77, s53
  s_add_u32 s77, s77, 1
  v_cmp_gt_u32 vcc, s77, v12
  s_nop 0
  s_cbranch_vccz qok_25
  s_mov_b32 s61, s53
  s_and_b32 s61, s61, 3
  s_mul_i32 s61, s61, 320
  s_mov_b32 s55, 150000
poll_26:
  buffer_load_dword v8, v4, s[4:7], s61 offen sc1
  s_waitcnt vmcnt(0)
  v_cmp_gt_u32 vcc, s77, v8
  s_nop 0
  s_cbranch_vccz pdone_27
  s_sleep 1
  s_mov_b32 s58, 20
  s_sub_u32 s55, s55, 1
  s_cbranch_scc0 poll_26
  s_branch ABORT
pdone_27:
qok_25:
  s_add_u32 s61, s53, s69
  s_and_b32 s61, s61, 3
  s_mul_i32 s61, s61, 320
  s_mul_i32 s60, s53, 36864
  buffer_load_dwordx4 v[20:23], v1, s[8:11], s60 offen offset:0 sc1
  buffer_load_dwordx4 v[24:27], v1, s[8:11], s60 offen offset:128 sc1
  buffer_load_dwordx4 v[28:31], v1, s[8:11], s60 offen offset:256 sc1
  buffer_load_dwordx4 v[32:35], v1, s[8:11], s60 offen offset:384 sc1
  buffer_load_dwordx4 v[36:39], v1, s[8:11], s60 offen offset:512 sc1
  buffer_load_dwordx4 v[40:43], v1, s[8:11], s60 offen offset:640 sc1
  buffer_load_dwordx4 v[44:47], v1, s[8:11], s60 offen offset:768 sc1
  buffer_load_dwordx4 v[48:51], v1, s[8:11], s60 offen offset:896 sc1
  buffer_load_dwordx4 v[52:55], v1, s[8:11], s60 offen offset:1024 sc1
  buffer_load_dword v12, v4, s[4:7], s61 offen sc1
Q_NP:
  s_cmp_lg_u32 s73, 0
  s_cbranch_scc1 Q_V
  v_add_u32 v8, s76, v3
  ds_read_b128 v[128:131], v8 offset:0
  ds_read_b128 v[132:135], v8 offset:1056
  ds_read_b128 v[136:139], v8 offset:2112
  ds_read_b128 v[140:143], v8 offset:3168
  ds_read_b128 v[144:147], v8 offset:4224
  ds_read_b128 v[148:151], v8 offset:5280
  s_waitcnt lgkmcnt(5)
  v_mfma_f32_32x32x16_bf16 v[164:179], a[0:3], v[128:131], 0
  ds_read_b128 v[128:131], v8 offset:6336
  s_waitcnt lgkmcnt(5)
  v_mfma_f32_32x32x16_bf16 v[164:179], a[4:7], v[132:135], v[164:179]
  ds_read_b128 v[132:135], v8 offset:7392
  s_waitcnt lgkmcnt(5)
  v_mfma_f32_32x32x16_bf16 v[164:179], a[8:11], v[136:139], v[164:179]
  ds_read_b128 v[136:139], v8 offset:8448
  s_waitcnt lgkmcnt(5)
  v_mfma_f32_32x32x16_bf16 v[164:179], a[12:15], v[140:143], v[164:179]
  ds_read_b128 v[140:143], v8 offset:9504
  s_waitcnt lgkmcnt(5)
  v_mfma_f32_32x32x16_bf16 v[164:179], a[16:19], v[144:147], v[164:179]
  ds_read_b128 v[144:147], v8 offset:10560
  s_waitcnt lgkmcnt(5)
  v_mfma_f32_32x32x16_bf16 v[164:179], a[20:23], v[148:151], v[164:179]
  ds_read_b128 v[148:151], v8 offset:11616
  s_waitcnt lgkmcnt(5)
  v_mfma_f32_32x32x16_bf16 v[164:179], a[24:27], v[128:131], v[164:179]
  ds_read_b128 v[128:131], v8 offset:12672
  s_waitcnt lgkmcnt(5)
  v_mfma_f32_32x32x16_bf16 v[164:179], a[28:31], v[132:135], v[164:179]
  ds_read_b128 v[132:135], v8 offset:13728
  s_waitcnt lgkmcnt(5)
  v_mfma_f32_32x32x16_bf16 v[164:179], a[32:35], v[136:139], v[164:179]
  ds_read_b128 v[136:139], v8 offset:14784
  s_waitcnt lgkmcnt(5)
  v_mfma_f32_32x32x16_bf16 v[164:179], a[36:39], v[140:143], v[164:179]
  ds_read_b128 v[140:143], v8 offset:15840
  s_waitcnt lgkmcnt(5)
  v_mfma_f32_32x32x16_bf16 v[164:179], a[40:43], v[144:147], v[164:179]
  ds_read_b128 v[144:147], v8 offset:16896
  s_waitcnt lgkmcnt(5)
  v_mfma_f32_32x32x16_bf16 v[164:179], a[44:47], v[148:151], v[164:179]
  ds_read_b128 v[148:151], v8 offset:17952
  s_waitcnt lgkmcnt(5)
  v_mfma_f32_32x32x16_bf16 v[164:179], a[48:51], v[128:131], v[164:179]
  ds_read_b128 v[128:131], v8 offset:19008
  s_waitcnt lgkmcnt(5)
  v_mfma_f32_32x32x16_bf16 v[164:179], a[52:55], v[132:135], v[164:179]
  ds_read_b128 v[132:135], v8 offset:20064
  s_waitcnt lgkmcnt(5)
  v_mfma_f32_32x32x16_bf16 v[164:179], a[56:59], v[136:139], v[164:179]
  ds_read_b128 v[136:139], v8 offset:21120
  s_waitcnt lgkmcnt(5)
  v_mfma_f32_32x32x16_bf16 v[164:179], a[60:63], v[140:143], v[164:179]
  ds_read_b128 v[140:143], v8 offset:22176
  s_waitcnt lgkmcnt(5)
  v_mfma_f32_32x32x16_bf16 v[164:179], a[64:67], v[144:147], v[164:179]
  ds_read_b128 v[144:147], v8 offset:23232
  s_waitcnt lgkmcnt(5)
  v_mfma_f32_32x32x16_bf16 v[164:179], a[68:71], v[148:151], v[164:179]
  ds_read_b128 v[148:151], v8 offset:24288
  s_waitcnt lgkmcnt(5)
  v_mfma_f32_32x32x16_bf16 v[164:179], a[72:75], v[128:131], v[164:179]
  ds_read_b128 v[128:131], v8 offset:25344
  s_waitcnt lgkmcnt(5)
  v_mfma_f32_32x32x16_bf16 v[164:179], a[76:79], v[132:135], v[164:179]
  ds_read_b128 v[132:135], v8 offset:26400
  s_waitcnt lgkmcnt(5)
  v_mfma_f32_32x32x16_bf16 v[164:179], a[80:83], v[136:139], v[164:179]
  ds_read_b128 v[136:139], v8 offset:27456
  s_waitcnt lgkmcnt(5)
  v_mfma_f32_32x32x16_bf16 v[164:179], a[84:87], v[140:143], v[164:179]
  ds_read_b128 v[140:143], v8 offset:28512
  s_waitcnt lgkmcnt(5)
  v_mfma_f32_32x32x16_bf16 v[164:179], a[88:91], v[144:147], v[164:179]
  ds_read_b128 v[144:147], v8 offset:29568
  s_waitcnt lgkmcnt(5)
  v_mfma_f32_32x32x16_bf16 v[164:179], a[92:95], v[148:151], v[164:179]
  ds_read_b128 v[148:151], v8 offset:30624
  s_waitcnt lgkmcnt(5)
  v_mfma_f32_32x32x16_bf16 v[164:179], a[96:99], v[128:131], v[164:179]
  ds_read_b128 v[128:131], v8 offset:31680
  s_waitcnt lgkmcnt(5)
  v_mfma_f32_32x32x16_bf16 v[164:179], a[100:103], v[132:135], v[164:179]
  ds_read_b128 v[132:135], v8 offset:32736
  s_waitcnt lgkmcnt(5)
  v_mfma_f32_32x32x16_bf16 v[164:179], a[104:107], v[136:139], v[164:179]
  ds_read_b128 v[136:139], v8 offset:33792
  s_waitcnt lgkmcnt(5)
  v_mfma_f32_32x32x16_bf16 v[164:179], a[108:111], v[140:143], v[164:179]
  ds_read_b128 v[140:143], v8 offset:34848
  s_waitcnt lgkmcnt(5)
  v_mfma_f32_32x32x16_bf16 v[164:179], a[112:115], v[144:147], v[164:179]
  ds_read_b128 v[144:147], v8 offset:35904
  s_waitcnt lgkmcnt(5)
  v_mfma_f32_32x32x16_bf16 v[164:179], a[116:119], v[148:151], v[164:179]
  ds_read_b128 v[148:151], v8 offset:36960
  s_waitcnt lgkmcnt(5)
  v_mfma_f32_32x32x16_bf16 v[164:179], a[120:123], v[128:131], v[164:179]
  s_waitcnt lgkmcnt(4)
  v_mfma_f32_32x32x16_bf16 v[164:179], a[124:127], v[132:135], v[164:179]
  s_waitcnt lgkmcnt(3)
  v_mfma_f32_32x32x16_bf16 v[164:179], a[128:131], v[136:139], v[164:179]
  s_waitcnt lgkmcnt(2)
  v_mfma_f32_32x32x16_bf16 v[164:179], a[132:135], v[140:143], v[164:179]
  s_waitcnt lgkmcnt(1)
  v_mfma_f32_32x32x16_bf16 v[164:179], a[136:139], v[144:147], v[164:179]
  s_waitcnt lgkmcnt(0)
  v_mfma_f32_32x32x16_bf16 v[164:179], a[140:143], v[148:151], v[164:179]
  s_nop 11
  v_cvt_pk_bf16_f32 v180, v164, v165
  v_cvt_pk_bf16_f32 v181, v166, v167
  v_cvt_pk_bf16_f32 v182, v168, v169
  v_cvt_pk_bf16_f32 v183, v170, v171
  v_cvt_pk_bf16_f32 v184, v172, v173
  v_cvt_pk_bf16_f32 v185, v174, v175
  v_cvt_pk_bf16_f32 v186, v176, v177
  v_cvt_pk_bf16_f32 v187, v178, v179
  buffer_store_dwordx4 v[180:183], v5, s[4:7], s75 offen offset:0 sc1
  buffer_store_dwordx4 v[184:187], v5, s[4:7], s75 offen offset:1024 sc1
  s_waitcnt vmcnt(2)
  s_branch Q_E
Q_V:
  v_add_u32 v8, s76, v3
  ds_read_b128 v[128:131], v8 offset:0
  ds_read_b128 v[132:135], v8 offset:1056
  ds_read_b128 v[136:139], v8 offset:2112
  ds_read_b128 v[140:143], v8 offset:3168
  ds_read_b128 v[144:147], v8 offset:4224
  ds_read_b128 v[148:151], v8 offset:5280
  s_waitcnt lgkmcnt(5)
  v_mfma_f32_32x32x16_bf16 v[164:179], a[0:3], v[128:131], 0
  v_mfma_f32_32x32x16_bf16 v[188:203], v[128:131], a[144:147], 0
  ds_read_b128 v[128:131], v8 offset:6336
  s_waitcnt lgkmcnt(5)
  v_mfma_f32_32x32x16_bf16 v[164:179], a[4:7], v[132:135], v[164:179]
  v_mfma_f32_32x32x16_bf16 v[188:203], v[132:135], a[148:151], v[188:203]
  ds_read_b128 v[132:135], v8 offset:7392
  s_waitcnt lgkmcnt(5)
  v_mfma_f32_32x32x16_bf16 v[164:179], a[8:11], v[136:139], v[164:179]
  v_mfma_f32_32x32x16_bf16 v[188:203], v[136:139], a[152:155], v[188:203]
  ds_read_b128 v[136:139], v8 offset:8448
  s_waitcnt lgkmcnt(5)
  v_mfma_f32_32x32x16_bf16 v[164:179], a[12:15], v[140:143], v[164:179]
  v_mfma_f32_32x32x16_bf16 v[188:203], v[140:143], a[156:159], v[188:203]
  ds_read_b128 v[140:143], v8 offset:9504
  s_waitcnt lgkmcnt(5)
  v_mfma_f32_32x32x16_bf16 v[164:179], a[16:19], v[144:147], v[164:179]
  v_mfma_f32_32x32x16_bf16 v[188:203], v[144:147], a[160:163], v[188:203]
  ds_read_b128 v[144:147], v8 offset:10560
  s_waitcnt lgkmcnt(5)
  v_mfma_f32_32x32x16_bf16 v[164:179], a[20:23], v[148:151], v[164:179]
  v_mfma_f32_32x32x16_bf16 v[188:203], v[148:151], a[164:167], v[188:203]
  ds_read_b128 v[148:151], v8 offset:11616
  s_waitcnt lgkmcnt(5)
  v_mfma_f32_32x32x16_bf16 v[164:179], a[24:27], v[128:131], v[164:179]
  v_mfma_f32_32x32x16_bf16 v[188:203], v[128:131], a[168:171], v[188:203]
  ds_read_b128 v[128:131], v8 offset:12672
  s_waitcnt lgkmcnt(5)
  v_mfma_f32_32x32x16_bf16 v[164:179], a[28:31], v[132:135], v[164:179]
  v_mfma_f32_32x32x16_bf16 v[188:203], v[132:135], a[172:175], v[188:203]
  ds_read_b128 v[132:135], v8 offset:13728
  s_waitcnt lgkmcnt(5)
  v_mfma_f32_32x32x16_bf16 v[164:179], a[32:35], v[136:139], v[164:179]
  v_mfma_f32_32x32x16_bf16 v[188:203], v[136:139], a[176:179], v[188:203]
  ds_read_b128 v[136:139], v8 offset:14784
  s_waitcnt lgkmcnt(5)
  v_mfma_f32_32x32x16_bf16 v[164:179], a[36:39], v[140:143], v[164:179]
  v_mfma_f32_32x32x16_bf16 v[188:203], v[140:143], a[180:183], v[188:203]
  ds_read_b128 v[140:143], v8 offset:15840
  s_waitcnt lgkmcnt(5)
  v_mfma_f32_32x32x16_bf16 v[164:179], a[40:43], v[144:147], v[164:179]
  v_mfma_f32_32x32x16_bf16 v[188:203], v[144:147], a[184:187], v[188:203]
  ds_read_b128 v[144:147], v8 offset:16896
  s_waitcnt lgkmcnt(5)
  v_mfma_f32_32x32x16_bf16 v[164:179], a[44:47], v[148:151], v[164:179]
  v_mfma_f32_32x32x16_bf16 v[188:203], v[148:151], a[188:191], v[188:203]
  ds_read_b128 v[148:151], v8 offset:17952
  s_waitcnt lgkmcnt(5)
  v_mfma_f32_32x32x16_bf16 v[164:179], a[48:51], v[128:131], v[164:179]
  v_mfma_f32_32x32x16_bf16 v[188:203], v[128:131], a[192:195], v[188:203]
  ds_read_b128 v[128:131], v8 offset:19008
  s_waitcnt lgkmcnt(5)
  v_mfma_f32_32x32x16_bf16 v[164:179], a[52:55], v[132:135], v[164:179]
  v_mfma_f32_32x32x16_bf16 v[188:203], v[132:135], a[196:199], v[188:203]
  ds_read_b128 v[132:135], v8 offset:20064
  s_waitcnt lgkmcnt(5)
  v_mfma_f32_32x32x16_bf16 v[164:179], a[56:59], v[136:139], v[164:179]
  v_mfma_f32_32x32x16_bf16 v[188:203], v[136:139], a[200:203], v[188:203]
  ds_read_b128 v[136:139], v8 offset:21120
  s_waitcnt lgkmcnt(5)
  v_mfma_f32_32x32x16_bf16 v[164:179], a[60:63], v[140:143], v[164:179]
  v_mfma_f32_32x32x16_bf16 v[188:203], v[140:143], a[204:207], v[188:203]
  ds_read_b128 v[140:143], v8 offset:22176
  s_waitcnt lgkmcnt(5)
  v_mfma_f32_32x32x16_bf16 v[164:179], a[64:67], v[144:147], v[164:179]
  v_mfma_f32_32x32x16_bf16 v[188:203], v[144:147], a[208:211], v[188:203]
  ds_read_b128 v[144:147], v8 offset:23232
  s_waitcnt lgkmcnt(5)
  v_mfma_f32_32x32x16_bf16 v[164:179], a[68:71], v[148:151], v[164:179]
  v_mfma_f32_32x32x16_bf16 v[188:203], v[148:151], a[212:215], v[188:203]
  ds_read_b128 v[148:151], v8 offset:24288
  s_waitcnt lgkmcnt(5)
  v_mfma_f32_32x32x16_bf16 v[164:179], a[72:75], v[128:131], v[164:179]
  v_mfma_f32_32x32x16_bf16 v[188:203], v[128:131], a[216:219], v[188:203]
  ds_read_b128 v[128:131], v8 offset:25344
  s_waitcnt lgkmcnt(5)
  v_mfma_f32_32x32x16_bf16 v[164:179], a[76:79], v[132:135], v[164:179]
  v_mfma_f32_32x32x16_bf16 v[188:203], v[132:135], a[220:223], v[188:203]
  ds_read_b128 v[132:135], v8 offset:26400
  s_waitcnt lgkmcnt(5)
  v_mfma_f32_32x32x16_bf16 v[164:179], a[80:83], v[136:139], v[164:179]
  v_mfma_f32_32x32x16_bf16 v[188:203], v[136:139], a[224:227], v[188:203]
  ds_read_b128 v[136:139], v8 offset:27456
  s_waitcnt lgkmcnt(5)
  v_mfma_f32_32x32x16_bf16 v[164:179], a[84:87], v[140:143], v[164:179]
  v_mfma_f32_32x32x16_bf16 v[188:203], v[140:143], a[228:231], v[188:203]
  ds_read_b128 v[140:143], v8 offset:28512
  s_waitcnt lgkmcnt(5)
  v_mfma_f32_32x32x16_bf16 v[164:179], a[88:91], v[144:147], v[164:179]
  v_mfma_f32_32x32x16_bf16 v[188:203], v[144:147], a[232:235], v[188:203]
  ds_read_b128 v[144:147], v8 offset:29568
  s_waitcnt lgkmcnt(5)
  v_mfma_f32_32x32x16_bf16 v[164:179], a[92:95], v[148:151], v[164:179]
  v_mfma_f32_32x32x16_bf16 v[188:203], v[148:151], a[236:239], v[188:203]
  ds_read_b128 v[148:151], v8 offset:30624
  s_waitcnt lgkmcnt(5)
  v_mfma_f32_32x32x16_bf16 v[164:179], a[96:99], v[128:131], v[164:179]
  v_mfma_f32_32x32x16_bf16 v[188:203], v[128:131], a[240:243], v[188:203]
  ds_read_b128 v[128:131], v8 offset:31680
  s_waitcnt lgkmcnt(5)
  v_mfma_f32_32x32x16_bf16 v[164:179], a[100:103], v[132:135], v[164:179]
  v_mfma_f32_32x32x16_bf16 v[188:203], v[132:135], a[244:247], v[188:203]
  ds_read_b128 v[132:135], v8 offset:32736
  s_waitcnt lgkmcnt(5)
  v_mfma_f32_32x32x16_bf16 v[164:179], a[104:107], v[136:139], v[164:179]
  v_mfma_f32_32x32x16_bf16 v[188:203], v[136:139], a[248:251], v[188:203]
  ds_read_b128 v[136:139], v8 offset:33792
  s_waitcnt lgkmcnt(5)
  v_mfma_f32_32x32x16_bf16 v[164:179], a[108:111], v[140:143], v[164:179]
  v_mfma_f32_32x32x16_bf16 v[188:203], v[140:143], a[252:255], v[188:203]
  ds_read_b128 v[140:143], v8 offset:34848
  s_waitcnt lgkmcnt(5)
  v_mfma_f32_32x32x16_bf16 v[164:179], a[112:115], v[144:147], v[164:179]
  v_mfma_f32_32x32x16_bf16 v[188:203], v[144:147], v[224:227], v[188:203]
  ds_read_b128 v[144:147], v8 offset:35904
  s_waitcnt lgkmcnt(5)
  v_mfma_f32_32x32x16_bf16 v[164:179], a[116:119], v[148:151], v[164:179]
  v_mfma_f32_32x32x16_bf16 v[188:203], v[148:151], v[228:231], v[188:203]
  ds_read_b128 v[148:151], v8 offset:36960
  s_waitcnt lgkmcnt(5)
  v_mfma_f32_32x32x16_bf16 v[164:179], a[120:123], v[128:131], v[164:179]
  v_mfma_f32_32x32x16_bf16 v[188:203], v[128:131], v[232:235], v[188:203]
  s_waitcnt lgkmcnt(4)
  v_mfma_f32_32x32x16_bf16 v[164:179], a[124:127], v[132:135], v[164:179]
  v_mfma_f32_32x32x16_bf16 v[188:203], v[132:135], v[236:239], v[188:203]
  s_waitcnt lgkmcnt(3)
  v_mfma_f32_32x32x16_bf16 v[164:179], a[128:131], v[136:139], v[164:179]
  v_mfma_f32_32x32x16_bf16 v[188:203], v[136:139], v[240:243], v[188:203]
  s_waitcnt lgkmcnt(2)
  v_mfma_f32_32x32x16_bf16 v[164:179], a[132:135], v[140:143], v[164:179]
  v_mfma_f32_32x32x16_bf16 v[188:203], v[140:143], v[244:247], v[188:203]
  s_waitcnt lgkmcnt(1)
  v_mfma_f32_32x32x16_bf16 v[164:179], a[136:139], v[144:147], v[164:179]
  v_mfma_f32_32x32x16_bf16 v[188:203], v[144:147], v[248:251], v[188:203]
  s_waitcnt lgkmcnt(0)
  v_mfma_f32_32x32x16_bf16 v[164:179], a[140:143], v[148:151], v[164:179]
  v_mfma_f32_32x32x16_bf16 v[188:203], v[148:151], v[252:255], v[188:203]
  s_add_u32 s60, s75, 16777216
  s_nop 9
  v_cvt_pk_bf16_f32 v180, v164, v165
  v_cvt_pk_bf16_f32 v181, v166, v167
  v_cvt_pk_bf16_f32 v182, v168, v169
  v_cvt_pk_bf16_f32 v183, v170, v171
  v_cvt_pk_bf16_f32 v184, v172, v173
  v_cvt_pk_bf16_f32 v185, v174, v175
  v_cvt_pk_bf16_f32 v186, v176, v177
  v_cvt_pk_bf16_f32 v187, v178, v179
  buffer_store_dwordx4 v[180:183], v5, s[4:7], s75 offen offset:0 sc1
  buffer_store_dwordx4 v[184:187], v5, s[4:7], s75 offen offset:1024 sc1
  v_cvt_pk_bf16_f32 v204, v188, v189
  v_cvt_pk_bf16_f32 v205, v190, v191
  v_cvt_pk_bf16_f32 v206, v192, v193
  v_cvt_pk_bf16_f32 v207, v194, v195
  v_cvt_pk_bf16_f32 v208, v196, v197
  v_cvt_pk_bf16_f32 v209, v198, v199
  v_cvt_pk_bf16_f32 v210, v200, v201
  v_cvt_pk_bf16_f32 v211, v202, v203
  buffer_store_dwordx4 v[204:207], v13, s[4:7], s60 offen offset:0 sc1
  buffer_store_dwordx4 v[208:211], v13, s[4:7], s60 offen offset:1024 sc1
  s_waitcnt vmcnt(4)
Q_E:
  s_lshl_b32 s60, s69, 18
  s_add_u32 s75, s75, s60
  s_add_u32 s71, s71, s69
  s_lshl_b32 s60, s69, 1
  s_cmp_lt_u32 s53, s60
  s_cselect_b32 s60, 64, s53
  s_cmp_lt_u32 s60, 64
  s_cbranch_scc1 Q_LOOP
  s_waitcnt vmcnt(0) lgkmcnt(0)
  s_barrier
  s_cmp_lg_u32 s51, 0
  s_cbranch_scc1 w0_28
  s_mov_b64 exec, 1
  v_mov_b32 v8, 0
  v_mov_b32 v9, s71
  buffer_store_dword v9, v8, s[4:7], s70 offen sc1
  s_mov_b64 exec, -1
w0_28:
  s_cmp_lt_u32 s53, 64
  s_cbranch_scc1 Q_LOOP
  s_add_u32 s52, s52, 1
  s_mov_b32 s54, 104857600
  s_cmp_lt_u32 s52, 2
  s_cbranch_scc1 Q_LAYER
  s_branch W_END
R_OUT:
  s_sub_u32 s72, s68, 96
  s_add_u32 s70, s72, 256
  s_lshl_b32 s70, s70, 6
  s_mul_i32 s73, s72, 57
  s_lshr_b32 s73, s73, 10
  s_mul_i32 s60, s73, 18
  s_sub_u32 s72, s72, s60
  s_lshl_b32 s72, s72, 6
  s_mov_b32 s12, s40
  s_mov_b32 s13, s41
  s_mov_b32 s14, 4718592
  s_mov_b32 s15, 0x00020000
  v_bfe_u32 v8, v0, 4, 1
  v_bfe_u32 v9, v0, 2, 2
  v_and_b32 v10, 3, v0
  v_lshl_add_u32 v11, v6, 2, v9
  v_lshl_add_u32 v11, v8, 3, v11
  v_mul_u32_u24 v11, 1152, v11
  v_lshl_add_u32 v11, v10, 4, v11
  v_lshlrev_b32 v10, 3, v10
  v_lshl_add_u32 v10, v8, 5, v10
  v_lshl_add_u32 v10, v9, 6, v10
  v_lshl_add_u32 v10, v6, 9, v10
  s_lshl_b32 s62, s51, 15
  v_add_u32 v10, s62, v10
  s_mul_i32 s60, s51, 1179648
  s_add_u32 s60, s60, s72
  s_waitcnt lgkmcnt(0)
  s_barrier
  s_mov_b32 s61, s62
  s_mov_b32 m0, s61
  s_add_u32 s61, s61, 1024
  buffer_load_dwordx4 v11, s[12:15], s60 offen  lds
  s_add_u32 s60, s60, 18432
  s_mov_b32 m0, s61
  s_add_u32 s61, s61, 1024
  buffer_load_dwordx4 v11, s[12:15], s60 offen  lds
  s_add_u32 s60, s60, 18432
  s_mov_b32 m0, s61
  s_add_u32 s61, s61, 1024
  buffer_load_dwordx4 v11, s[12:15], s60 offen  lds
  s_add_u32 s60, s60, 18432
  s_mov_b32 m0, s61
  s_add_u32 s61, s61, 1024
  buffer_load_dwordx4 v11, s[12:15], s60 offen  lds
  s_add_u32 s60, s60, 18432
  s_mov_b32 m0, s61
  s_add_u32 s61, s61, 1024
  buffer_load_dwordx4 v11, s[12:15], s60 offen  lds
  s_add_u32 s60, s60, 18432
  s_mov_b32 m0, s61
  s_add_u32 s61, s61, 1024
  buffer_load_dwordx4 v11, s[12:15], s60 offen  lds
  s_add_u32 s60, s60, 18432
  s_mov_b32 m0, s61
  s_add_u32 s61, s61, 1024
  buffer_load_dwordx4 v11, s[12:15], s60 offen  lds
  s_add_u32 s60, s60, 18432
  s_mov_b32 m0, s61
  s_add_u32 s61, s61, 1024
  buffer_load_dwordx4 v11, s[12:15], s60 offen  lds
  s_add_u32 s60, s60, 18432
  s_mov_b32 m0, s61
  s_add_u32 s61, s61, 1024
  buffer_load_dwordx4 v11, s[12:15], s60 offen  lds
  s_add_u32 s60, s60, 18432
  s_mov_b32 m0, s61
  s_add_u32 s61, s61, 1024
  buffer_load_dwordx4 v11, s[12:15], s60 offen  lds
  s_add_u32 s60, s60, 18432
  s_mov_b32 m0, s61
  s_add_u32 s61, s61, 1024
  buffer_load_dwordx4 v11, s[12:15], s60 offen  lds
  s_add_u32 s60, s60, 18432
  s_mov_b32 m0, s61
  s_add_u32 s61, s61, 1024
  buffer_load_dwordx4 v11, s[12:15], s60 offen  lds
  s_add_u32 s60, s60, 18432
  s_mov_b32 m0, s61
  s_add_u32 s61, s61, 1024
  buffer_load_dwordx4 v11, s[12:15], s60 offen  lds
  s_add_u32 s60, s60, 18432
  s_mov_b32 m0, s61
  s_add_u32 s61, s61, 1024
  buffer_load_dwordx4 v11, s[12:15], s60 offen  lds
  s_add_u32 s60, s60, 18432
  s_mov_b32 m0, s61
  s_add_u32 s61, s61, 1024
  buffer_load_dwordx4 v11, s[12:15], s60 offen  lds
  s_add_u32 s60, s60, 18432
  s_mov_b32 m0, s61
  s_add_u32 s61, s61, 1024
  buffer_load_dwordx4 v11, s[12:15], s60 offen  lds
  s_add_u32 s60, s60, 18432
  s_mov_b32 m0, s61
  s_add_u32 s61, s61, 1024
  buffer_load_dwordx4 v11, s[12:15], s60 offen  lds
  s_add_u32 s60, s60, 18432
  s_mov_b32 m0, s61
  s_add_u32 s61, s61, 1024
  buffer_load_dwordx4 v11, s[12:15], s60 offen  lds
  s_add_u32 s60, s60, 18432
  s_mov_b32 m0, s61
  s_add_u32 s61, s61, 1024
  buffer_load_dwordx4 v11, s[12:15], s60 offen  lds
  s_add_u32 s60, s60, 18432
  s_mov_b32 m0, s61
  s_add_u32 s61, s61, 1024
  buffer_load_dwordx4 v11, s[12:15], s60 offen  lds
  s_add_u32 s60, s60, 18432
  s_mov_b32 m0, s61
  s_add_u32 s61, s61, 1024
  buffer_load_dwordx4 v11, s[12:15], s60 offen  lds
  s_add_u32 s60, s60, 18432
  s_mov_b32 m0, s61
  s_add_u32 s61, s61, 1024
  buffer_load_dwordx4 v11, s[12:15], s60 offen  lds
  s_add_u32 s60, s60, 18432
  s_mov_b32 m0, s61
  s_add_u32 s61, s61, 1024
  buffer_load_dwordx4 v11, s[12:15], s60 offen  lds
  s_add_u32 s60, s60, 18432
  s_mov_b32 m0, s61
  s_add_u32 s61, s61, 1024
  buffer_load_dwordx4 v11, s[12:15], s60 offen  lds
  s_add_u32 s60, s60, 18432
  s_mov_b32 m0, s61
  s_add_u32 s61, s61, 1024
  buffer_load_dwordx4 v11, s[12:15], s60 offen  lds
  s_add_u32 s60, s60, 18432
  s_mov_b32 m0, s61
  s_add_u32 s61, s61, 1024
  buffer_load_dwordx4 v11, s[12:15], s60 offen  lds
  s_add_u32 s60, s60, 18432
  s_mov_b32 m0, s61
  s_add_u32 s61, s61, 1024
  buffer_load_dwordx4 v11, s[12:15], s60 offen  lds
  s_add_u32 s60, s60, 18432
  s_mov_b32 m0, s61
  s_add_u32 s61, s61, 1024
  buffer_load_dwordx4 v11, s[12:15], s60 offen  lds
  s_add_u32 s60, s60, 18432
  s_mov_b32 m0, s61
  s_add_u32 s61, s61, 1024
  buffer_load_dwordx4 v11, s[12:15], s60 offen  lds
  s_add_u32 s60, s60, 18432
  s_mov_b32 m0, s61
  s_add_u32 s61, s61, 1024
  buffer_load_dwordx4 v11, s[12:15], s60 offen  lds
  s_add_u32 s60, s60, 18432
  s_mov_b32 m0, s61
  s_add_u32 s61, s61, 1024
  buffer_load_dwordx4 v11, s[12:15], s60 offen  lds
  s_add_u32 s60, s60, 18432
  s_mov_b32 m0, s61
  s_add_u32 s61, s61, 1024
  buffer_load_dwordx4 v11, s[12:15], s60 offen  lds
  s_add_u32 s60, s60, 18432
  s_waitcnt vmcnt(0)
  ds_read_b64_tr_b16 a[0:1], v10 offset:0
  ds_read_b64_tr_b16 a[2:3], v10 offset:256
  ds_read_b64_tr_b16 a[4:5], v10 offset:1024
  ds_read_b64_tr_b16 a[6:7], v10 offset:1280
  ds_read_b64_tr_b16 a[8:9], v10 offset:2048
  ds_read_b64_tr_b16 a[10:11], v10 offset:2304
  ds_read_b64_tr_b16 a[12:13], v10 offset:3072
  ds_read_b64_tr_b16 a[14:15], v10 offset:3328
  ds_read_b64_tr_b16 a[16:17], v10 offset:4096
  ds_read_b64_tr_b16 a[18:19], v10 offset:4352
  ds_read_b64_tr_b16 a[20:21], v10 offset:5120
  ds_read_b64_tr_b16 a[22:23], v10 offset:5376
  ds_read_b64_tr_b16 a[24:25], v10 offset:6144
  ds_read_b64_tr_b16 a[26:27], v10 offset:6400
  ds_read_b64_tr_b16 a[28:29], v10 offset:7168
  ds_read_b64_tr_b16 a[30:31], v10 offset:7424
  ds_read_b64_tr_b16 a[32:33], v10 offset:8192
  ds_read_b64_tr_b16 a[34:35], v10 offset:8448
  ds_read_b64_tr_b16 a[36:37], v10 offset:9216
  ds_read_b64_tr_b16 a[38:39], v10 offset:9472
  ds_read_b64_tr_b16 a[40:41], v10 offset:10240
  ds_read_b64_tr_b16 a[42:43], v10 offset:10496
  ds_read_b64_tr_b16 a[44:45], v10 offset:11264
  ds_read_b64_tr_b16 a[46:47], v10 offset:11520
  ds_read_b64_tr_b16 a[48:49], v10 offset:12288
  ds_read_b64_tr_b16 a[50:51], v10 offset:12544
  ds_read_b64_tr_b16 a[52:53], v10 offset:13312
  ds_read_b64_tr_b16 a[54:55], v10 offset:13568
  ds_read_b64_tr_b16 a[56:57], v10 offset:14336
  ds_read_b64_tr_b16 a[58:59], v10 offset:14592
  ds_read_b64_tr_b16 a[60:61], v10 offset:15360
  ds_read_b64_tr_b16 a[62:63], v10 offset:15616
  ds_read_b64_tr_b16 a[64:65], v10 offset:16384
  ds_read_b64_tr_b16 a[66:67], v10 offset:16640
  ds_read_b64_tr_b16 a[68:69], v10 offset:17408
  ds_read_b64_tr_b16 a[70:71], v10 offset:17664
  ds_read_b64_tr_b16 a[72:73], v10 offset:18432
  ds_read_b64_tr_b16 a[74:75], v10 offset:18688
  ds_read_b64_tr_b16 a[76:77], v10 offset:19456
  ds_read_b64_tr_b16 a[78:79], v10 offset:19712
  ds_read_b64_tr_b16 a[80:81], v10 offset:20480
  ds_read_b64_tr_b16 a[82:83], v10 offset:20736
  ds_read_b64_tr_b16 a[84:85], v10 offset:21504
  ds_read_b64_tr_b16 a[86:87], v10 offset:21760
  ds_read_b64_tr_b16 a[88:89], v10 offset:22528
  ds_read_b64_tr_b16 a[90:91], v10 offset:22784
  ds_read_b64_tr_b16 a[92:93], v10 offset:23552
  ds_read_b64_tr_b16 a[94:95], v10 offset:23808
  ds_read_b64_tr_b16 a[96:97], v10 offset:24576
  ds_read_b64_tr_b16 a[98:99], v10 offset:24832
  ds_read_b64_tr_b16 a[100:101], v10 offset:25600
  ds_read_b64_tr_b16 a[102:103], v10 offset:25856
  ds_read_b64_tr_b16 a[104:105], v10 offset:26624
  ds_read_b64_tr_b16 a[106:107], v10 offset:26880
  ds_read_b64_tr_b16 a[108:109], v10 offset:27648
  ds_read_b64_tr_b16 a[110:111], v10 offset:27904
  ds_read_b64_tr_b16 a[112:113], v10 offset:28672
  ds_read_b64_tr_b16 a[114:115], v10 offset:28928
  ds_read_b64_tr_b16 a[116:117], v10 offset:29696
  ds_read_b64_tr_b16 a[118:119], v10 offset:29952
  ds_read_b64_tr_b16 a[120:121], v10 offset:30720
  ds_read_b64_tr_b16 a[122:123], v10 offset:30976
  ds_read_b64_tr_b16 a[124:125], v10 offset:31744
  ds_read_b64_tr_b16 a[126:127], v10 offset:32000
  s_waitcnt lgkmcnt(0)
  s_mov_b32 s61, s62
  s_mov_b32 m0, s61
  s_add_u32 s61, s61, 1024
  buffer_load_dwordx4 v11, s[12:15], s60 offen  lds
  s_add_u32 s60, s60, 18432
  s_mov_b32 m0, s61
  s_add_u32 s61, s61, 1024
  buffer_load_dwordx4 v11, s[12:15], s60 offen  lds
  s_add_u32 s60, s60, 18432
  s_mov_b32 m0, s61
  s_add_u32 s61, s61, 1024
  buffer_load_dwordx4 v11, s[12:15], s60 offen  lds
  s_add_u32 s60, s60, 18432
  s_mov_b32 m0, s61
  s_add_u32 s61, s61, 1024
  buffer_load_dwordx4 v11, s[12:15], s60 offen  lds
  s_add_u32 s60, s60, 18432
  s_mov_b32 m0, s61
  s_add_u32 s61, s61, 1024
  buffer_load_dwordx4 v11, s[12:15], s60 offen  lds
  s_add_u32 s60, s60, 18432
  s_mov_b32 m0, s61
  s_add_u32 s61, s61, 1024
  buffer_load_dwordx4 v11, s[12:15], s60 offen  lds
  s_add_u32 s60, s60, 18432
  s_mov_b32 m0, s61
  s_add_u32 s61, s61, 1024
  buffer_load_dwordx4 v11, s[12:15], s60 offen  lds
  s_add_u32 s60, s60, 18432
  s_mov_b32 m0, s61
  s_add_u32 s61, s61, 1024
  buffer_load_dwordx4 v11, s[12:15], s60 offen  lds
  s_add_u32 s60, s60, 18432
  s_mov_b32 m0, s61
  s_add_u32 s61, s61, 1024
  buffer_load_dwordx4 v11, s[12:15], s60 offen  lds
  s_add_u32 s60, s60, 18432
  s_mov_b32 m0, s61
  s_add_u32 s61, s61, 1024
  buffer_load_dwordx4 v11, s[12:15], s60 offen  lds
  s_add_u32 s60, s60, 18432
  s_mov_b32 m0, s61
  s_add_u32 s61, s61, 1024
  buffer_load_dwordx4 v11, s[12:15], s60 offen  lds
  s_add_u32 s60, s60, 18432
  s_mov_b32 m0, s61
  s_add_u32 s61, s61, 1024
  buffer_load_dwordx4 v11, s[12:15], s60 offen  lds
  s_add_u32 s60, s60, 18432
  s_mov_b32 m0, s61
  s_add_u32 s61, s61, 1024
  buffer_load_dwordx4 v11, s[12:15], s60 offen  lds
  s_add_u32 s60, s60, 18432
  s_mov_b32 m0, s61
  s_add_u32 s61, s61, 1024
  buffer_load_dwordx4 v11, s[12:15], s60 offen  lds
  s_add_u32 s60, s60, 18432
  s_mov_b32 m0, s61
  s_add_u32 s61, s61, 1024
  buffer_load_dwordx4 v11, s[12:15], s60 offen  lds
  s_add_u32 s60, s60, 18432
  s_mov_b32 m0, s61
  s_add_u32 s61, s61, 1024
  buffer_load_dwordx4 v11, s[12:15], s60 offen  lds
  s_add_u32 s60, s60, 18432
  s_mov_b32 m0, s61
  s_add_u32 s61, s61, 1024
  buffer_load_dwordx4 v11, s[12:15], s60 offen  lds
  s_add_u32 s60, s60, 18432
  s_mov_b32 m0, s61
  s_add_u32 s61, s61, 1024
  buffer_load_dwordx4 v11, s[12:15], s60 offen  lds
  s_add_u32 s60, s60, 18432
  s_mov_b32 m0, s61
  s_add_u32 s61, s61, 1024
  buffer_load_dwordx4 v11, s[12:15], s60 offen  lds
  s_add_u32 s60, s60, 18432
  s_mov_b32 m0, s61
  s_add_u32 s61, s61, 1024
  buffer_load_dwordx4 v11, s[12:15], s60 offen  lds
  s_add_u32 s60, s60, 18432
  s_mov_b32 m0, s61
  s_add_u32 s61, s61, 1024
  buffer_load_dwordx4 v11, s[12:15], s60 offen  lds
  s_add_u32 s60, s60, 18432
  s_mov_b32 m0, s61
  s_add_u32 s61, s61, 1024
  buffer_load_dwordx4 v11, s[12:15], s60 offen  lds
  s_add_u32 s60, s60, 18432
  s_mov_b32 m0, s61
  s_add_u32 s61, s61, 1024
  buffer_load_dwordx4 v11, s[12:15], s60 offen  lds
  s_add_u32 s60, s60, 18432
  s_mov_b32 m0, s61
  s_add_u32 s61, s61, 1024
  buffer_load_dwordx4 v11, s[12:15], s60 offen  lds
  s_add_u32 s60, s60, 18432
  s_mov_b32 m0, s61
  s_add_u32 s61, s61, 1024
  buffer_load_dwordx4 v11, s[12:15], s60 offen  lds
  s_add_u32 s60, s60, 18432
  s_mov_b32 m0, s61
  s_add_u32 s61, s61, 1024
  buffer_load_dwordx4 v11, s[12:15], s60 offen  lds
  s_add_u32 s60, s60, 18432
  s_mov_b32 m0, s61
  s_add_u32 s61, s61, 1024
  buffer_load_dwordx4 v11, s[12:15], s60 offen  lds
  s_add_u32 s60, s60, 18432
  s_mov_b32 m0, s61
  s_add_u32 s61, s61, 1024
  buffer_load_dwordx4 v11, s[12:15], s60 offen  lds
  s_add_u32 s60, s60, 18432
  s_mov_b32 m0, s61
  s_add_u32 s61, s61, 1024
  buffer_load_dwordx4 v11, s[12:15], s60 offen  lds
  s_add_u32 s60, s60, 18432
  s_mov_b32 m0, s61
  s_add_u32 s61, s61, 1024
  buffer_load_dwordx4 v11, s[12:15], s60 offen  lds
  s_add_u32 s60, s60, 18432
  s_mov_b32 m0, s61
  s_add_u32 s61, s61, 1024
  buffer_load_dwordx4 v11, s[12:15], s60 offen  lds
  s_add_u32 s60, s60, 18432
  s_mov_b32 m0, s61
  s_add_u32 s61, s61, 1024
  buffer_load_dwordx4 v11, s[12:15], s60 offen  lds
  s_add_u32 s60, s60, 18432
  s_waitcnt vmcnt(0)
  ds_read_b64_tr_b16 a[128:129], v10 offset:0
  ds_read_b64_tr_b16 a[130:131], v10 offset:256
  ds_read_b64_tr_b16 a[132:133], v10 offset:1024
  ds_read_b64_tr_b16 a[134:135], v10 offset:1280
  ds_read_b64_tr_b16 a[136:137], v10 offset:2048
  ds_read_b64_tr_b16 a[138:139], v10 offset:2304
  ds_read_b64_tr_b16 a[140:141], v10 offset:3072
  ds_read_b64_tr_b16 a[142:143], v10 offset:3328
  ds_read_b64_tr_b16 a[144:145], v10 offset:4096
  ds_read_b64_tr_b16 a[146:147], v10 offset:4352
  ds_read_b64_tr_b16 a[148:149], v10 offset:5120
  ds_read_b64_tr_b16 a[150:151], v10 offset:5376
  ds_read_b64_tr_b16 a[152:153], v10 offset:6144
  ds_read_b64_tr_b16 a[154:155], v10 offset:6400
  ds_read_b64_tr_b16 a[156:157], v10 offset:7168
  ds_read_b64_tr_b16 a[158:159], v10 offset:7424
  ds_read_b64_tr_b16 a[160:161], v10 offset:8192
  ds_read_b64_tr_b16 a[162:163], v10 offset:8448
  ds_read_b64_tr_b16 a[164:165], v10 offset:9216
  ds_read_b64_tr_b16 a[166:167], v10 offset:9472
  ds_read_b64_tr_b16 a[168:169], v10 offset:10240
  ds_read_b64_tr_b16 a[170:171], v10 offset:10496
  ds_read_b64_tr_b16 a[172:173], v10 offset:11264
  ds_read_b64_tr_b16 a[174:175], v10 offset:11520
  ds_read_b64_tr_b16 a[176:177], v10 offset:12288
  ds_read_b64_tr_b16 a[178:179], v10 offset:12544
  ds_read_b64_tr_b16 a[180:181], v10 offset:13312
  ds_read_b64_tr_b16 a[182:183], v10 offset:13568
  ds_read_b64_tr_b16 a[184:185], v10 offset:14336
  ds_read_b64_tr_b16 a[186:187], v10 offset:14592
  ds_read_b64_tr_b16 a[188:189], v10 offset:15360
  ds_read_b64_tr_b16 a[190:191], v10 offset:15616
  ds_read_b64_tr_b16 a[192:193], v10 offset:16384
  ds_read_b64_tr_b16 a[194:195], v10 offset:16640
  ds_read_b64_tr_b16 a[196:197], v10 offset:17408
  ds_read_b64_tr_b16 a[198:199], v10 offset:17664
  ds_read_b64_tr_b16 a[200:201], v10 offset:18432
  ds_read_b64_tr_b16 a[202:203], v10 offset:18688
  ds_read_b64_tr_b16 a[204:205], v10 offset:19456
  ds_read_b64_tr_b16 a[206:207], v10 offset:19712
  ds_read_b64_tr_b16 a[208:209], v10 offset:20480
  ds_read_b64_tr_b16 a[210:211], v10 offset:20736
  ds_read_b64_tr_b16 a[212:213], v10 offset:21504
  ds_read_b64_tr_b16 a[214:215], v10 offset:21760
  ds_read_b64_tr_b16 a[216:217], v10 offset:22528
  ds_read_b64_tr_b16 a[218:219], v10 offset:22784
  ds_read_b64_tr_b16 a[220:221], v10 offset:23552
  ds_read_b64_tr_b16 a[222:223], v10 offset:23808
  ds_read_b64_tr_b16 a[224:225], v10 offset:24576
  ds_read_b64_tr_b16 a[226:227], v10 offset:24832
  ds_read_b64_tr_b16 a[228:229], v10 offset:25600
  ds_read_b64_tr_b16 a[230:231], v10 offset:25856
  ds_read_b64_tr_b16 a[232:233], v10 offset:26624
  ds_read_b64_tr_b16 a[234:235], v10 offset:26880
  ds_read_b64_tr_b16 a[236:237], v10 offset:27648
  ds_read_b64_tr_b16 a[238:239], v10 offset:27904
  ds_read_b64_tr_b16 a[240:241], v10 offset:28672
  ds_read_b64_tr_b16 a[242:243], v10 offset:28928
  ds_read_b64_tr_b16 a[244:245], v10 offset:29696
  ds_read_b64_tr_b16 a[246:247], v10 offset:29952
  ds_read_b64_tr_b16 a[248:249], v10 offset:30720
  ds_read_b64_tr_b16 a[250:251], v10 offset:30976
  ds_read_b64_tr_b16 a[252:253], v10 offset:31744
  ds_read_b64_tr_b16 a[254:255], v10 offset:32000
  s_waitcnt lgkmcnt(0)
  v_mul_u32_u24 v12, 1152, v7
  v_lshl_add_u32 v12, v6, 3, v12
  s_lshl_b32 s60, s51, 4
  s_add_u32 s60, s60, s72
  v_add_u32 v12, s60, v12
  v_and_b32 v4, 7, v0
  s_lshl_b32 s60, s51, 3
  v_add_u32 v4, s60, v4
  v_lshlrev_b32 v4, 6, v4
  s_lshl_b32 s60, s51, 12
  v_add_u32 v13, s60, v5
  s_lshl_b32 s60, s51, 10
  v_add_u32 v14, s60, v5
  s_waitcnt lgkmcnt(0)
  s_barrier
  s_add_u32 s16, s48, 1048576
  s_addc_u32 s17, s49, 0
  s_mov_b32 s18, 2359296
  s_mov_b32 s19, 0x00020000
O_LAYER:
  s_mov_b32 s53, s73
  s_add_u32 s60, s54, 3145728
  s_add_u32 s8, s48, s60
  s_addc_u32 s9, s49, 0
O_LOOP:
  s_mul_i32 s61, s53, 43
  s_lshr_b32 s61, s61, 7
  s_mul_i32 s61, s61, 3
  s_sub_u32 s61, s53, s61
  s_mul_i32 s61, s61, 2048
  s_add_u32 s61, s61, 10240
  s_lshl_b32 s77, s52, 6
  s_add_u32 s77, s77, s53
  s_add_u32 s77, s77, 1
  s_mov_b32 s55, 150000
poll_29:
  buffer_load_dword v8, v4, s[4:7], s61 offen sc1
  s_waitcnt vmcnt(0)
  v_cmp_gt_u32 vcc, s77, v8
  s_nop 0
  s_cbranch_vccz pdone_30
  s_sleep 1
  s_mov_b32 s58, 30
  s_sub_u32 s55, s55, 1
  s_cbranch_scc0 poll_29
  s_branch ABORT
pdone_30:
  s_lshl_b32 s74, s53, 18
  s_lshl_b32 s60, s51, 16
  s_add_u32 s74, s74, s60
  s_add_u32 s74, s74, s54
  s_add_u32 s74, s74, 56623104
  s_mul_i32 s75, s53, 36864
  buffer_load_dwordx4 v[40:43], v5, s[4:7], s74 offen offset:0 sc1
  buffer_load_dwordx4 v[44:47], v5, s[4:7], s74 offen offset:1024 sc1
  buffer_load_dwordx4 v[48:51], v5, s[4:7], s74 offen offset:2048 sc1
  buffer_load_dwordx4 v[52:55], v5, s[4:7], s74 offen offset:3072 sc1
  s_add_u32 s74, s74, 4096
  buffer_load_dwordx4 v[56:59], v5, s[4:7], s74 offen offset:0 sc1
  buffer_load_dwordx4 v[60:63], v5, s[4:7], s74 offen offset:1024 sc1
  buffer_load_dwordx4 v[64:67], v5, s[4:7], s74 offen offset:2048 sc1
  buffer_load_dwordx4 v[68:71], v5, s[4:7], s74 offen offset:3072 sc1
  s_add_u32 s74, s74, 4096
  buffer_load_dwordx4 v[72:75], v5, s[4:7], s74 offen offset:0 sc1
  buffer_load_dwordx4 v[76:79], v5, s[4:7], s74 offen offset:1024 sc1
  buffer_load_dwordx4 v[80:83], v5, s[4:7], s74 offen offset:2048 sc1
  buffer_load_dwordx4 v[84:87], v5, s[4:7], s74 offen offset:3072 sc1
  s_add_u32 s74, s74, 4096
  buffer_load_dwordx4 v[88:91], v5, s[4:7], s74 offen offset:0 sc1
  buffer_load_dwordx4 v[92:95], v5, s[4:7], s74 offen offset:1024 sc1
  buffer_load_dwordx4 v[96:99], v5, s[4:7], s74 offen offset:2048 sc1
  buffer_load_dwordx4 v[100:103], v5, s[4:7], s74 offen offset:3072 sc1
  s_add_u32 s74, s74, 4096
  buffer_load_dwordx4 v[104:107], v5, s[4:7], s74 offen offset:0 sc1
  buffer_load_dwordx4 v[108:111], v5, s[4:7], s74 offen offset:1024 sc1
  buffer_load_dwordx4 v[112:115], v5, s[4:7], s74 offen offset:2048 sc1
  buffer_load_dwordx4 v[116:119], v5, s[4:7], s74 offen offset:3072 sc1
  s_add_u32 s74, s74, 4096
  buffer_load_dwordx4 v[120:123], v5, s[4:7], s74 offen offset:0 sc1
  buffer_load_dwordx4 v[124:127], v5, s[4:7], s74 offen offset:1024 sc1
  buffer_load_dwordx4 v[128:131], v5, s[4:7], s74 offen offset:2048 sc1
  buffer_load_dwordx4 v[132:135], v5, s[4:7], s74 offen offset:3072 sc1
  s_add_u32 s74, s74, 4096
  buffer_load_dwordx4 v[136:139], v5, s[4:7], s74 offen offset:0 sc1
  buffer_load_dwordx4 v[140:143], v5, s[4:7], s74 offen offset:1024 sc1
  buffer_load_dwordx4 v[144:147], v5, s[4:7], s74 offen offset:2048 sc1
  buffer_load_dwordx4 v[148:151], v5, s[4:7], s74 offen offset:3072 sc1
  s_add_u32 s74, s74, 4096
  buffer_load_dwordx4 v[152:155], v5, s[4:7], s74 offen offset:0 sc1
  buffer_load_dwordx4 v[156:159], v5, s[4:7], s74 offen offset:1024 sc1
  buffer_load_dwordx4 v[160:163], v5, s[4:7], s74 offen offset:2048 sc1
  buffer_load_dwordx4 v[164:167], v5, s[4:7], s74 offen offset:3072 sc1
  s_add_u32 s74, s74, 4096
  buffer_load_dwordx4 v[168:171], v5, s[4:7], s74 offen offset:0 sc1
  buffer_load_dwordx4 v[172:175], v5, s[4:7], s74 offen offset:1024 sc1
  buffer_load_dwordx4 v[176:179], v5, s[4:7], s74 offen offset:2048 sc1
  buffer_load_dwordx4 v[180:183], v5, s[4:7], s74 offen offset:3072 sc1
  s_add_u32 s74, s74, 4096
  buffer_load_dwordx4 v[184:187], v5, s[4:7], s74 offen offset:0 sc1
  buffer_load_dwordx4 v[188:191], v5, s[4:7], s74 offen offset:1024 sc1
  buffer_load_dwordx4 v[192:195], v5, s[4:7], s74 offen offset:2048 sc1
  buffer_load_dwordx4 v[196:199], v5, s[4:7], s74 offen offset:3072 sc1
  s_add_u32 s74, s74, 4096
  buffer_load_dwordx4 v[200:203], v5, s[4:7], s74 offen offset:0 sc1
  buffer_load_dwordx4 v[204:207], v5, s[4:7], s74 offen offset:1024 sc1
  buffer_load_dwordx4 v[208:211], v5, s[4:7], s74 offen offset:2048 sc1
  buffer_load_dwordx4 v[212:215], v5, s[4:7], s74 offen offset:3072 sc1
  s_add_u32 s74, s74, 4096
  buffer_load_dwordx4 v[216:219], v5, s[4:7], s74 offen offset:0 sc1
  buffer_load_dwordx4 v[220:223], v5, s[4:7], s74 offen offset:1024 sc1
  buffer_load_dwordx4 v[224:227], v5, s[4:7], s74 offen offset:2048 sc1
  buffer_load_dwordx4 v[228:231], v5, s[4:7], s74 offen offset:3072 sc1
  s_add_u32 s74, s74, 4096
  buffer_load_dwordx4 v[232:235], v5, s[4:7], s74 offen offset:0 sc1
  buffer_load_dwordx4 v[236:239], v5, s[4:7], s74 offen offset:1024 sc1
  buffer_load_dwordx4 v[240:243], v5, s[4:7], s74 offen offset:2048 sc1
  buffer_load_dwordx4 v[244:247], v5, s[4:7], s74 offen offset:3072 sc1
  s_add_u32 s74, s74, 4096
  s_waitcnt vmcnt(51)
  v_mfma_f32_32x32x16_bf16 v[20:35], a[0:3], v[40:43], 0
  buffer_load_dwordx4 v[40:43], v5, s[4:7], s74 offen offset:0 sc1
  s_waitcnt vmcnt(51)
  v_mfma_f32_32x32x16_bf16 v[20:35], a[4:7], v[44:47], v[20:35]
  buffer_load_dwordx4 v[44:47], v5, s[4:7], s74 offen offset:1024 sc1
  s_waitcnt vmcnt(51)
  v_mfma_f32_32x32x16_bf16 v[20:35], a[8:11], v[48:51], v[20:35]
  buffer_load_dwordx4 v[48:51], v5, s[4:7], s74 offen offset:2048 sc1
  s_waitcnt vmcnt(51)
  v_mfma_f32_32x32x16_bf16 v[20:35], a[12:15], v[52:55], v[20:35]
  buffer_load_dwordx4 v[52:55], v5, s[4:7], s74 offen offset:3072 sc1
  s_add_u32 s74, s74, 4096
  s_waitcnt vmcnt(51)
  v_mfma_f32_32x32x16_bf16 v[20:35], a[16:19], v[56:59], v[20:35]
  buffer_load_dwordx4 v[56:59], v5, s[4:7], s74 offen offset:0 sc1
  s_waitcnt vmcnt(51)
  v_mfma_f32_32x32x16_bf16 v[20:35], a[20:23], v[60:63], v[20:35]
  buffer_load_dwordx4 v[60:63], v5, s[4:7], s74 offen offset:1024 sc1
  s_waitcnt vmcnt(51)
  v_mfma_f32_32x32x16_bf16 v[20:35], a[24:27], v[64:67], v[20:35]
  buffer_load_dwordx4 v[64:67], v5, s[4:7], s74 offen offset:2048 sc1
  s_waitcnt vmcnt(51)
  v_mfma_f32_32x32x16_bf16 v[20:35], a[28:31], v[68:71], v[20:35]
  buffer_load_dwordx4 v[68:71], v5, s[4:7], s74 offen offset:3072 sc1
  s_add_u32 s74, s74, 4096
  s_waitcnt vmcnt(51)
  v_mfma_f32_32x32x16_bf16 v[20:35], a[32:35], v[72:75], v[20:35]
  buffer_load_dwordx4 v[72:75], v5, s[4:7], s74 offen offset:0 sc1
  s_waitcnt vmcnt(51)
  v_mfma_f32_32x32x16_bf16 v[20:35], a[36:39], v[76:79], v[20:35]
  buffer_load_dwordx4 v[76:79], v5, s[4:7], s74 offen offset:1024 sc1
  s_waitcnt vmcnt(51)
  v_mfma_f32_32x32x16_bf16 v[20:35], a[40:43], v[80:83], v[20:35]
  buffer_load_dwordx4 v[80:83], v5, s[4:7], s74 offen offset:2048 sc1
  s_waitcnt vmcnt(51)
  v_mfma_f32_32x32x16_bf16 v[20:35], a[44:47], v[84:87], v[20:35]
  buffer_load_dwordx4 v[84:87], v5, s[4:7], s74 offen offset:3072 sc1
  s_add_u32 s74, s74, 4096
  s_waitcnt vmcnt(51)
  v_mfma_f32_32x32x16_bf16 v[20:35], a[48:51], v[88:91], v[20:35]
  buffer_load_dwordx2 v[36:37], v12, s[8:11], s75 offen sc1
  s_waitcnt vmcnt(51)
  v_mfma_f32_32x32x16_bf16 v[20:35], a[52:55], v[92:95], v[20:35]
  s_waitcnt vmcnt(50)
  v_mfma_f32_32x32x16_bf16 v[20:35], a[56:59], v[96:99], v[20:35]
  s_waitcnt vmcnt(49)
  v_mfma_f32_32x32x16_bf16 v[20:35], a[60:63], v[100:103], v[20:35]
  s_waitcnt vmcnt(48)
  v_mfma_f32_32x32x16_bf16 v[20:35], a[64:67], v[104:107], v[20:35]
  s_waitcnt vmcnt(47)
  v_mfma_f32_32x32x16_bf16 v[20:35], a[68:71], v[108:111], v[20:35]
  s_waitcnt vmcnt(46)
  v_mfma_f32_32x32x16_bf16 v[20:35], a[72:75], v[112:115], v[20:35]
  s_waitcnt vmcnt(45)
  v_mfma_f32_32x32x16_bf16 v[20:35], a[76:79], v[116:119], v[20:35]
  s_waitcnt vmcnt(44)
  v_mfma_f32_32x32x16_bf16 v[20:35], a[80:83], v[120:123], v[20:35]
  s_waitcnt vmcnt(43)
  v_mfma_f32_32x32x16_bf16 v[20:35], a[84:87], v[124:127], v[20:35]
  s_waitcnt vmcnt(42)
  v_mfma_f32_32x32x16_bf16 v[20:35], a[88:91], v[128:131], v[20:35]
  s_waitcnt vmcnt(41)
  v_mfma_f32_32x32x16_bf16 v[20:35], a[92:95], v[132:135], v[20:35]
  s_waitcnt vmcnt(40)
  v_mfma_f32_32x32x16_bf16 v[20:35], a[96:99], v[136:139], v[20:35]
  s_waitcnt vmcnt(39)
  v_mfma_f32_32x32x16_bf16 v[20:35], a[100:103], v[140:143], v[20:35]
  s_waitcnt vmcnt(38)
  v_mfma_f32_32x32x16_bf16 v[20:35], a[104:107], v[144:147], v[20:35]
  s_waitcnt vmcnt(37)
  v_mfma_f32_32x32x16_bf16 v[20:35], a[108:111], v[148:151], v[20:35]
  s_waitcnt vmcnt(36)
  v_mfma_f32_32x32x16_bf16 v[20:35], a[112:115], v[152:155], v[20:35]
  s_waitcnt vmcnt(35)
  v_mfma_f32_32x32x16_bf16 v[20:35], a[116:119], v[156:159], v[20:35]
  s_waitcnt vmcnt(34)
  v_mfma_f32_32x32x16_bf16 v[20:35], a[120:123], v[160:163], v[20:35]
  s_waitcnt vmcnt(33)
  v_mfma_f32_32x32x16_bf16 v[20:35], a[124:127], v[164:167], v[20:35]
  s_waitcnt vmcnt(32)
  v_mfma_f32_32x32x16_bf16 v[20:35], a[128:131], v[168:171], v[20:35]
  s_waitcnt vmcnt(31)
  v_mfma_f32_32x32x16_bf16 v[20:35], a[132:135], v[172:175], v[20:35]
  s_waitcnt vmcnt(30)
  v_mfma_f32_32x32x16_bf16 v[20:35], a[136:139], v[176:179], v[20:35]
  s_waitcnt vmcnt(29)
  v_mfma_f32_32x32x16_bf16 v[20:35], a[140:143], v[180:183], v[20:35]
  s_waitcnt vmcnt(28)
  v_mfma_f32_32x32x16_bf16 v[20:35], a[144:147], v[184:187], v[20:35]
  s_waitcnt vmcnt(27)
  v_mfma_f32_32x32x16_bf16 v[20:35], a[148:151], v[188:191], v[20:35]
  s_waitcnt vmcnt(26)
  v_mfma_f32_32x32x16_bf16 v[20:35], a[152:155], v[192:195], v[20:35]
  s_waitcnt vmcnt(25)
  v_mfma_f32_32x32x16_bf16 v[20:35], a[156:159], v[196:199], v[20:35]
  s_waitcnt vmcnt(24)
  v_mfma_f32_32x32x16_bf16 v[20:35], a[160:163], v[200:203], v[20:35]
  s_waitcnt vmcnt(23)
  v_mfma_f32_32x32x16_bf16 v[20:35], a[164:167], v[204:207], v[20:35]
  s_waitcnt vmcnt(22)
  v_mfma_f32_32x32x16_bf16 v[20:35], a[168:171], v[208:211], v[20:35]
  s_waitcnt vmcnt(21)
  v_mfma_f32_32x32x16_bf16 v[20:35], a[172:175], v[212:215], v[20:35]
  s_waitcnt vmcnt(20)
  v_mfma_f32_32x32x16_bf16 v[20:35], a[176:179], v[216:219], v[20:35]
  s_waitcnt vmcnt(19)
  v_mfma_f32_32x32x16_bf16 v[20:35], a[180:183], v[220:223], v[20:35]
  s_waitcnt vmcnt(18)
  v_mfma_f32_32x32x16_bf16 v[20:35], a[184:187], v[224:227], v[20:35]
  s_waitcnt vmcnt(17)
  v_mfma_f32_32x32x16_bf16 v[20:35], a[188:191], v[228:231], v[20:35]
  s_waitcnt vmcnt(16)
  v_mfma_f32_32x32x16_bf16 v[20:35], a[192:195], v[232:235], v[20:35]
  s_waitcnt vmcnt(15)
  v_mfma_f32_32x32x16_bf16 v[20:35], a[196:199], v[236:239], v[20:35]
  s_waitcnt vmcnt(14)
  v_mfma_f32_32x32x16_bf16 v[20:35], a[200:203], v[240:243], v[20:35]
  s_waitcnt vmcnt(13)
  v_mfma_f32_32x32x16_bf16 v[20:35], a[204:207], v[244:247], v[20:35]
  s_waitcnt vmcnt(12)
  v_mfma_f32_32x32x16_bf16 v[20:35], a[208:211], v[40:43], v[20:35]
  s_waitcnt vmcnt(11)
  v_mfma_f32_32x32x16_bf16 v[20:35], a[212:215], v[44:47], v[20:35]
  s_waitcnt vmcnt(10)
  v_mfma_f32_32x32x16_bf16 v[20:35], a[216:219], v[48:51], v[20:35]
  s_waitcnt vmcnt(9)
  v_mfma_f32_32x32x16_bf16 v[20:35], a[220:223], v[52:55], v[20:35]
  s_waitcnt vmcnt(8)
  v_mfma_f32_32x32x16_bf16 v[20:35], a[224:227], v[56:59], v[20:35]
  s_waitcnt vmcnt(7)
  v_mfma_f32_32x32x16_bf16 v[20:35], a[228:231], v[60:63], v[20:35]
  s_waitcnt vmcnt(6)
  v_mfma_f32_32x32x16_bf16 v[20:35], a[232:235], v[64:67], v[20:35]
  s_waitcnt vmcnt(5)
  v_mfma_f32_32x32x16_bf16 v[20:35], a[236:239], v[68:71], v[20:35]
  s_waitcnt vmcnt(4)
  v_mfma_f32_32x32x16_bf16 v[20:35], a[240:243], v[72:75], v[20:35]
  s_waitcnt vmcnt(3)
  v_mfma_f32_32x32x16_bf16 v[20:35], a[244:247], v[76:79], v[20:35]
  s_waitcnt vmcnt(2)
  v_mfma_f32_32x32x16_bf16 v[20:35], a[248:251], v[80:83], v[20:35]
  s_waitcnt vmcnt(1)
  v_mfma_f32_32x32x16_bf16 v[20:35], a[252:255], v[84:87], v[20:35]
  s_nop 11
  ds_write_b128 v13, v[20:23] offset:0
  ds_write_b128 v13, v[24:27] offset:1024
  ds_write_b128 v13, v[28:31] offset:2048
  ds_write_b128 v13, v[32:35] offset:3072
  s_waitcnt lgkmcnt(0)
  s_barrier
  ds_read_b128 v[20:23], v14 offset:0
  ds_read_b128 v[24:27], v14 offset:4096
  ds_read_b128 v[28:31], v14 offset:8192
  ds_read_b128 v[32:35], v14 offset:12288
  s_waitcnt lgkmcnt(2)
  v_pk_add_f32 v[20:21], v[20:21], v[24:25]
  s_waitcnt lgkmcnt(0)
  v_pk_add_f32 v[28:29], v[28:29], v[32:33]
  v_pk_add_f32 v[20:21], v[20:21], v[28:29]
  v_pk_add_f32 v[22:23], v[22:23], v[26:27]
  v_pk_add_f32 v[30:31], v[30:31], v[34:35]
  v_pk_add_f32 v[22:23], v[22:23], v[30:31]
  s_waitcnt vmcnt(0)
  v_lshlrev_b32 v8, 16, v36
  v_and_b32 v9, 0xffff0000, v36
  v_add_f32 v8, v8, v20
  v_add_f32 v9, v9, v21
  v_cvt_pk_bf16_f32 v36, v8, v9
  v_lshlrev_b32 v8, 16, v37
  v_and_b32 v9, 0xffff0000, v37
  v_add_f32 v8, v8, v22
  v_add_f32 v9, v9, v23
  v_cvt_pk_bf16_f32 v37, v8, v9
  buffer_store_dwordx2 v[36:37], v12, s[16:19], s75 offen sc1
  s_waitcnt vmcnt(0) lgkmcnt(0)
  s_barrier
  s_cmp_lg_u32 s51, 0
  s_cbranch_scc1 w0_31
  s_mov_b64 exec, 1
  v_mov_b32 v8, 0
  v_mov_b32 v9, s77
  buffer_store_dword v9, v8, s[4:7], s70 offen sc1
  s_mov_b64 exec, -1
w0_31:
  s_add_u32 s53, s53, 4
  s_cmp_lt_u32 s53, 64
  s_cbranch_scc1 O_LOOP
  s_mov_b32 s16, s44
  s_mov_b32 s17, s45
  s_mov_b32 s18, 2359296
  s_mov_b32 s19, 0x00020000
  s_add_u32 s52, s52, 1
  s_mov_b32 s54, 104857600
  s_cmp_lt_u32 s52, 2
  s_cbranch_scc1 O_LAYER
  s_branch W_END
R_ATT:
  s_sub_u32 s60, s68, 192
  s_mul_i32 s73, s60, 52
  s_lshr_b32 s73, s73, 8
  s_mul_i32 s61, s73, 5
  s_sub_u32 s72, s60, s61
  s_lshl_b32 s72, s72, 8
  s_lshl_b32 s61, s51, 10
  v_add_u32 v8, s61, v5
  s_and_b32 s61, s60, 7
  s_lshl_b32 s61, s61, 12
  s_lshl_b32 s60, s60, 13
  s_add_u32 s60, s60, 524288
  s_add_u32 s62, s60, 4096
  v_mov_b64 v[12:13], 0
  v_mov_b64 v[14:15], 0
  buffer_store_dwordx4 v[12:15], v8, s[4:7], s60 offen sc1
  buffer_store_dwordx4 v[12:15], v8, s[4:7], s61 offen sc1
  buffer_store_dwordx4 v[12:15], v8, s[4:7], s62 offen sc1
  s_waitcnt vmcnt(0) lgkmcnt(0)
  s_barrier
  s_cmp_lg_u32 s51, 0
  s_cbranch_scc1 w0_32
  s_mov_b64 exec, 1
  v_mov_b32 v8, 4
  v_mov_b32 v9, 1
  buffer_atomic_add v9, v8, s[20:23], 0 offen sc1
  s_mov_b64 exec, -1
w0_32:
  s_mov_b32 s12, s28
  s_mov_b32 s13, s29
  s_mov_b32 s14, 663552
  s_mov_b32 s15, 0x00020000
  s_cmp_ge_u32 s68, 212
  s_cbranch_scc1 AT_NW
  s_waitcnt lgkmcnt(0)
  s_barrier
  v_lshrrev_b32 v8, 4, v0
  v_and_b32 v9, 15, v0
  v_lshlrev_b32 v10, 2, v8
  v_xor_b32 v9, v9, v10
  v_lshlrev_b32 v9, 4, v9
  v_mul_u32_u24 v10, 1152, v8
  v_add_u32 v10, v10, v9
  s_and_b32 s60, s51, 1
  s_lshl_b32 s60, s60, 1
  s_lshr_b32 s61, s51, 1
  s_add_u32 s60, s60, s61
  s_mul_i32 s60, s60, 4608
  s_add_u32 s60, s60, s72
  s_lshl_b32 s61, s51, 10
  s_mov_b32 m0, s61
  s_add_u32 s61, s61, 4096
  buffer_load_dwordx4 v10, s[12:15], s60 offen  lds
  s_add_u32 s60, s60, 20736
  s_mov_b32 m0, s61
  s_add_u32 s61, s61, 4096
  buffer_load_dwordx4 v10, s[12:15], s60 offen  lds
  s_add_u32 s60, s60, 20736
  s_mov_b32 m0, s61
  s_add_u32 s61, s61, 4096
  buffer_load_dwordx4 v10, s[12:15], s60 offen  lds
  s_add_u32 s60, s60, 20736
  s_mov_b32 m0, s61
  s_add_u32 s61, s61, 4096
  buffer_load_dwordx4 v10, s[12:15], s60 offen  lds
  s_add_u32 s60, s60, 20736
  s_mov_b32 m0, s61
  s_add_u32 s61, s61, 4096
  buffer_load_dwordx4 v10, s[12:15], s60 offen  lds
  s_add_u32 s60, s60, 20736
  s_mov_b32 m0, s61
  s_add_u32 s61, s61, 4096
  buffer_load_dwordx4 v10, s[12:15], s60 offen  lds
  s_add_u32 s60, s60, 20736
  s_mov_b32 m0, s61
  s_add_u32 s61, s61, 4096
  buffer_load_dwordx4 v10, s[12:15], s60 offen  lds
  s_add_u32 s60, s60, 20736
  s_mov_b32 m0, s61
  s_add_u32 s61, s61, 4096
  buffer_load_dwordx4 v10, s[12:15], s60 offen  lds
  s_add_u32 s60, s60, 20736
  s_mov_b32 m0, s61
  s_add_u32 s61, s61, 4096
  buffer_load_dwordx4 v10, s[12:15], s60 offen  lds
  s_add_u32 s60, s60, 20736
  s_mov_b32 m0, s61
  s_add_u32 s61, s61, 4096
  buffer_load_dwordx4 v10, s[12:15], s60 offen  lds
  s_add_u32 s60, s60, 20736
  s_mov_b32 m0, s61
  s_add_u32 s61, s61, 4096
  buffer_load_dwordx4 v10, s[12:15], s60 offen  lds
  s_add_u32 s60, s60, 20736
  s_mov_b32 m0, s61
  s_add_u32 s61, s61, 4096
  buffer_load_dwordx4 v10, s[12:15], s60 offen  lds
  s_add_u32 s60, s60, 20736
  s_mov_b32 m0, s61
  s_add_u32 s61, s61, 4096
  buffer_load_dwordx4 v10, s[12:15], s60 offen  lds
  s_add_u32 s60, s60, 20736
  s_mov_b32 m0, s61
  s_add_u32 s61, s61, 4096
  buffer_load_dwordx4 v10, s[12:15], s60 offen  lds
  s_add_u32 s60, s60, 20736
  s_mov_b32 m0, s61
  s_add_u32 s61, s61, 4096
  buffer_load_dwordx4 v10, s[12:15], s60 offen  lds
  s_add_u32 s60, s60, 20736
  s_mov_b32 m0, s61
  s_add_u32 s61, s61, 4096
  buffer_load_dwordx4 v10, s[12:15], s60 offen  lds
  s_add_u32 s60, s60, 20736
  s_mov_b32 m0, s61
  s_add_u32 s61, s61, 4096
  buffer_load_dwordx4 v10, s[12:15], s60 offen  lds
  s_add_u32 s60, s60, 20736
  s_mov_b32 m0, s61
  s_add_u32 s61, s61, 4096
  buffer_load_dwordx4 v10, s[12:15], s60 offen  lds
  s_add_u32 s60, s60, 20736
  s_mov_b32 m0, s61
  s_add_u32 s61, s61, 4096
  buffer_load_dwordx4 v10, s[12:15], s60 offen  lds
  s_add_u32 s60, s60, 20736
  s_mov_b32 m0, s61
  s_add_u32 s61, s61, 4096
  buffer_load_dwordx4 v10, s[12:15], s60 offen  lds
  s_add_u32 s60, s60, 20736
  s_mov_b32 m0, s61
  s_add_u32 s61, s61, 4096
  buffer_load_dwordx4 v10, s[12:15], s60 offen  lds
  s_add_u32 s60, s60, 20736
  s_mov_b32 m0, s61
  s_add_u32 s61, s61, 4096
  buffer_load_dwordx4 v10, s[12:15], s60 offen  lds
  s_add_u32 s60, s60, 20736
  s_mov_b32 m0, s61
  s_add_u32 s61, s61, 4096
  buffer_load_dwordx4 v10, s[12:15], s60 offen  lds
  s_add_u32 s60, s60, 20736
  s_mov_b32 m0, s61
  s_add_u32 s61, s61, 4096
  buffer_load_dwordx4 v10, s[12:15], s60 offen  lds
  s_add_u32 s60, s60, 20736
  s_mov_b32 m0, s61
  s_add_u32 s61, s61, 4096
  buffer_load_dwordx4 v10, s[12:15], s60 offen  lds
  s_add_u32 s60, s60, 20736
  s_mov_b32 m0, s61
  s_add_u32 s61, s61, 4096
  buffer_load_dwordx4 v10, s[12:15], s60 offen  lds
  s_add_u32 s60, s60, 20736
  s_mov_b32 m0, s61
  s_add_u32 s61, s61, 4096
  buffer_load_dwordx4 v10, s[12:15], s60 offen  lds
  s_add_u32 s60, s60, 20736
  s_mov_b32 m0, s61
  s_add_u32 s61, s61, 4096
  buffer_load_dwordx4 v10, s[12:15], s60 offen  lds
  s_add_u32 s60, s60, 20736
  s_mov_b32 m0, s61
  s_add_u32 s61, s61, 4096
  buffer_load_dwordx4 v10, s[12:15], s60 offen  lds
  s_add_u32 s60, s60, 20736
  s_mov_b32 m0, s61
  s_add_u32 s61, s61, 4096
  buffer_load_dwordx4 v10, s[12:15], s60 offen  lds
  s_add_u32 s60, s60, 20736
  s_mov_b32 m0, s61
  s_add_u32 s61, s61, 4096
  buffer_load_dwordx4 v10, s[12:15], s60 offen  lds
  s_add_u32 s60, s60, 20736
  s_mov_b32 m0, s61
  s_add_u32 s61, s61, 4096
  buffer_load_dwordx4 v10, s[12:15], s60 offen  lds
  s_add_u32 s60, s60, 20736
  v_lshrrev_b32 v10, 1, v8
  v_mul_u32_u24 v10, 18, v10
  v_and_b32 v8, 1, v8
  v_add_u32 v10, v10, v8
  v_mul_u32_u24 v10, 1152, v10
  v_add_u32 v10, v10, v9
  s_mul_i32 s60, s51, 41472
  s_add_u32 s60, s60, 18432
  s_add_u32 s60, s60, s72
  s_mov_b32 m0, s61
  s_add_u32 s61, s61, 4096
  buffer_load_dwordx4 v10, s[12:15], s60 offen  lds
  s_add_u32 s60, s60, 165888
  s_mov_b32 m0, s61
  s_add_u32 s61, s61, 4096
  buffer_load_dwordx4 v10, s[12:15], s60 offen  lds
  s_add_u32 s60, s60, 165888
  s_mov_b32 m0, s61
  s_add_u32 s61, s61, 4096
  buffer_load_dwordx4 v10, s[12:15], s60 offen  lds
  s_add_u32 s60, s60, 165888
  s_mov_b32 m0, s61
  s_add_u32 s61, s61, 4096
  buffer_load_dwordx4 v10, s[12:15], s60 offen  lds
  s_add_u32 s60, s60, 165888
  v_bfe_u32 v8, v0, 4, 1
  v_bfe_u32 v9, v0, 2, 2
  v_and_b32 v10, 3, v0
  v_xor_b32 v11, s51, v9
  v_lshlrev_b32 v11, 6, v11
  v_lshl_add_u32 v11, v8, 5, v11
  v_lshl_add_u32 v11, v10, 3, v11
  v_lshl_add_u32 v11, v9, 8, v11
  v_lshl_add_u32 v11, v6, 11, v11
  s_waitcnt vmcnt(0) lgkmcnt(0)
  s_barrier
  ds_read_b64_tr_b16 a[0:1], v11 offset:0
  ds_read_b64_tr_b16 a[2:3], v11 offset:1024
  ds_read_b64_tr_b16 a[4:5], v11 offset:4096
  ds_read_b64_tr_b16 a[6:7], v11 offset:5120
  ds_read_b64_tr_b16 a[8:9], v11 offset:8192
  ds_read_b64_tr_b16 a[10:11], v11 offset:9216
  ds_read_b64_tr_b16 a[12:13], v11 offset:12288
  ds_read_b64_tr_b16 a[14:15], v11 offset:13312
  ds_read_b64_tr_b16 a[16:17], v11 offset:16384
  ds_read_b64_tr_b16 a[18:19], v11 offset:17408
  ds_read_b64_tr_b16 a[20:21], v11 offset:20480
  ds_read_b64_tr_b16 a[22:23], v11 offset:21504
  ds_read_b64_tr_b16 a[24:25], v11 offset:24576
  ds_read_b64_tr_b16 a[26:27], v11 offset:25600
  ds_read_b64_tr_b16 a[28:29], v11 offset:28672
  ds_read_b64_tr_b16 a[30:31], v11 offset:29696
  ds_read_b64_tr_b16 a[32:33], v11 offset:32768
  ds_read_b64_tr_b16 a[34:35], v11 offset:33792
  ds_read_b64_tr_b16 a[36:37], v11 offset:36864
  ds_read_b64_tr_b16 a[38:39], v11 offset:37888
  ds_read_b64_tr_b16 a[40:41], v11 offset:40960
  ds_read_b64_tr_b16 a[42:43], v11 offset:41984
  ds_read_b64_tr_b16 a[44:45], v11 offset:45056
  ds_read_b64_tr_b16 a[46:47], v11 offset:46080
  ds_read_b64_tr_b16 a[48:49], v11 offset:49152
  ds_read_b64_tr_b16 a[50:51], v11 offset:50176
  ds_read_b64_tr_b16 a[52:53], v11 offset:53248
  ds_read_b64_tr_b16 a[54:55], v11 offset:54272
  ds_read_b64_tr_b16 a[56:57], v11 offset:57344
  ds_read_b64_tr_b16 a[58:59], v11 offset:58368
  ds_read_b64_tr_b16 a[60:61], v11 offset:61440
  ds_read_b64_tr_b16 a[62:63], v11 offset:62464
  v_add_u32 v11, 0x10000, v11
  ds_read_b64_tr_b16 a[64:65], v11 offset:0
  ds_read_b64_tr_b16 a[66:67], v11 offset:1024
  ds_read_b64_tr_b16 a[68:69], v11 offset:4096
  ds_read_b64_tr_b16 a[70:71], v11 offset:5120
  ds_read_b64_tr_b16 a[72:73], v11 offset:8192
  ds_read_b64_tr_b16 a[74:75], v11 offset:9216
  ds_read_b64_tr_b16 a[76:77], v11 offset:12288
  ds_read_b64_tr_b16 a[78:79], v11 offset:13312
  ds_read_b64_tr_b16 a[80:81], v11 offset:16384
  ds_read_b64_tr_b16 a[82:83], v11 offset:17408
  ds_read_b64_tr_b16 a[84:85], v11 offset:20480
  ds_read_b64_tr_b16 a[86:87], v11 offset:21504
  ds_read_b64_tr_b16 a[88:89], v11 offset:24576
  ds_read_b64_tr_b16 a[90:91], v11 offset:25600
  ds_read_b64_tr_b16 a[92:93], v11 offset:28672
  ds_read_b64_tr_b16 a[94:95], v11 offset:29696
  ds_read_b64_tr_b16 a[96:97], v11 offset:32768
  ds_read_b64_tr_b16 a[98:99], v11 offset:33792
  ds_read_b64_tr_b16 a[100:101], v11 offset:36864
  ds_read_b64_tr_b16 a[102:103], v11 offset:37888
  ds_read_b64_tr_b16 a[104:105], v11 offset:40960
  ds_read_b64_tr_b16 a[106:107], v11 offset:41984
  ds_read_b64_tr_b16 a[108:109], v11 offset:45056
  ds_read_b64_tr_b16 a[110:111], v11 offset:46080
  ds_read_b64_tr_b16 a[112:113], v11 offset:49152
  ds_read_b64_tr_b16 a[114:115], v11 offset:50176
  ds_read_b64_tr_b16 a[116:117], v11 offset:53248
  ds_read_b64_tr_b16 a[118:119], v11 offset:54272
  ds_read_b64_tr_b16 a[120:121], v11 offset:57344
  ds_read_b64_tr_b16 a[122:123], v11 offset:58368
  ds_read_b64_tr_b16 a[124:125], v11 offset:61440
  ds_read_b64_tr_b16 a[126:127], v11 offset:62464
  v_add_u32 v11, 0x10000, v11
  ds_read_b64_tr_b16 a[128:129], v11 offset:0
  ds_read_b64_tr_b16 a[130:131], v11 offset:1024
  ds_read_b64_tr_b16 a[132:133], v11 offset:4096
  ds_read_b64_tr_b16 a[134:135], v11 offset:5120
  ds_read_b64_tr_b16 a[136:137], v11 offset:8192
  ds_read_b64_tr_b16 a[138:139], v11 offset:9216
  ds_read_b64_tr_b16 a[140:141], v11 offset:12288
  ds_read_b64_tr_b16 a[142:143], v11 offset:13312
  s_waitcnt lgkmcnt(0)
  s_barrier
AT_NW:
  v_mov_b32 v8, 4
  s_mov_b32 s55, 150000
poll_33:
  buffer_load_dword v9, v8, s[20:23], 0 offen sc1
  s_waitcnt vmcnt(0)
  v_cmp_gt_u32 vcc, 56, v9
  s_nop 0
  s_cbranch_vccz pdone_34
  s_sleep 2
  s_mov_b32 s58, 43
  s_sub_u32 s55, s55, 1
  s_cbranch_scc0 poll_33
  s_branch ABORT
pdone_34:
AT_LAYER:
  s_cmp_ge_u32 s68, 212
  s_cbranch_scc1 A2_DONE
  v_bfe_u32 v8, v0, 4, 1
  v_bfe_u32 v9, v0, 2, 2
  v_and_b32 v10, 3, v0
  v_and_b32 v11, 1, v10
  v_lshlrev_b32 v11, 5, v11
  v_lshl_add_u32 v11, v8, 4, v11
  v_lshrrev_b32 v10, 1, v10
  v_lshl_add_u32 v11, v10, 3, v11
  s_mul_i32 s78, s51, 9216
  s_add_u32 s60, s78, 38016
  v_add_u32 v11, s60, v11
  v_lshl_add_u32 v13, v9, 6, v11
  v_lshl_add_u32 v13, v6, 9, v13
  v_and_b32 v9, 1, v9
  v_lshl_add_u32 v14, v9, 6, v11
  s_mul_i32 s60, s51, 8448
  v_add_u32 v2, s60, v3
  s_mul_i32 s60, s51, 1056
  v_add_u32 v15, s60, v3
  s_lshl_b32 s60, s51, 6
  s_add_u32 s60, s60, s72
  s_cmp_lt_u32 s60, 1152
  s_cselect_b32 s60, s60, 1073741824
  v_mul_u32_u24 v12, 1152, v7
  v_lshl_add_u32 v12, v6, 4, v12
  v_add_u32 v12, s60, v12
  v_and_b32 v8, 1, v0
  v_add_u32 v8, 16, v8
  v_and_b32 v9, 2, v0
  v_cmp_eq_u32 vcc, 0, v9
  s_nop 1
  v_cndmask_b32 v8, 18, v8, vcc
  v_cmp_gt_u32 vcc, 16, v7
  s_nop 1
  v_cndmask_b32 v8, v8, v7, vcc
  v_lshlrev_b32 v9, 1, v6
  v_xor_b32 v9, v9, v8
  v_and_b32 v9, 7, v9
  v_lshlrev_b32 v9, 4, v9
  v_lshl_add_u32 v9, v8, 7, v9
  s_mul_i32 s79, s51, 20480
  s_add_u32 s60, s79, 74880
  v_add_u32 v16, s60, v9
  v_xor_b32 v17, 16, v16
  v_xor_b32 v18, 64, v16
  v_xor_b32 v19, 16, v18
  v_lshrrev_b32 v8, 3, v0
  v_lshlrev_b32 v8, 4, v8
  v_xor_b32 v4, v8, v5
  s_sub_u32 s70, s68, 192
  s_lshl_b32 s70, s70, 6
  s_mov_b32 s53, s73
  s_cmp_eq_u32 s52, 0
  s_cselect_b32 s77, 24, 3
  v_and_b32 v8, 7, v0
  v_lshlrev_b32 v8, 7, v8
  s_lshl_b32 s61, s52, 10
  s_add_u32 s61, s61, 22528
  s_add_u32 s60, s54, 3145728
  s_add_u32 s16, s48, s60
  s_addc_u32 s17, s49, 0
  s_cmp_lg_u32 s51, 0
  s_cbranch_scc1 w0_35
  s_mov_b32 s55, 150000
poll_36:
  buffer_load_dword v9, v8, s[4:7], s61 offen sc1
  s_waitcnt vmcnt(0)
  v_cmp_gt_u32 vcc, s77, v9
  s_nop 0
  s_cbranch_vccz pdone_37
  s_sleep 1
  s_mov_b32 s58, 40
  s_sub_u32 s55, s55, 1
  s_cbranch_scc0 poll_36
  s_branch ABORT
pdone_37:
w0_35:
  s_waitcnt lgkmcnt(0)
  s_barrier
  s_mul_i32 s61, s52, 81920
  s_add_u32 s62, s79, s61
  s_add_u32 s62, s62, 524288
  s_add_u32 s63, s79, 74880
  s_mov_b32 m0, s63
  s_add_u32 s63, s63, 1024
  buffer_load_dwordx4 v4, s[4:7], s62 offen sc1 lds
  s_add_u32 s62, s62, 1024
  s_mov_b32 m0, s63
  s_add_u32 s63, s63, 1024
  buffer_load_dwordx4 v4, s[4:7], s62 offen sc1 lds
  s_add_u32 s62, s62, 1024
  s_mov_b32 m0, s63
  s_add_u32 s63, s63, 1024
  buffer_load_dwordx4 v4, s[4:7], s62 offen sc1 lds
  s_add_u32 s62, s62, 1024
  s_mov_b32 m0, s63
  s_add_u32 s63, s63, 1024
  buffer_load_dwordx4 v4, s[4:7], s62 offen sc1 lds
  s_add_u32 s62, s62, 1024
  s_mov_b32 m0, s63
  s_add_u32 s63, s63, 1024
  buffer_load_dwordx4 v4, s[4:7], s62 offen sc1 lds
  s_add_u32 s62, s62, 1024
  s_mov_b32 m0, s63
  s_add_u32 s63, s63, 1024
  buffer_load_dwordx4 v4, s[4:7], s62 offen sc1 lds
  s_add_u32 s62, s62, 1024
  s_mov_b32 m0, s63
  s_add_u32 s63, s63, 1024
  buffer_load_dwordx4 v4, s[4:7], s62 offen sc1 lds
  s_add_u32 s62, s62, 1024
  s_mov_b32 m0, s63
  s_add_u32 s63, s63, 1024
  buffer_load_dwordx4 v4, s[4:7], s62 offen sc1 lds
  s_add_u32 s62, s62, 1024
  s_mov_b32 m0, s63
  s_add_u32 s63, s63, 1024
  buffer_load_dwordx4 v4, s[4:7], s62 offen sc1 lds
  s_add_u32 s62, s62, 1024
  s_mov_b32 m0, s63
  s_add_u32 s63, s63, 1024
  buffer_load_dwordx4 v4, s[4:7], s62 offen sc1 lds
  s_add_u32 s62, s62, 1024
  s_mov_b32 m0, s63
  s_add_u32 s63, s63, 1024
  buffer_load_dwordx4 v4, s[4:7], s62 offen sc1 lds
  s_add_u32 s62, s62, 1024
  s_mov_b32 m0, s63
  s_add_u32 s63, s63, 1024
  buffer_load_dwordx4 v4, s[4:7], s62 offen sc1 lds
  s_add_u32 s62, s62, 1024
  s_mov_b32 m0, s63
  s_add_u32 s63, s63, 1024
  buffer_load_dwordx4 v4, s[4:7], s62 offen sc1 lds
  s_add_u32 s62, s62, 1024
  s_mov_b32 m0, s63
  s_add_u32 s63, s63, 1024
  buffer_load_dwordx4 v4, s[4:7], s62 offen sc1 lds
  s_add_u32 s62, s62, 1024
  s_mov_b32 m0, s63
  s_add_u32 s63, s63, 1024
  buffer_load_dwordx4 v4, s[4:7], s62 offen sc1 lds
  s_add_u32 s62, s62, 1024
  s_mov_b32 m0, s63
  s_add_u32 s63, s63, 1024
  buffer_load_dwordx4 v4, s[4:7], s62 offen sc1 lds
  s_add_u32 s62, s62, 1024
  s_mov_b32 m0, s63
  s_add_u32 s63, s63, 1024
  buffer_load_dwordx4 v4, s[4:7], s62 offen sc1 lds
  s_add_u32 s62, s62, 1024
  s_mov_b32 m0, s63
  s_add_u32 s63, s63, 1024
  buffer_load_dwordx4 v4, s[4:7], s62 offen sc1 lds
  s_add_u32 s62, s62, 1024
  s_mov_b32 m0, s63
  s_add_u32 s63, s63, 1024
  buffer_load_dwordx4 v4, s[4:7], s62 offen sc1 lds
  s_add_u32 s62, s62, 1024
  s_mov_b32 m0, s63
  s_add_u32 s63, s63, 1024
  buffer_load_dwordx4 v4, s[4:7], s62 offen sc1 lds
  s_add_u32 s62, s62, 1024
  s_mul_i32 s60, s53, 36864
  s_add_u32 s60, s60, s78
  s_add_u32 s60, s60, s54
  s_add_u32 s61, s78, 38016
  s_mov_b32 m0, s61
  s_add_u32 s61, s61, 1024
  buffer_load_dwordx4 v5, s[4:7], s60 offen sc1 lds
  s_add_u32 s60, s60, 1024
  s_mov_b32 m0, s61
  s_add_u32 s61, s61, 1024
  buffer_load_dwordx4 v5, s[4:7], s60 offen sc1 lds
  s_add_u32 s60, s60, 1024
  s_mov_b32 m0, s61
  s_add_u32 s61, s61, 1024
  buffer_load_dwordx4 v5, s[4:7], s60 offen sc1 lds
  s_add_u32 s60, s60, 1024
  s_mov_b32 m0, s61
  s_add_u32 s61, s61, 1024
  buffer_load_dwordx4 v5, s[4:7], s60 offen sc1 lds
  s_add_u32 s60, s60, 1024
  s_mov_b32 m0, s61
  s_add_u32 s61, s61, 1024
  buffer_load_dwordx4 v5, s[4:7], s60 offen sc1 lds
  s_add_u32 s60, s60, 1024
  s_mov_b32 m0, s61
  s_add_u32 s61, s61, 1024
  buffer_load_dwordx4 v5, s[4:7], s60 offen sc1 lds
  s_add_u32 s60, s60, 1024
  s_mov_b32 m0, s61
  s_add_u32 s61, s61, 1024
  buffer_load_dwordx4 v5, s[4:7], s60 offen sc1 lds
  s_add_u32 s60, s60, 1024
  s_mov_b32 m0, s61
  s_add_u32 s61, s61, 1024
  buffer_load_dwordx4 v5, s[4:7], s60 offen sc1 lds
  s_add_u32 s60, s60, 1024
  s_mov_b32 m0, s61
  s_add_u32 s61, s61, 1024
  buffer_load_dwordx4 v5, s[4:7], s60 offen sc1 lds
  s_add_u32 s60, s60, 1024
  s_waitcnt vmcnt(9)
  ds_read_b128 v[116:119], v16 offset:0
  ds_read_b128 v[120:123], v17 offset:0
  ds_read_b64 v[124:125], v18 offset:0
  ds_read_b128 v[126:129], v18 offset:2560
  ds_read_b128 v[130:133], v19 offset:2560
  ds_read_b64 v[134:135], v16 offset:2560
  ds_read_b128 v[136:139], v16 offset:5120
  ds_read_b128 v[140:143], v17 offset:5120
  ds_read_b64 v[144:145], v18 offset:5120
  ds_read_b128 v[146:149], v18 offset:7680
  ds_read_b128 v[150:153], v19 offset:7680
  ds_read_b64 v[154:155], v16 offset:7680
  ds_read_b128 v[156:159], v16 offset:10240
  ds_read_b128 v[160:163], v17 offset:10240
  ds_read_b64 v[164:165], v18 offset:10240
  ds_read_b128 v[166:169], v18 offset:12800
  ds_read_b128 v[170:173], v19 offset:12800
  ds_read_b64 v[174:175], v16 offset:12800
  ds_read_b128 v[176:179], v16 offset:15360
  ds_read_b128 v[180:183], v17 offset:15360
  ds_read_b64 v[184:185], v18 offset:15360
  ds_read_b128 v[186:189], v18 offset:17920
  ds_read_b128 v[190:193], v19 offset:17920
  ds_read_b64 v[194:195], v16 offset:17920
  s_waitcnt lgkmcnt(15)
  v_cvt_pk_bf16_f32 v20, v116, v117
  v_cvt_pk_bf16_f32 v21, v118, v119
  v_cvt_pk_bf16_f32 v22, v120, v121
  v_cvt_pk_bf16_f32 v23, v122, v123
  v_cvt_pk_bf16_f32 v24, v124, v125
  v_mov_b32 v25, 0
  v_cvt_pk_bf16_f32 v26, v126, v127
  v_cvt_pk_bf16_f32 v27, v128, v129
  v_cvt_pk_bf16_f32 v28, v130, v131
  v_cvt_pk_bf16_f32 v29, v132, v133
  v_cvt_pk_bf16_f32 v30, v134, v135
  v_mov_b32 v31, 0
  v_cvt_pk_bf16_f32 v32, v136, v137
  v_cvt_pk_bf16_f32 v33, v138, v139
  v_cvt_pk_bf16_f32 v34, v140, v141
  v_cvt_pk_bf16_f32 v35, v142, v143
  v_cvt_pk_bf16_f32 v36, v144, v145
  v_mov_b32 v37, 0
  s_waitcnt lgkmcnt(14)
  v_cvt_pk_bf16_f32 v38, v146, v147
  v_cvt_pk_bf16_f32 v39, v148, v149
  s_waitcnt lgkmcnt(13)
  v_cvt_pk_bf16_f32 v40, v150, v151
  v_cvt_pk_bf16_f32 v41, v152, v153
  s_waitcnt lgkmcnt(12)
  v_cvt_pk_bf16_f32 v42, v154, v155
  v_mov_b32 v43, 0
  s_waitcnt lgkmcnt(11)
  v_cvt_pk_bf16_f32 v44, v156, v157
  v_cvt_pk_bf16_f32 v45, v158, v159
  s_waitcnt lgkmcnt(10)
  v_cvt_pk_bf16_f32 v46, v160, v161
  v_cvt_pk_bf16_f32 v47, v162, v163
  s_waitcnt lgkmcnt(9)
  v_cvt_pk_bf16_f32 v48, v164, v165
  v_mov_b32 v49, 0
  s_waitcnt lgkmcnt(8)
  v_cvt_pk_bf16_f32 v50, v166, v167
  v_cvt_pk_bf16_f32 v51, v168, v169
  s_waitcnt lgkmcnt(7)
  v_cvt_pk_bf16_f32 v52, v170, v171
  v_cvt_pk_bf16_f32 v53, v172, v173
  s_waitcnt lgkmcnt(6)
  v_cvt_pk_bf16_f32 v54, v174, v175
  v_mov_b32 v55, 0
  s_waitcnt lgkmcnt(5)
  v_cvt_pk_bf16_f32 v56, v176, v177
  v_cvt_pk_bf16_f32 v57, v178, v179
  s_waitcnt lgkmcnt(4)
  v_cvt_pk_bf16_f32 v58, v180, v181
  v_cvt_pk_bf16_f32 v59, v182, v183
  s_waitcnt lgkmcnt(3)
  v_cvt_pk_bf16_f32 v60, v184, v185
  v_mov_b32 v61, 0
  s_waitcnt lgkmcnt(2)
  v_cvt_pk_bf16_f32 v62, v186, v187
  v_cvt_pk_bf16_f32 v63, v188, v189
  s_waitcnt lgkmcnt(1)
  v_cvt_pk_bf16_f32 v64, v190, v191
  v_cvt_pk_bf16_f32 v65, v192, v193
  s_waitcnt lgkmcnt(0)
  v_cvt_pk_bf16_f32 v66, v194, v195
  v_mov_b32 v67, 0
  s_waitcnt vmcnt(0)
A2_LOOP:
  ds_read_b64_tr_b16 v[68:69], v13 offset:0
  ds_read_b64_tr_b16 v[70:71], v13 offset:256
  ds_read_b64_tr_b16 v[72:73], v14 offset:1024
  ds_read_b64_tr_b16 v[74:75], v13 offset:1152
  ds_read_b64_tr_b16 v[76:77], v13 offset:1408
  ds_read_b64_tr_b16 v[78:79], v14 offset:2176
  ds_read_b64_tr_b16 v[80:81], v13 offset:2304
  ds_read_b64_tr_b16 v[82:83], v13 offset:2560
  ds_read_b64_tr_b16 v[84:85], v14 offset:3328
  ds_read_b64_tr_b16 v[86:87], v13 offset:3456
  ds_read_b64_tr_b16 v[88:89], v13 offset:3712
  ds_read_b64_tr_b16 v[90:91], v14 offset:4480
  ds_read_b64_tr_b16 v[92:93], v13 offset:4608
  ds_read_b64_tr_b16 v[94:95], v13 offset:4864
  ds_read_b64_tr_b16 v[96:97], v14 offset:5632
  ds_read_b64_tr_b16 v[98:99], v13 offset:5760
  ds_read_b64_tr_b16 v[100:101], v13 offset:6016
  ds_read_b64_tr_b16 v[102:103], v14 offset:6784
  ds_read_b64_tr_b16 v[104:105], v13 offset:6912
  ds_read_b64_tr_b16 v[106:107], v13 offset:7168
  ds_read_b64_tr_b16 v[108:109], v14 offset:7936
  ds_read_b64_tr_b16 v[110:111], v13 offset:8064
  ds_read_b64_tr_b16 v[112:113], v13 offset:8320
  ds_read_b64_tr_b16 v[114:115], v14 offset:9088
  s_mul_i32 s75, s53, 36864
  buffer_load_dwordx4 v[244:247], v12, s[8:11], s75 offen offset:0 sc1
  buffer_load_dwordx4 v[248:251], v12, s[8:11], s75 offen offset:32 sc1
  s_waitcnt lgkmcnt(15)
  v_mfma_f32_32x32x16_bf16 v[116:131], v[20:23], v[68:71], 0
  v_mfma_f32_32x32x16_bf16 v[132:147], v[26:29], v[74:77], 0
  s_nop 8
  v_mfma_f32_32x32x8bf16_1k v[116:131], v[24:25], v[72:73], v[116:131]
  v_mfma_f32_32x32x16_bf16 v[148:163], v[32:35], v[80:83], 0
  v_mfma_f32_32x32x8bf16_1k v[132:147], v[30:31], v[78:79], v[132:147]
  s_nop 9
  v_add_f32 v126, 0x358637bd, v126
  v_rcp_f32 v126, v126
  s_nop 0
  v_pk_mul_f32 v[116:117], v[116:117], v[126:127] op_sel_hi:[1,0]
  v_pk_mul_f32 v[118:119], v[118:119], v[126:127] op_sel_hi:[1,0]
  v_pk_mul_f32 v[120:121], v[120:121], v[126:127] op_sel_hi:[1,0]
  v_pk_mul_f32 v[122:123], v[122:123], v[126:127] op_sel_hi:[1,0]
  v_pk_mul_f32 v[124:125], v[124:125], v[126:127] op_sel_hi:[1,0]
  v_cvt_pk_bf16_f32 v116, v116, v117
  v_cvt_pk_bf16_f32 v117, v118, v119
  v_cvt_pk_bf16_f32 v118, v120, v121
  v_cvt_pk_bf16_f32 v119, v122, v123
  ds_write_b128 v2, v[116:119] offset:0
  v_cvt_pk_bf16_f32 v252, v124, v125
  s_waitcnt lgkmcnt(14)
  v_mfma_f32_32x32x16_bf16 v[164:179], v[38:41], v[86:89], 0
  v_mfma_f32_32x32x8bf16_1k v[148:163], v[36:37], v[84:85], v[148:163]
  v_add_f32 v142, 0x358637bd, v142
  v_rcp_f32 v142, v142
  s_nop 0
  v_pk_mul_f32 v[132:133], v[132:133], v[142:143] op_sel_hi:[1,0]
  v_pk_mul_f32 v[134:135], v[134:135], v[142:143] op_sel_hi:[1,0]
  v_pk_mul_f32 v[136:137], v[136:137], v[142:143] op_sel_hi:[1,0]
  v_pk_mul_f32 v[138:139], v[138:139], v[142:143] op_sel_hi:[1,0]
  v_pk_mul_f32 v[140:141], v[140:141], v[142:143] op_sel_hi:[1,0]
  v_cvt_pk_bf16_f32 v132, v132, v133
  v_cvt_pk_bf16_f32 v133, v134, v135
  v_cvt_pk_bf16_f32 v134, v136, v137
  v_cvt_pk_bf16_f32 v135, v138, v139
  ds_write_b128 v2, v[132:135] offset:1056
  v_cvt_pk_bf16_f32 v253, v140, v141
  s_waitcnt lgkmcnt(12)
  v_mfma_f32_32x32x16_bf16 v[180:195], v[44:47], v[92:95], 0
  v_mfma_f32_32x32x8bf16_1k v[164:179], v[42:43], v[90:91], v[164:179]
  v_add_f32 v158, 0x358637bd, v158
  v_rcp_f32 v158, v158
  s_nop 0
  v_pk_mul_f32 v[148:149], v[148:149], v[158:159] op_sel_hi:[1,0]
  v_pk_mul_f32 v[150:151], v[150:151], v[158:159] op_sel_hi:[1,0]
  v_pk_mul_f32 v[152:153], v[152:153], v[158:159] op_sel_hi:[1,0]
  v_pk_mul_f32 v[154:155], v[154:155], v[158:159] op_sel_hi:[1,0]
  v_pk_mul_f32 v[156:157], v[156:157], v[158:159] op_sel_hi:[1,0]
  v_cvt_pk_bf16_f32 v148, v148, v149
  v_cvt_pk_bf16_f32 v149, v150, v151
  v_cvt_pk_bf16_f32 v150, v152, v153
  v_cvt_pk_bf16_f32 v151, v154, v155
  ds_write_b128 v2, v[148:151] offset:2112
  v_cvt_pk_bf16_f32 v254, v156, v157
  s_waitcnt lgkmcnt(10)
  v_mfma_f32_32x32x16_bf16 v[196:211], v[50:53], v[98:101], 0
  v_mfma_f32_32x32x8bf16_1k v[180:195], v[48:49], v[96:97], v[180:195]
  v_add_f32 v174, 0x358637bd, v174
  v_rcp_f32 v174, v174
  s_nop 0
  v_pk_mul_f32 v[164:165], v[164:165], v[174:175] op_sel_hi:[1,0]
  v_pk_mul_f32 v[166:167], v[166:167], v[174:175] op_sel_hi:[1,0]
  v_pk_mul_f32 v[168:169], v[168:169], v[174:175] op_sel_hi:[1,0]
  v_pk_mul_f32 v[170:171], v[170:171], v[174:175] op_sel_hi:[1,0]
  v_pk_mul_f32 v[172:173], v[172:173], v[174:175] op_sel_hi:[1,0]
  v_cvt_pk_bf16_f32 v164, v164, v165
  v_cvt_pk_bf16_f32 v165, v166, v167
  v_cvt_pk_bf16_f32 v166, v168, v169
  v_cvt_pk_bf16_f32 v167, v170, v171
  ds_write_b128 v2, v[164:167] offset:3168
  v_cvt_pk_bf16_f32 v255, v172, v173
  s_waitcnt lgkmcnt(8)
  v_mfma_f32_32x32x16_bf16 v[212:227], v[56:59], v[104:107], 0
  v_mfma_f32_32x32x8bf16_1k v[196:211], v[54:55], v[102:103], v[196:211]
  v_add_f32 v190, 0x358637bd, v190
  v_rcp_f32 v190, v190
  s_nop 0
  v_pk_mul_f32 v[180:181], v[180:181], v[190:191] op_sel_hi:[1,0]
  v_pk_mul_f32 v[182:183], v[182:183], v[190:191] op_sel_hi:[1,0]
  v_pk_mul_f32 v[184:185], v[184:185], v[190:191] op_sel_hi:[1,0]
  v_pk_mul_f32 v[186:187], v[186:187], v[190:191] op_sel_hi:[1,0]
  v_pk_mul_f32 v[188:189], v[188:189], v[190:191] op_sel_hi:[1,0]
  v_cvt_pk_bf16_f32 v180, v180, v181
  v_cvt_pk_bf16_f32 v181, v182, v183
  v_cvt_pk_bf16_f32 v182, v184, v185
  v_cvt_pk_bf16_f32 v183, v186, v187
  ds_write_b128 v2, v[180:183] offset:4224
  v_cvt_pk_bf16_f32 v188, v188, v189
  v_cndmask_b32 v252, v252, v188, s[96:97]
  s_waitcnt lgkmcnt(6)
  v_mfma_f32_32x32x16_bf16 v[228:243], v[62:65], v[110:113], 0
  v_mfma_f32_32x32x8bf16_1k v[212:227], v[60:61], v[108:109], v[212:227]
  v_add_f32 v206, 0x358637bd, v206
  v_rcp_f32 v206, v206
  s_nop 0
  v_pk_mul_f32 v[196:197], v[196:197], v[206:207] op_sel_hi:[1,0]
  v_pk_mul_f32 v[198:199], v[198:199], v[206:207] op_sel_hi:[1,0]
  v_pk_mul_f32 v[200:201], v[200:201], v[206:207] op_sel_hi:[1,0]
  v_pk_mul_f32 v[202:203], v[202:203], v[206:207] op_sel_hi:[1,0]
  v_pk_mul_f32 v[204:205], v[204:205], v[206:207] op_sel_hi:[1,0]
  v_cvt_pk_bf16_f32 v196, v196, v197
  v_cvt_pk_bf16_f32 v197, v198, v199
  v_cvt_pk_bf16_f32 v198, v200, v201
  v_cvt_pk_bf16_f32 v199, v202, v203
  ds_write_b128 v2, v[196:199] offset:5280
  v_cvt_pk_bf16_f32 v204, v204, v205
  v_cndmask_b32 v253, v253, v204, s[96:97]
  s_waitcnt lgkmcnt(6)
  v_mfma_f32_32x32x8bf16_1k v[228:243], v[66:67], v[114:115], v[228:243]
  v_add_f32 v222, 0x358637bd, v222
  v_rcp_f32 v222, v222
  s_nop 0
  v_pk_mul_f32 v[212:213], v[212:213], v[222:223] op_sel_hi:[1,0]
  v_pk_mul_f32 v[214:215], v[214:215], v[222:223] op_sel_hi:[1,0]
  v_pk_mul_f32 v[216:217], v[216:217], v[222:223] op_sel_hi:[1,0]
  v_pk_mul_f32 v[218:219], v[218:219], v[222:223] op_sel_hi:[1,0]
  v_pk_mul_f32 v[220:221], v[220:221], v[222:223] op_sel_hi:[1,0]
  v_cvt_pk_bf16_f32 v212, v212, v213
  v_cvt_pk_bf16_f32 v213, v214, v215
  v_cvt_pk_bf16_f32 v214, v216, v217
  v_cvt_pk_bf16_f32 v215, v218, v219
  ds_write_b128 v2, v[212:215] offset:6336
  v_cvt_pk_bf16_f32 v220, v220, v221
  v_cndmask_b32 v254, v254, v220, s[96:97]
  v_add_f32 v238, 0x358637bd, v238
  v_rcp_f32 v238, v238
  s_nop 0
  v_pk_mul_f32 v[228:229], v[228:229], v[238:239] op_sel_hi:[1,0]
  v_pk_mul_f32 v[230:231], v[230:231], v[238:239] op_sel_hi:[1,0]
  v_pk_mul_f32 v[232:233], v[232:233], v[238:239] op_sel_hi:[1,0]
  v_pk_mul_f32 v[234:235], v[234:235], v[238:239] op_sel_hi:[1,0]
  v_pk_mul_f32 v[236:237], v[236:237], v[238:239] op_sel_hi:[1,0]
  v_cvt_pk_bf16_f32 v228, v228, v229
  v_cvt_pk_bf16_f32 v229, v230, v231
  v_cvt_pk_bf16_f32 v230, v232, v233
  v_cvt_pk_bf16_f32 v231, v234, v235
  ds_write_b128 v2, v[228:231] offset:7392
  v_cvt_pk_bf16_f32 v236, v236, v237
  v_cndmask_b32 v255, v255, v236, s[96:97]
  ds_write_b128 v15, v[252:255] offset:33792
  s_lshl_b32 s77, s52, 6
  s_add_u32 s77, s77, s53
  s_add_u32 s77, s77, 1
  s_add_u32 s53, s53, 4
  s_min_u32 s74, s53, 63
  s_waitcnt lgkmcnt(0)
  s_barrier
  s_mul_i32 s60, s74, 36864
  s_add_u32 s60, s60, s78
  s_add_u32 s60, s60, s54
  s_add_u32 s61, s78, 38016
  v_add_u32 v8, s76, v3
  ds_read_b128 v[128:131], v8 offset:0
  ds_read_b128 v[132:135], v8 offset:1056
  ds_read_b128 v[136:139], v8 offset:2112
  ds_read_b128 v[140:143], v8 offset:3168
  ds_read_b128 v[144:147], v8 offset:4224
  ds_read_b128 v[148:151], v8 offset:5280
  s_waitcnt lgkmcnt(5)
  v_mfma_f32_32x32x16_bf16 v[160:175], a[0:3], v[128:131], 0
  ds_read_b128 v[128:131], v8 offset:6336
  s_waitcnt lgkmcnt(5)
  v_mfma_f32_32x32x16_bf16 v[160:175], a[4:7], v[132:135], v[160:175]
  s_mov_b32 m0, s61
  s_add_u32 s61, s61, 1024
  buffer_load_dwordx4 v5, s[4:7], s60 offen sc1 lds
  s_add_u32 s60, s60, 1024
  ds_read_b128 v[132:135], v8 offset:7392
  s_waitcnt lgkmcnt(5)
  v_mfma_f32_32x32x16_bf16 v[160:175], a[8:11], v[136:139], v[160:175]
  ds_read_b128 v[136:139], v8 offset:8448
  s_waitcnt lgkmcnt(5)
  v_mfma_f32_32x32x16_bf16 v[160:175], a[12:15], v[140:143], v[160:175]
  ds_read_b128 v[140:143], v8 offset:9504
  s_waitcnt lgkmcnt(5)
  v_mfma_f32_32x32x16_bf16 v[160:175], a[16:19], v[144:147], v[160:175]
  s_mov_b32 m0, s61
  s_add_u32 s61, s61, 1024
  buffer_load_dwordx4 v5, s[4:7], s60 offen sc1 lds
  s_add_u32 s60, s60, 1024
  ds_read_b128 v[144:147], v8 offset:10560
  s_waitcnt lgkmcnt(5)
  v_mfma_f32_32x32x16_bf16 v[160:175], a[20:23], v[148:151], v[160:175]
  ds_read_b128 v[148:151], v8 offset:11616
  s_waitcnt lgkmcnt(5)
  v_mfma_f32_32x32x16_bf16 v[160:175], a[24:27], v[128:131], v[160:175]
  ds_read_b128 v[128:131], v8 offset:12672
  s_waitcnt lgkmcnt(5)
  v_mfma_f32_32x32x16_bf16 v[160:175], a[28:31], v[132:135], v[160:175]
  s_mov_b32 m0, s61
  s_add_u32 s61, s61, 1024
  buffer_load_dwordx4 v5, s[4:7], s60 offen sc1 lds
  s_add_u32 s60, s60, 1024
  ds_read_b128 v[132:135], v8 offset:13728
  s_waitcnt lgkmcnt(5)
  v_mfma_f32_32x32x16_bf16 v[160:175], a[32:35], v[136:139], v[160:175]
  ds_read_b128 v[136:139], v8 offset:14784
  s_waitcnt lgkmcnt(5)
  v_mfma_f32_32x32x16_bf16 v[160:175], a[36:39], v[140:143], v[160:175]
  ds_read_b128 v[140:143], v8 offset:15840
  s_waitcnt lgkmcnt(5)
  v_mfma_f32_32x32x16_bf16 v[160:175], a[40:43], v[144:147], v[160:175]
  s_mov_b32 m0, s61
  s_add_u32 s61, s61, 1024
  buffer_load_dwordx4 v5, s[4:7], s60 offen sc1 lds
  s_add_u32 s60, s60, 1024
  ds_read_b128 v[144:147], v8 offset:16896
  s_waitcnt lgkmcnt(5)
  v_mfma_f32_32x32x16_bf16 v[160:175], a[44:47], v[148:151], v[160:175]
  ds_read_b128 v[148:151], v8 offset:17952
  s_waitcnt lgkmcnt(5)
  v_mfma_f32_32x32x16_bf16 v[160:175], a[48:51], v[128:131], v[160:175]
  ds_read_b128 v[128:131], v8 offset:19008
  s_waitcnt lgkmcnt(5)
  v_mfma_f32_32x32x16_bf16 v[160:175], a[52:55], v[132:135], v[160:175]
  s_mov_b32 m0, s61
  s_add_u32 s61, s61, 1024
  buffer_load_dwordx4 v5, s[4:7], s60 offen sc1 lds
  s_add_u32 s60, s60, 1024
  ds_read_b128 v[132:135], v8 offset:20064
  s_waitcnt lgkmcnt(5)
  v_mfma_f32_32x32x16_bf16 v[160:175], a[56:59], v[136:139], v[160:175]
  ds_read_b128 v[136:139], v8 offset:21120
  s_waitcnt lgkmcnt(5)
  v_mfma_f32_32x32x16_bf16 v[160:175], a[60:63], v[140:143], v[160:175]
  ds_read_b128 v[140:143], v8 offset:22176
  s_waitcnt lgkmcnt(5)
  v_mfma_f32_32x32x16_bf16 v[160:175], a[64:67], v[144:147], v[160:175]
  s_mov_b32 m0, s61
  s_add_u32 s61, s61, 1024
  buffer_load_dwordx4 v5, s[4:7], s60 offen sc1 lds
  s_add_u32 s60, s60, 1024
  ds_read_b128 v[144:147], v8 offset:23232
  s_waitcnt lgkmcnt(5)
  v_mfma_f32_32x32x16_bf16 v[160:175], a[68:71], v[148:151], v[160:175]
  ds_read_b128 v[148:151], v8 offset:24288
  s_waitcnt lgkmcnt(5)
  v_mfma_f32_32x32x16_bf16 v[160:175], a[72:75], v[128:131], v[160:175]
  ds_read_b128 v[128:131], v8 offset:25344
  s_waitcnt lgkmcnt(5)
  v_mfma_f32_32x32x16_bf16 v[160:175], a[76:79], v[132:135], v[160:175]
  s_mov_b32 m0, s61
  s_add_u32 s61, s61, 1024
  buffer_load_dwordx4 v5, s[4:7], s60 offen sc1 lds
  s_add_u32 s60, s60, 1024
  ds_read_b128 v[132:135], v8 offset:26400
  s_waitcnt lgkmcnt(5)
  v_mfma_f32_32x32x16_bf16 v[160:175], a[80:83], v[136:139], v[160:175]
  ds_read_b128 v[136:139], v8 offset:27456
  s_waitcnt lgkmcnt(5)
  v_mfma_f32_32x32x16_bf16 v[160:175], a[84:87], v[140:143], v[160:175]
  ds_read_b128 v[140:143], v8 offset:28512
  s_waitcnt lgkmcnt(5)
  v_mfma_f32_32x32x16_bf16 v[160:175], a[88:91], v[144:147], v[160:175]
  s_mov_b32 m0, s61
  s_add_u32 s61, s61, 1024
  buffer_load_dwordx4 v5, s[4:7], s60 offen sc1 lds
  s_add_u32 s60, s60, 1024
  ds_read_b128 v[144:147], v8 offset:29568
  s_waitcnt lgkmcnt(5)
  v_mfma_f32_32x32x16_bf16 v[160:175], a[92:95], v[148:151], v[160:175]
  ds_read_b128 v[148:151], v8 offset:30624
  s_waitcnt lgkmcnt(5)
  v_mfma_f32_32x32x16_bf16 v[160:175], a[96:99], v[128:131], v[160:175]
  ds_read_b128 v[128:131], v8 offset:31680
  s_waitcnt lgkmcnt(5)
  v_mfma_f32_32x32x16_bf16 v[160:175], a[100:103], v[132:135], v[160:175]
  s_mov_b32 m0, s61
  s_add_u32 s61, s61, 1024
  buffer_load_dwordx4 v5, s[4:7], s60 offen sc1 lds
  s_add_u32 s60, s60, 1024
  ds_read_b128 v[132:135], v8 offset:32736
  s_waitcnt lgkmcnt(5)
  v_mfma_f32_32x32x16_bf16 v[160:175], a[104:107], v[136:139], v[160:175]
  ds_read_b128 v[136:139], v8 offset:33792
  s_waitcnt lgkmcnt(5)
  v_mfma_f32_32x32x16_bf16 v[160:175], a[108:111], v[140:143], v[160:175]
  ds_read_b128 v[140:143], v8 offset:34848
  s_waitcnt lgkmcnt(5)
  v_mfma_f32_32x32x16_bf16 v[160:175], a[112:115], v[144:147], v[160:175]
  ds_read_b128 v[144:147], v8 offset:35904
  s_waitcnt lgkmcnt(5)
  v_mfma_f32_32x32x16_bf16 v[160:175], a[116:119], v[148:151], v[160:175]
  ds_read_b128 v[148:151], v8 offset:36960
  s_waitcnt lgkmcnt(5)
  v_mfma_f32_32x32x16_bf16 v[160:175], a[120:123], v[128:131], v[160:175]
  s_waitcnt lgkmcnt(4)
  v_mfma_f32_32x32x16_bf16 v[160:175], a[124:127], v[132:135], v[160:175]
  s_waitcnt lgkmcnt(3)
  v_mfma_f32_32x32x16_bf16 v[160:175], a[128:131], v[136:139], v[160:175]
  s_waitcnt lgkmcnt(2)
  v_mfma_f32_32x32x16_bf16 v[160:175], a[132:135], v[140:143], v[160:175]
  s_waitcnt lgkmcnt(1)
  v_mfma_f32_32x32x16_bf16 v[160:175], a[136:139], v[144:147], v[160:175]
  s_waitcnt lgkmcnt(0)
  v_mfma_f32_32x32x16_bf16 v[160:175], a[140:143], v[148:151], v[160:175]
  s_waitcnt vmcnt(10)
  v_permlane32_swap_b32 v244, v246
  v_permlane32_swap_b32 v245, v247
  v_lshlrev_b32 v8, 16, v244
  v_and_b32 v9, 0xffff0000, v244
  s_nop 6
  v_add_f32 v8, v8, v160
  v_add_f32 v9, v9, v161
  v_cvt_pk_bf16_f32 v244, v8, v9
  v_lshlrev_b32 v8, 16, v245
  v_and_b32 v9, 0xffff0000, v245
  v_add_f32 v8, v8, v162
  v_add_f32 v9, v9, v163
  v_cvt_pk_bf16_f32 v245, v8, v9
  v_lshlrev_b32 v8, 16, v246
  v_and_b32 v9, 0xffff0000, v246
  v_add_f32 v8, v8, v164
  v_add_f32 v9, v9, v165
  v_cvt_pk_bf16_f32 v246, v8, v9
  v_lshlrev_b32 v8, 16, v247
  v_and_b32 v9, 0xffff0000, v247
  v_add_f32 v8, v8, v166
  v_add_f32 v9, v9, v167
  v_cvt_pk_bf16_f32 v247, v8, v9
  v_permlane32_swap_b32 v244, v246
  s_nop 0
  v_permlane32_swap_b32 v245, v247
  buffer_store_dwordx4 v[244:247], v12, s[16:19], s75 offen offset:0 sc1
  s_waitcnt vmcnt(10)
  v_permlane32_swap_b32 v248, v250
  v_permlane32_swap_b32 v249, v251
  v_lshlrev_b32 v8, 16, v248
  v_and_b32 v9, 0xffff0000, v248
  v_add_f32 v8, v8, v168
  v_add_f32 v9, v9, v169
  v_cvt_pk_bf16_f32 v248, v8, v9
  v_lshlrev_b32 v8, 16, v249
  v_and_b32 v9, 0xffff0000, v249
  v_add_f32 v8, v8, v170
  v_add_f32 v9, v9, v171
  v_cvt_pk_bf16_f32 v249, v8, v9
  v_lshlrev_b32 v8, 16, v250
  v_and_b32 v9, 0xffff0000, v250
  v_add_f32 v8, v8, v172
  v_add_f32 v9, v9, v173
  v_cvt_pk_bf16_f32 v250, v8, v9
  v_lshlrev_b32 v8, 16, v251
  v_and_b32 v9, 0xffff0000, v251
  v_add_f32 v8, v8, v174
  v_add_f32 v9, v9, v175
  v_cvt_pk_bf16_f32 v251, v8, v9
  v_permlane32_swap_b32 v248, v250
  s_nop 0
  v_permlane32_swap_b32 v249, v251
  buffer_store_dwordx4 v[248:251], v12, s[16:19], s75 offen offset:32 sc1
  s_waitcnt vmcnt(0) lgkmcnt(0)
  s_barrier
  s_cmp_lg_u32 s51, 0
  s_cbranch_scc1 w0_38
  s_mov_b64 exec, 1
  v_mov_b32 v8, 0
  v_mov_b32 v9, s77
  buffer_store_dword v9, v8, s[4:7], s70 offen sc1
  s_mov_b64 exec, -1
w0_38:
  s_cmp_lt_u32 s53, 64
  s_cbranch_scc1 A2_LOOP
A2_DONE:
  s_sub_u32 s60, s68, 192
  s_lshr_b32 s53, s60, 3
  s_lshl_b32 s60, s60, 2
  s_add_u32 s60, s60, s51
  s_add_u32 s70, s60, 160
  s_lshl_b32 s70, s70, 6
  s_and_b32 s74, s60, 31
  s_mov_b32 s78, 0x3e0293ee
  v_and_b32 v15, 1, v0
  v_lshlrev_b32 v15, 8, v15
  v_lshl_add_u32 v15, v6, 9, v15
  v_bfe_u32 v8, v0, 1, 4
  v_lshl_add_u32 v15, v8, 4, v15
  v_min_u32 v4, 2, v0
  v_lshlrev_b32 v4, 11, v4
  v_and_b32 v12, 7, v0
  v_lshlrev_b32 v12, 4, v12
  v_lshl_add_u32 v12, v6, 7, v12
  v_lshlrev_b32 v13, 2, v7
  v_lshl_add_u32 v13, v6, 8, v13
  v_mov_b32 v14, 6144
  v_lshlrev_b32 v8, 2, v6
  v_sub_u32 v8, v7, v8
  v_mov_b32 v9, 0xff800000
  v_cmp_le_i32 vcc, 0, v8
  s_nop 1
  v_cndmask_b32 v188, v9, 0, vcc
  v_cmp_le_i32 vcc, 1, v8
  s_nop 1
  v_cndmask_b32 v189, v9, 0, vcc
  v_cmp_le_i32 vcc, 2, v8
  s_nop 1
  v_cndmask_b32 v190, v9, 0, vcc
  v_cmp_le_i32 vcc, 3, v8
  s_nop 1
  v_cndmask_b32 v191, v9, 0, vcc
  v_cmp_le_i32 vcc, 8, v8
  s_nop 1
  v_cndmask_b32 v192, v9, 0, vcc
  v_cmp_le_i32 vcc, 9, v8
  s_nop 1
  v_cndmask_b32 v193, v9, 0, vcc
  v_cmp_le_i32 vcc, 10, v8
  s_nop 1
  v_cndmask_b32 v194, v9, 0, vcc
  v_cmp_le_i32 vcc, 11, v8
  s_nop 1
  v_cndmask_b32 v195, v9, 0, vcc
  v_cmp_le_i32 vcc, 16, v8
  s_nop 1
  v_cndmask_b32 v196, v9, 0, vcc
  v_cmp_le_i32 vcc, 17, v8
  s_nop 1
  v_cndmask_b32 v197, v9, 0, vcc
  v_cmp_le_i32 vcc, 18, v8
  s_nop 1
  v_cndmask_b32 v198, v9, 0, vcc
  v_cmp_le_i32 vcc, 19, v8
  s_nop 1
  v_cndmask_b32 v199, v9, 0, vcc
  v_cmp_le_i32 vcc, 24, v8
  s_nop 1
  v_cndmask_b32 v200, v9, 0, vcc
  v_cmp_le_i32 vcc, 25, v8
  s_nop 1
  v_cndmask_b32 v201, v9, 0, vcc
  v_cmp_le_i32 vcc, 26, v8
  s_nop 1
  v_cndmask_b32 v202, v9, 0, vcc
  v_cmp_le_i32 vcc, 27, v8
  s_nop 1
  v_cndmask_b32 v203, v9, 0, vcc
AT_LOOP:
  s_add_u32 s69, s74, 32
  s_lshl_b32 s69, s69, 6
  s_lshl_b32 s77, s52, 6
  s_add_u32 s77, s77, s53
  s_add_u32 s77, s77, 1
  s_mov_b32 s55, 150000
poll_39:
  buffer_load_dword v8, v4, s[4:7], s69 offen sc1
  s_waitcnt vmcnt(0)
  v_cmp_gt_u32 vcc, s77, v8
  s_nop 0
  s_cbranch_vccz pdone_40
  s_sleep 2
  s_mov_b32 s58, 41
  s_sub_u32 s55, s55, 1
  s_cbranch_scc0 poll_39
  s_branch ABORT
pdone_40:
  s_lshl_b32 s75, s53, 5
  s_add_u32 s75, s75, s74
  s_lshl_b32 s71, s75, 11
  s_add_u32 s71, s71, s54
  s_lshl_b32 s75, s75, 13
  s_add_u32 s75, s75, s54
  s_add_u32 s60, s75, 6291456
  buffer_load_dwordx4 v[20:23], v5, s[4:7], s60 offen offset:0 sc1
  buffer_load_dwordx4 v[24:27], v5, s[4:7], s60 offen offset:1024 sc1
  buffer_load_dwordx4 v[28:31], v5, s[4:7], s60 offen offset:2048 sc1
  buffer_load_dwordx4 v[32:35], v5, s[4:7], s60 offen offset:3072 sc1
  s_add_u32 s61, s75, 23068672
  buffer_load_dwordx4 v[52:55], v5, s[4:7], s61 offen offset:0 sc1
  buffer_load_dwordx4 v[56:59], v5, s[4:7], s61 offen offset:1024 sc1
  buffer_load_dwordx4 v[60:63], v5, s[4:7], s61 offen offset:2048 sc1
  buffer_load_dwordx4 v[64:67], v5, s[4:7], s61 offen offset:3072 sc1
  s_add_u32 s62, s75, 6295552
  buffer_load_dwordx4 v[36:39], v5, s[4:7], s62 offen offset:0 sc1
  buffer_load_dwordx4 v[40:43], v5, s[4:7], s62 offen offset:1024 sc1
  buffer_load_dwordx4 v[44:47], v5, s[4:7], s62 offen offset:2048 sc1
  buffer_load_dwordx4 v[48:51], v5, s[4:7], s62 offen offset:3072 sc1
  s_add_u32 s63, s75, 23072768
  buffer_load_dwordx4 v[68:71], v5, s[4:7], s63 offen offset:0 sc1
  buffer_load_dwordx4 v[72:75], v5, s[4:7], s63 offen offset:1024 sc1
  buffer_load_dwordx4 v[76:79], v5, s[4:7], s63 offen offset:2048 sc1
  buffer_load_dwordx4 v[80:83], v5, s[4:7], s63 offen offset:3072 sc1
  s_add_u32 s64, s75, 39845888
  buffer_load_dwordx4 v[84:87], v15, s[4:7], s64 offen offset:0 sc1
  buffer_load_dwordx4 v[88:91], v15, s[4:7], s64 offen offset:1024 sc1
  buffer_load_dwordx4 v[92:95], v15, s[4:7], s64 offen offset:2048 sc1
  buffer_load_dwordx4 v[96:99], v15, s[4:7], s64 offen offset:3072 sc1
  s_add_u32 s65, s75, 39849984
  buffer_load_dwordx4 v[100:103], v15, s[4:7], s65 offen offset:0 sc1
  buffer_load_dwordx4 v[104:107], v15, s[4:7], s65 offen offset:1024 sc1
  buffer_load_dwordx4 v[108:111], v15, s[4:7], s65 offen offset:2048 sc1
  buffer_load_dwordx4 v[112:115], v15, s[4:7], s65 offen offset:3072 sc1
  s_waitcnt vmcnt(19)
  v_mfma_f32_32x32x16_bf16 v[156:171], v[52:55], v[20:23], v[188:203]
  s_waitcnt vmcnt(18)
  v_mfma_f32_32x32x16_bf16 v[156:171], v[56:59], v[24:27], v[156:171]
  s_waitcnt vmcnt(17)
  v_mfma_f32_32x32x16_bf16 v[156:171], v[60:63], v[28:31], v[156:171]
  s_waitcnt vmcnt(16)
  v_mfma_f32_32x32x16_bf16 v[156:171], v[64:67], v[32:35], v[156:171]
  s_waitcnt vmcnt(11)
  v_mfma_f32_32x32x16_bf16 v[156:171], v[68:71], v[36:39], v[156:171]
  s_waitcnt vmcnt(10)
  v_mfma_f32_32x32x16_bf16 v[156:171], v[72:75], v[40:43], v[156:171]
  s_waitcnt vmcnt(9)
  v_mfma_f32_32x32x16_bf16 v[156:171], v[76:79], v[44:47], v[156:171]
  s_waitcnt vmcnt(8)
  v_mfma_f32_32x32x16_bf16 v[156:171], v[80:83], v[48:51], v[156:171]
  s_nop 11
  v_max3_f32 v16, v156, v157, v158
  v_max3_f32 v16, v16, v159, v160
  v_max3_f32 v16, v16, v161, v162
  v_max3_f32 v16, v16, v163, v164
  v_max3_f32 v16, v16, v165, v166
  v_max3_f32 v16, v16, v167, v168
  v_max3_f32 v16, v16, v169, v170
  s_mov_b32 s55, 150000
poll_41:
  buffer_load_dword v8, v14, s[4:7], s69 offen sc1
  s_waitcnt vmcnt(0)
  v_cmp_gt_u32 vcc, s77, v8
  s_nop 0
  s_cbranch_vccz pdone_42
  s_sleep 1
  s_mov_b32 s58, 42
  s_sub_u32 s55, s55, 1
  s_cbranch_scc0 poll_41
  s_branch ABORT
pdone_42:
  s_add_u32 s60, s71, 73400320
  s_add_u32 s61, s71, 77594624
  s_add_u32 s62, s75, 56623104
  s_add_u32 s63, s75, 56627200
  buffer_load_dwordx4 v[116:119], v12, s[4:7], s60 offen offset:0 sc1
  buffer_load_dwordx4 v[120:123], v12, s[4:7], s60 offen offset:256 sc1
  buffer_load_dwordx4 v[124:127], v12, s[4:7], s60 offen offset:512 sc1
  buffer_load_dwordx4 v[128:131], v12, s[4:7], s60 offen offset:768 sc1
  buffer_load_dwordx4 v[132:135], v12, s[4:7], s60 offen offset:1024 sc1
  buffer_load_dwordx4 v[136:139], v12, s[4:7], s60 offen offset:1280 sc1
  buffer_load_dwordx4 v[140:143], v12, s[4:7], s60 offen offset:1536 sc1
  buffer_load_dwordx4 v[144:147], v12, s[4:7], s60 offen offset:1792 sc1
  buffer_load_dword v148, v13, s[4:7], s61 offen offset:0 sc1
  buffer_load_dword v149, v13, s[4:7], s61 offen offset:128 sc1
  buffer_load_dword v150, v13, s[4:7], s61 offen offset:512 sc1
  buffer_load_dword v151, v13, s[4:7], s61 offen offset:640 sc1
  buffer_load_dword v152, v13, s[4:7], s61 offen offset:1024 sc1
  buffer_load_dword v153, v13, s[4:7], s61 offen offset:1152 sc1
  buffer_load_dword v154, v13, s[4:7], s61 offen offset:1536 sc1
  buffer_load_dword v155, v13, s[4:7], s61 offen offset:1664 sc1
  s_waitcnt vmcnt(15)
  v_mfma_f32_32x32x16_bf16 v[172:187], v[116:119], v[20:23], 0
  s_waitcnt vmcnt(14)
  v_mfma_f32_32x32x16_bf16 v[172:187], v[120:123], v[24:27], v[172:187]
  s_waitcnt vmcnt(13)
  v_mfma_f32_32x32x16_bf16 v[172:187], v[124:127], v[28:31], v[172:187]
  s_waitcnt vmcnt(12)
  v_mfma_f32_32x32x16_bf16 v[172:187], v[128:131], v[32:35], v[172:187]
  s_waitcnt vmcnt(11)
  v_mfma_f32_32x32x16_bf16 v[172:187], v[132:135], v[36:39], v[172:187]
  s_waitcnt vmcnt(10)
  v_mfma_f32_32x32x16_bf16 v[172:187], v[136:139], v[40:43], v[172:187]
  s_waitcnt vmcnt(9)
  v_mfma_f32_32x32x16_bf16 v[172:187], v[140:143], v[44:47], v[172:187]
  s_waitcnt vmcnt(8)
  v_mfma_f32_32x32x16_bf16 v[172:187], v[144:147], v[48:51], v[172:187]
  s_nop 11
  v_max3_f32 v16, v16, v171, v172
  v_max3_f32 v16, v16, v173, v174
  v_max_f32 v17, v16, v175
  v_max_f32 v16, v16, v175
  s_nop 1
  v_permlane32_swap_b32 v16, v17
  v_max_f32 v16, v16, v17
  v_mul_f32 v16, s78, v16
  v_pk_fma_f32 v[156:157], v[156:157], s[78:79], v[16:17] op_sel_hi:[1,0,0] neg_lo:[0,0,1] neg_hi:[0,0,1]
  v_exp_f32 v156, v156
  v_exp_f32 v157, v157
  v_pk_fma_f32 v[158:159], v[158:159], s[78:79], v[16:17] op_sel_hi:[1,0,0] neg_lo:[0,0,1] neg_hi:[0,0,1]
  v_exp_f32 v158, v158
  v_exp_f32 v159, v159
  v_pk_fma_f32 v[160:161], v[160:161], s[78:79], v[16:17] op_sel_hi:[1,0,0] neg_lo:[0,0,1] neg_hi:[0,0,1]
  v_exp_f32 v160, v160
  v_exp_f32 v161, v161
  v_pk_fma_f32 v[162:163], v[162:163], s[78:79], v[16:17] op_sel_hi:[1,0,0] neg_lo:[0,0,1] neg_hi:[0,0,1]
  v_exp_f32 v162, v162
  v_exp_f32 v163, v163
  v_pk_fma_f32 v[164:165], v[164:165], s[78:79], v[16:17] op_sel_hi:[1,0,0] neg_lo:[0,0,1] neg_hi:[0,0,1]
  v_exp_f32 v164, v164
  v_exp_f32 v165, v165
  v_pk_fma_f32 v[166:167], v[166:167], s[78:79], v[16:17] op_sel_hi:[1,0,0] neg_lo:[0,0,1] neg_hi:[0,0,1]
  v_exp_f32 v166, v166
  v_exp_f32 v167, v167
  v_pk_fma_f32 v[168:169], v[168:169], s[78:79], v[16:17] op_sel_hi:[1,0,0] neg_lo:[0,0,1] neg_hi:[0,0,1]
  v_exp_f32 v168, v168
  v_exp_f32 v169, v169
  v_pk_fma_f32 v[170:171], v[170:171], s[78:79], v[16:17] op_sel_hi:[1,0,0] neg_lo:[0,0,1] neg_hi:[0,0,1]
  v_exp_f32 v170, v170
  v_exp_f32 v171, v171
  v_pk_fma_f32 v[172:173], v[172:173], s[78:79], v[16:17] op_sel_hi:[1,0,0] neg_lo:[0,0,1] neg_hi:[0,0,1]
  v_exp_f32 v172, v172
  v_exp_f32 v173, v173
  v_pk_fma_f32 v[174:175], v[174:175], s[78:79], v[16:17] op_sel_hi:[1,0,0] neg_lo:[0,0,1] neg_hi:[0,0,1]
  v_exp_f32 v174, v174
  v_exp_f32 v175, v175
  v_pk_add_f32 v[18:19], v[156:157], v[158:159]
  v_pk_add_f32 v[18:19], v[18:19], v[160:161]
  v_pk_add_f32 v[18:19], v[18:19], v[162:163]
  v_pk_add_f32 v[18:19], v[18:19], v[164:165]
  v_pk_add_f32 v[18:19], v[18:19], v[166:167]
  v_pk_add_f32 v[18:19], v[18:19], v[168:169]
  v_pk_add_f32 v[18:19], v[18:19], v[170:171]
  v_pk_add_f32 v[18:19], v[18:19], v[172:173]
  v_pk_add_f32 v[18:19], v[18:19], v[174:175]
  v_add_f32 v16, v18, v19
  v_add_f32 v17, v18, v19
  s_nop 1
  v_permlane32_swap_b32 v16, v17
  v_add_f32 v16, v16, v17
  v_rcp_f32 v16, v16
  s_nop 0
  v_pk_mul_f32 v[156:157], v[156:157], v[16:17] op_sel_hi:[1,0]
  v_cvt_pk_bf16_f32 v156, v156, v157
  v_pk_mul_f32 v[158:159], v[158:159], v[16:17] op_sel_hi:[1,0]
  v_cvt_pk_bf16_f32 v157, v158, v159
  v_pk_mul_f32 v[160:161], v[160:161], v[16:17] op_sel_hi:[1,0]
  v_cvt_pk_bf16_f32 v158, v160, v161
  v_pk_mul_f32 v[162:163], v[162:163], v[16:17] op_sel_hi:[1,0]
  v_cvt_pk_bf16_f32 v159, v162, v163
  v_pk_mul_f32 v[164:165], v[164:165], v[16:17] op_sel_hi:[1,0]
  v_cvt_pk_bf16_f32 v160, v164, v165
  v_pk_mul_f32 v[166:167], v[166:167], v[16:17] op_sel_hi:[1,0]
  v_cvt_pk_bf16_f32 v161, v166, v167
  v_pk_mul_f32 v[168:169], v[168:169], v[16:17] op_sel_hi:[1,0]
  v_cvt_pk_bf16_f32 v162, v168, v169
  v_pk_mul_f32 v[170:171], v[170:171], v[16:17] op_sel_hi:[1,0]
  v_cvt_pk_bf16_f32 v163, v170, v171
  v_pk_mul_f32 v[172:173], v[172:173], v[16:17] op_sel_hi:[1,0]
  v_cvt_pk_bf16_f32 v164, v172, v173
  v_pk_mul_f32 v[174:175], v[174:175], v[16:17] op_sel_hi:[1,0]
  v_cvt_pk_bf16_f32 v165, v174, v175
  s_waitcnt vmcnt(6)
  s_nop 0
  v_mfma_f32_32x32x8bf16_1k v[204:219], v[148:149], v[164:165], 0
  s_waitcnt vmcnt(4)
  v_mfma_f32_32x32x8bf16_1k v[220:235], v[150:151], v[164:165], 0
  s_waitcnt vmcnt(2)
  v_mfma_f32_32x32x8bf16_1k v[236:251], v[152:153], v[164:165], 0
  s_waitcnt vmcnt(0)
  v_mfma_f32_32x32x8bf16_1k v[20:35], v[154:155], v[164:165], 0
  s_nop 3
  v_mfma_f32_32x32x16_bf16 v[204:219], v[84:87], v[156:159], v[204:219]
  v_mfma_f32_32x32x16_bf16 v[204:219], v[88:91], v[160:163], v[204:219]
  v_mfma_f32_32x32x16_bf16 v[220:235], v[92:95], v[156:159], v[220:235]
  v_mfma_f32_32x32x16_bf16 v[220:235], v[96:99], v[160:163], v[220:235]
  s_nop 9
  v_cvt_pk_bf16_f32 v52, v204, v205
  v_cvt_pk_bf16_f32 v53, v206, v207
  v_cvt_pk_bf16_f32 v54, v208, v209
  v_cvt_pk_bf16_f32 v55, v210, v211
  buffer_store_dwordx4 v[52:55], v5, s[4:7], s62 offen offset:0 sc1
  v_cvt_pk_bf16_f32 v56, v212, v213
  v_cvt_pk_bf16_f32 v57, v214, v215
  v_cvt_pk_bf16_f32 v58, v216, v217
  v_cvt_pk_bf16_f32 v59, v218, v219
  buffer_store_dwordx4 v[56:59], v5, s[4:7], s62 offen offset:1024 sc1
  v_mfma_f32_32x32x16_bf16 v[236:251], v[100:103], v[156:159], v[236:251]
  v_mfma_f32_32x32x16_bf16 v[236:251], v[104:107], v[160:163], v[236:251]
  v_cvt_pk_bf16_f32 v60, v220, v221
  v_cvt_pk_bf16_f32 v61, v222, v223
  v_cvt_pk_bf16_f32 v62, v224, v225
  v_cvt_pk_bf16_f32 v63, v226, v227
  buffer_store_dwordx4 v[60:63], v5, s[4:7], s62 offen offset:2048 sc1
  v_cvt_pk_bf16_f32 v64, v228, v229
  v_cvt_pk_bf16_f32 v65, v230, v231
  v_cvt_pk_bf16_f32 v66, v232, v233
  v_cvt_pk_bf16_f32 v67, v234, v235
  buffer_store_dwordx4 v[64:67], v5, s[4:7], s62 offen offset:3072 sc1
  v_mfma_f32_32x32x16_bf16 v[20:35], v[108:111], v[156:159], v[20:35]
  v_mfma_f32_32x32x16_bf16 v[20:35], v[112:115], v[160:163], v[20:35]
  v_cvt_pk_bf16_f32 v68, v236, v237
  v_cvt_pk_bf16_f32 v69, v238, v239
  v_cvt_pk_bf16_f32 v70, v240, v241
  v_cvt_pk_bf16_f32 v71, v242, v243
  buffer_store_dwordx4 v[68:71], v5, s[4:7], s63 offen offset:0 sc1
  v_cvt_pk_bf16_f32 v72, v244, v245
  v_cvt_pk_bf16_f32 v73, v246, v247
  v_cvt_pk_bf16_f32 v74, v248, v249
  v_cvt_pk_bf16_f32 v75, v250, v251
  buffer_store_dwordx4 v[72:75], v5, s[4:7], s63 offen offset:1024 sc1
  s_nop 1
  v_cvt_pk_bf16_f32 v76, v20, v21
  v_cvt_pk_bf16_f32 v77, v22, v23
  v_cvt_pk_bf16_f32 v78, v24, v25
  v_cvt_pk_bf16_f32 v79, v26, v27
  buffer_store_dwordx4 v[76:79], v5, s[4:7], s63 offen offset:2048 sc1
  v_cvt_pk_bf16_f32 v80, v28, v29
  v_cvt_pk_bf16_f32 v81, v30, v31
  v_cvt_pk_bf16_f32 v82, v32, v33
  v_cvt_pk_bf16_f32 v83, v34, v35
  buffer_store_dwordx4 v[80:83], v5, s[4:7], s63 offen offset:3072 sc1
  s_waitcnt vmcnt(0)
  s_mov_b64 exec, 1
  v_mov_b32 v8, 0
  v_mov_b32 v9, s77
  buffer_store_dword v9, v8, s[4:7], s70 offen sc1
  s_mov_b64 exec, -1
  s_add_u32 s53, s53, 3
  s_cmp_lt_u32 s53, 64
  s_cbranch_scc1 AT_LOOP
  s_add_u32 s8, s48, 1048576
  s_addc_u32 s9, s49, 0
  s_mov_b32 s10, 2359296
  s_mov_b32 s11, 0x00020000
  s_add_u32 s52, s52, 1
  s_mov_b32 s54, 104857600
  s_cmp_lt_u32 s52, 2
  s_cbranch_scc1 AT_LAYER
W_END:
  s_branch END
ABORT:
  s_mov_b64 exec, 1
  v_mov_b32 v1, 196
  s_lshl_b32 s58, s58, 16
  s_lshl_b32 s60, s50, 8
  s_or_b32 s58, s58, s60
  s_or_b32 s58, s58, s53
  v_mov_b32 v2, s58
  buffer_store_dword v2, v1, s[20:23], 0 offen
END:
  s_endpgm
.section .rodata,"a"
.p2align 6
.amdhsa_kernel interleave_layers__linear_attn_block__memory_aug_recurrent_mem_tr__prompt_kernel
  .amdhsa_next_free_vgpr 512
  .amdhsa_next_free_sgpr 102
  .amdhsa_accum_offset 256
  .amdhsa_group_segment_fixed_size 0
  .amdhsa_kernarg_size 104
  .amdhsa_user_sgpr_count 2
  .amdhsa_user_sgpr_kernarg_segment_ptr 1
  .amdhsa_system_sgpr_workgroup_id_x 1
.end_amdhsa_kernel
```
